```python
import torch

def _softmax(x, axis=-1):
    return torch.softmax(x, dim=axis)
def _gelu(x):
    return torch.nn.functional.gelu(x, approximate="tanh")
def _silu(x):
    return torch.nn.functional.silu(x)
def _sigmoid(x):
    return torch.sigmoid(x)
def _layernorm(x, axis=-1, eps=1e-5):
    m = x.mean(dim=axis, keepdim=True)
    v = x.var(dim=axis, keepdim=True, unbiased=False)
    return (x - m) / torch.sqrt(v + eps)
def _scatter_add(tgt, idx, src, axis=0):
    return tgt.clone().index_add_(axis, idx, src)
def _segment_sum(src, seg, n):
    out = torch.zeros((n,) + src.shape[1:], dtype=src.dtype)
    return out.index_add_(0, seg, src)
def _pad(x, pw):
    flat = tuple(v for pair in reversed(pw) for v in pair)
    return torch.nn.functional.pad(x, flat)

kernel_name = 'recurrent_scan__sliding_local_dilated__glu_gated_bilinear__prompt'

def setup_inputs():

    _w = (lambda a: (lambda t: t.to(torch.bfloat16) if t.is_floating_point() else t)(torch.as_tensor(a)))
    def _A_setup():
        B, S, D = 1, 2048, 448
        return {
            "x": _w((lambda *s: torch.randn(*s, dtype=torch.bfloat16) * 0.05)(B, S, D)),
            "wqkv": _w((lambda *s: torch.randn(*s, dtype=torch.bfloat16) * 0.2)(D, 3 * D)),
            "wo": _w((lambda *s: torch.randn(*s, dtype=torch.bfloat16) * 0.2)(D, D)),
        }
    _A_in = _A_setup()

    def _B_setup():
        B, S, D, F = 1, 2048, 448, 1792
        return {
            "x": _w((lambda *s: torch.randn(*s, dtype=torch.bfloat16) * 0.05)(B, S, D)),
            "w_gate": _w((lambda *s: torch.randn(*s, dtype=torch.bfloat16) * 0.1)(D, F) * (D ** -0.5)),
            "w_up": _w((lambda *s: torch.randn(*s, dtype=torch.bfloat16) * 0.1)(D, F) * (D ** -0.5)),
            "w_down": _w((lambda *s: torch.randn(*s, dtype=torch.bfloat16) * 0.1)(F, D) * (F ** -0.5)),
        }
    _B_in = _B_setup()

    return {
        "A_x": _A_in["x"],
        "A_wqkv": _A_in["wqkv"],
        "A_wo": _A_in["wo"],
        "B_x": _B_in["x"],
        "B_w_gate": _B_in["w_gate"],
        "B_w_up": _B_in["w_up"],
        "B_w_down": _B_in["w_down"],
    }

def reference(A_x, A_wqkv, A_wo, B_x, B_w_gate, B_w_up, B_w_down):
    def _A_ref(x, wqkv, wo):
        B, S, D = x.shape
        H = 16; Dh = D // H
        W, dil = 8, 2
        qkv = (lambda x, *d: x.permute(*d))((x @ wqkv).reshape(B, S, 3, H, Dh), 2, 0, 3, 1, 4)
        q, k, v = qkv[0], qkv[1], qkv[2]
        scale = Dh ** -0.5
        pos = torch.arange(S)
        off = torch.arange(W) * dil
        idx = pos[:, None] - off[None, :]
        mask = idx >= 0
        idx_c = torch.where(mask, idx, 0).reshape(-1)
        kg = k[:, :, idx_c, :].reshape(B, H, S, W, Dh)
        vg = v[:, :, idx_c, :].reshape(B, H, S, W, Dh)
        logits = torch.einsum("bhsd,bhswd->bhsw", q, kg) * scale
        logits = torch.where(mask[None, None, :, :], logits, -1e9)
        attn = _softmax(logits, axis=-1)
        o = torch.einsum("bhsw,bhswd->bhsd", attn, vg)
        return (lambda x, *d: x.permute(*d))(o, 0, 2, 1, 3).reshape(B, S, D) @ wo

    def _B_ref(x, w_gate, w_up, w_down):
        g = torch.einsum("bsd,df->bsf", x, w_gate)
        u = torch.einsum("bsd,df->bsf", x, w_up)
        h = g * u
        return torch.einsum("bsf,fd->bsd", h, w_down)

    x = A_x
    xn = _layernorm(x, axis=-1)
    s = _A_ref(xn, A_wqkv, A_wo)
    g = _silu(_B_ref(xn, B_w_gate, B_w_up, B_w_down))
    return x + s * g
```

```asm
; @launch grid=(256,1,1) block=(512,1,1) lds=163840
.amdgcn_target "amdgcn-amd-amdhsa--gfx950"
.text
.globl recurrent_scan__sliding_local_dilated__glu_gated_bilinear__prompt_kernel
.p2align 8
.type recurrent_scan__sliding_local_dilated__glu_gated_bilinear__prompt_kernel,@function
recurrent_scan__sliding_local_dilated__glu_gated_bilinear__prompt_kernel:
  s_load_dwordx2 s[12:13], s[0:1], 0
  s_load_dwordx2 s[24:25], s[0:1], 72
  s_load_dwordx2 s[4:5], s[0:1], 16
  s_load_dwordx2 s[8:9], s[0:1], 48
  v_lshrrev_b32 v2, 6, v0
  s_cmp_ge_u32 s2, 256
  s_cbranch_scc1 L_end
  v_readfirstlane_b32 s30, v2
  s_and_b32 s56, s2, 7
  s_lshr_b32 s57, s2, 3
  s_cmp_ge_u32 s57, 21
  s_cbranch_scc1 L_att
  s_load_dwordx2 s[16:17], s[0:1], 32
  s_load_dwordx2 s[20:21], s[0:1], 40
  s_load_dwordx2 s[68:69], s[0:1], 8
  s_getpc_b64 s[48:49]
L_pcffn:
  s_sub_u32 s48, s48, L_pcffn-recurrent_scan__sliding_local_dilated__glu_gated_bilinear__prompt_kernel
  s_subb_u32 s49, s49, 0
  s_mov_b32 s50, L_ffn0-recurrent_scan__sliding_local_dilated__glu_gated_bilinear__prompt_kernel
  s_cmp_ge_u32 s30, 4
  s_cselect_b32 s50, L_ffn1-recurrent_scan__sliding_local_dilated__glu_gated_bilinear__prompt_kernel, s50
  s_lshl_b32 s51, s57, 3
  s_add_u32 s51, s51, s30
  s_lshl_b32 s51, s51, 8
  v_and_b32 v1, 63, v0
  v_and_b32 v4, 1, v1
  v_lshl_add_u32 v4, v4, 7, s51
  v_lshl_add_u32 v5, v1, 7, s50
  v_cmp_gt_u32 vcc, 8, v1
  s_nop 1
  v_cndmask_b32 v4, v4, v5, vcc
  v_min_u32 v4, L_end-recurrent_scan__sliding_local_dilated__glu_gated_bilinear__prompt_kernel, v4
  v_mov_b32 v5, s49
  v_add_co_u32 v4, vcc, s48, v4
  s_nop 1
  v_addc_co_u32 v5, vcc, 0, v5, vcc
  global_load_dword v35, v[4:5], off
  s_and_b32 s60, s56, 3
  s_mul_i32 s60, s60, 21
  s_add_u32 s60, s60, s57
  s_mul_i32 s59, s60, 43
  s_lshr_b32 s59, s59, 8
  s_mul_i32 s58, s59, 6
  s_sub_u32 s58, s60, s58
  s_lshr_b32 s60, s56, 2
  s_mul_i32 s60, s60, 6
  s_add_u32 s58, s58, s60
  s_mul_i32 s33, s58, 176
  s_lshl_b32 s60, s33, 4
  s_mul_i32 s101, s58, 14
  s_add_u32 s101, s101, s59
  s_lshl_b32 s101, s101, 7
  s_add_u32 s101, s101, 9732096
  s_mul_i32 s33, s58, 171
  s_min_u32 s33, s33, 1873
  s_and_b32 s47, s59, 0
  s_lshl_b32 s43, s59, 1
  s_sub_u32 s43, s43, s47
  s_mul_i32 s46, s43, 270336
  s_lshl_b32 s43, s43, 7
  s_add_u32 s46, s46, 2162688
  s_add_u32 s46, s46, s60
  s_load_dwordx2 s[60:61], s[0:1], 64
  s_load_dwordx2 s[72:73], s[0:1], 56
  v_and_b32 v1, 63, v0
  s_and_b32 s29, s30, 3
  s_and_b32 s31, s30, 1
  s_lshr_b32 s32, s30, 1
  v_lshrrev_b32 v3, 4, v1
  v_and_b32 v2, 15, v1
  s_mov_b32 s14, 1835008
  s_mov_b32 s15, 0x20000
  s_mov_b32 s19, 0x20000
  s_mov_b32 s18, 1605632
  s_mov_b32 s22, 1605632
  s_mov_b32 s23, 0x20000
  s_lshl_b32 s47, s32, 2
  s_and_b32 s47, s47, 4
  v_or_b32 v4, s47, v3
  v_lshlrev_b32 v5, 1, v4
  v_xor_b32 v5, v5, v2
  s_mul_i32 s52, s30, 14336
  s_add_u32 s52, s52, s43
  v_mul_u32_u24 v6, 3584, v3
  v_lshl_add_u32 v6, v5, 4, v6
  v_add_u32 v32, s52, v6
  v_add_u32 v33, 114688, v32
  s_lshl_b32 s41, s30, 10
  s_lshl_b32 s53, s31, 2
  v_or_b32 v4, s53, v3
  v_and_b32 v5, 7, v1
  v_xor_b32 v4, v4, v5
  v_lshrrev_b32 v5, 3, v1
  v_mul_u32_u24 v5, 896, v5
  v_lshl_add_u32 v10, v4, 4, v5
  s_lshl_b32 s39, s30, 3
  s_add_u32 s39, s39, s33
  s_mul_i32 s39, s39, 896
  s_add_u32 s34, s39, 0
  s_add_u32 s35, s39, 57344
  s_add_u32 s36, s39, 114688
  s_cmp_eq_u32 s30, 5
  s_cselect_b32 s45, 0x00ffffff, -1
  s_cmp_ge_u32 s30, 6
  s_cselect_b32 s45, 0, s45
  s_cselect_b32 s44, 0, -1
  s_waitcnt lgkmcnt(0)
  s_mov_b32 s64, 0
  s_add_u32 m0, s41, 103936
  s_nop 0
  buffer_load_dwordx4 v32, s[16:19], s64 offen offset:0 lds
  s_add_u32 m0, s41, 112128
  s_nop 0
  buffer_load_dwordx4 v32, s[20:23], s64 offen offset:0 lds
  s_add_u32 m0, s41, 48640
  s_nop 0
  buffer_load_dwordx4 v10, s[12:15], s34 offen offset:0 lds
  s_add_u32 m0, s41, 56832
  s_nop 0
  buffer_load_dwordx4 v10, s[12:15], s35 offen offset:0 lds
  s_add_u32 m0, s41, 65024
  s_mov_b64 exec, s[44:45]
  buffer_load_dwordx4 v10, s[12:15], s36 offen offset:0 lds
  s_mov_b64 exec, -1
  s_barrier
  s_cmp_ge_u32 s30, 4
  s_cbranch_scc1 L_ffn1
  s_branch L_ffn0
L_att:
  s_load_dwordx2 s[16:17], s[0:1], 8
  s_getpc_b64 s[48:49]
L_pcatt:
  s_sub_u32 s48, s48, L_pcatt-recurrent_scan__sliding_local_dilated__glu_gated_bilinear__prompt_kernel
  s_subb_u32 s49, s49, 0
  s_mov_b32 s50, L_att0-recurrent_scan__sliding_local_dilated__glu_gated_bilinear__prompt_kernel
  s_cmp_ge_u32 s30, 4
  s_cselect_b32 s50, L_att1-recurrent_scan__sliding_local_dilated__glu_gated_bilinear__prompt_kernel, s50
  s_lshl_b32 s51, s57, 3
  s_add_u32 s51, s51, s30
  s_lshl_b32 s51, s51, 8
  v_and_b32 v1, 63, v0
  v_and_b32 v4, 1, v1
  v_lshl_add_u32 v4, v4, 7, s51
  v_lshl_add_u32 v5, v1, 7, s50
  v_cmp_gt_u32 vcc, 8, v1
  s_nop 1
  v_cndmask_b32 v4, v4, v5, vcc
  v_min_u32 v4, L_end-recurrent_scan__sliding_local_dilated__glu_gated_bilinear__prompt_kernel, v4
  v_mov_b32 v5, s49
  v_add_co_u32 v4, vcc, s48, v4
  s_nop 1
  v_addc_co_u32 v5, vcc, 0, v5, vcc
  global_load_dword v35, v[4:5], off
  s_lshr_b32 s58, s56, 2
  s_mul_i32 s58, s58, 11
  s_add_u32 s58, s58, s57
  s_sub_u32 s58, s58, 21
  s_and_b32 s59, s56, 3
  s_mul_i32 s60, s58, 94
  s_lshl_b32 s101, s58, 2
  s_add_u32 s101, s101, s59
  s_lshl_b32 s101, s101, 7
  s_add_u32 s101, s101, 9753600
  s_min_u32 s60, s60, 1953
  s_sub_u32 s33, s60, 16
  s_mul_i32 s43, s59, 224
  s_mul_i32 s46, s59, 540672
  s_mul_i32 s60, s58, 1536
  s_add_u32 s46, s46, s60
  s_cmp_eq_u32 s58, 0
  s_cselect_b64 s[54:55], -1, 0
  s_lshl_b32 s47, s2, 3
  s_add_u32 s47, s47, s30
  s_cmp_lg_u32 s47, 2040
  s_cbranch_scc1 L_nononce
  s_load_dwordx2 s[36:37], s[0:1], 64
  s_memrealtime s[34:35]
  s_mov_b32 s38, 256
  s_mov_b32 s39, 0x20000
  v_mov_b32 v6, 0
  s_waitcnt lgkmcnt(0)
  s_or_b32 s34, s34, 1
  s_mul_i32 s35, s35, 0x9e3779b1
  s_xor_b32 s35, s35, s34
  v_mov_b32 v4, s34
  v_mov_b32 v5, s35
  s_mov_b64 exec, 1
  buffer_store_dwordx2 v[4:5], v6, s[36:39], 0 offen sc1
  s_mov_b64 exec, -1
L_nononce:
  s_load_dwordx2 s[60:61], s[0:1], 64
  s_load_dwordx2 s[72:73], s[0:1], 56
  v_and_b32 v1, 63, v0
  s_and_b32 s29, s30, 3
  s_and_b32 s31, s30, 1
  s_lshr_b32 s32, s30, 1
  v_lshrrev_b32 v3, 4, v1
  v_and_b32 v2, 15, v1
  s_mov_b32 s14, 1835008
  s_mov_b32 s15, 0x20000
  s_mov_b32 s19, 0x20000
  s_mov_b32 s18, 1204224
  s_lshl_b32 s47, s32, 2
  s_and_b32 s47, s47, 4
  v_or_b32 v4, s47, v3
  v_lshlrev_b32 v5, 1, v4
  v_xor_b32 v5, v5, v2
  s_mul_i32 s52, s30, 10752
  s_add_u32 s52, s52, s43
  v_mul_u32_u24 v6, 2688, v3
  v_lshl_add_u32 v6, v5, 4, v6
  v_add_u32 v32, s52, v6
  v_cmp_le_u32 vcc, 14, v5
  v_mov_b32 v6, 0x40000000
  s_nop 0
  v_cndmask_b32 v32, v32, v6, vcc
  v_add_u32 v33, 86016, v32
  s_lshl_b32 s41, s30, 10
  s_lshl_b32 s53, s31, 2
  v_or_b32 v4, s53, v3
  v_and_b32 v5, 7, v1
  v_xor_b32 v4, v4, v5
  v_lshrrev_b32 v5, 3, v1
  v_mul_u32_u24 v5, 896, v5
  v_lshl_add_u32 v10, v4, 4, v5
  s_lshl_b32 s39, s30, 3
  s_add_u32 s39, s39, s33
  s_mul_i32 s39, s39, 896
  s_max_i32 s34, s39, 0
  s_add_u32 s35, s39, 57344
  s_cmp_eq_u32 s30, 5
  s_cselect_b32 s45, 0x00ffffff, -1
  s_cmp_ge_u32 s30, 6
  s_cselect_b32 s45, 0, s45
  s_cselect_b32 s44, 0, -1
  s_waitcnt lgkmcnt(0)
  s_mov_b32 s64, 0
  s_add_u32 m0, s41, 73216
  s_nop 0
  buffer_load_dwordx4 v32, s[16:19], s64 offen offset:0 lds
  s_add_u32 m0, s41, 80512
  s_nop 0
  buffer_load_dwordx4 v32, s[16:19], s64 offen offset:896 lds
  s_add_u32 m0, s41, 87808
  s_nop 0
  buffer_load_dwordx4 v32, s[16:19], s64 offen offset:1792 lds
  s_add_u32 m0, s41, 42496
  s_nop 0
  buffer_load_dwordx4 v10, s[12:15], s34 offen offset:0 lds
  s_add_u32 m0, s41, 50688
  s_mov_b64 exec, s[44:45]
  buffer_load_dwordx4 v10, s[12:15], s35 offen offset:0 lds
  s_mov_b64 exec, -1
  s_barrier
  s_cmp_ge_u32 s30, 4
  s_cbranch_scc1 L_att1
  s_branch L_att0
L_ffn0:
  v_mov_b32 v60, 0x40000000
  s_lshl_b32 s37, s2, 3
  s_add_u32 s37, s37, s30
  s_mul_i32 s58, s37, 1792
  v_and_b32 v56, 31, v1
  v_cmp_gt_u32 vcc, 28, v56
  v_lshrrev_b32 v57, 5, v1
  v_mul_u32_u24 v57, 896, v57
  v_lshl_add_u32 v56, v56, 4, v57
  v_add_u32 v56, s58, v56
  v_cndmask_b32 v56, v60, v56, vcc
  buffer_load_dwordx4 v[48:51], v56, s[12:15], 0 offen
  buffer_load_dwordx4 v[52:55], v56, s[12:15], 0 offen offset:448
  s_mov_b32 s70, 1204224
  s_mov_b32 s71, 0x20000
  s_lshl_b32 s59, s2, 2
  s_add_u32 s59, s59, s29
  s_mul_i32 s58, s59, 256
  s_add_u32 s58, s58, 172032
  v_min_u32 v16, 1, v1
  v_lshl_add_u32 v16, v16, 7, s58
  buffer_load_dword v35, v16, s[68:71], 0 offen offset:0
  s_add_u32 m0, s41, 142848
  s_nop 0
  buffer_load_dwordx4 v33, s[16:19], s64 offen offset:0 lds
  s_add_u32 m0, s41, 151040
  s_nop 0
  buffer_load_dwordx4 v33, s[20:23], s64 offen offset:0 lds
  v_lshlrev_b32 v5, 7, v2
  v_add_u32 v5, 0, v5
  v_lshrrev_b32 v4, 1, v2
  v_xor_b32 v4, v4, v3
  v_lshl_add_u32 v13, v4, 4, v5
  v_bfe_u32 v4, v1, 2, 2
  v_lshl_add_u32 v5, v3, 3, v4
  v_lshlrev_b32 v5, 8, v5
  v_add_u32 v5, 71168, v5
  v_and_b32 v6, 1, v3
  v_lshl_add_u32 v4, v6, 2, v4
  v_lshlrev_b32 v4, 5, v4
  v_and_b32 v6, 3, v1
  s_mul_i32 s52, s29, 64
  v_lshl_add_u32 v7, v6, 3, s52
  v_xor_b32 v8, v7, v4
  v_add_u32 v17, v8, v5
  s_waitcnt vmcnt(5)
  s_barrier
  ds_read_b64_tr_b16 a[0:1], v17 offset:32768
  ds_read_b64_tr_b16 a[2:3], v17 offset:33792
  ds_read_b128 v[36:39], v13 offset:48640
  ds_read_b64_tr_b16 a[8:9], v17 offset:40960
  ds_read_b64_tr_b16 a[10:11], v17 offset:41984
  ds_read_b128 v[40:43], v13 offset:50688
  ds_read_b128 v[44:47], v13 offset:52736
  ds_read_b128 v[164:167], v13 offset:54784
  ds_read_b128 v[168:171], v13 offset:56832
  ds_read_b128 v[172:175], v13 offset:58880
  s_waitcnt lgkmcnt(7)
  v_mfma_f32_16x16x32_bf16 v[64:67], a[0:3], v[36:39], 0
  s_mul_i32 s58, s59, 512
  v_add_u32 v7, 32, v7
  v_xor_b32 v8, v7, v4
  s_add_u32 s58, s58, 344064
  s_mov_b32 s64, 229376
  s_mov_b32 s10, 1605632
  v_add_u32 v18, v8, v5
  ds_read_b64_tr_b16 a[4:5], v18 offset:32768
  ds_read_b64_tr_b16 a[6:7], v18 offset:33792
  ds_read_b64_tr_b16 a[12:13], v18 offset:40960
  ds_read_b64_tr_b16 a[14:15], v18 offset:41984
  v_min_u32 v16, 3, v1
  v_lshl_add_u32 v16, v16, 7, s58
  s_mul_i32 s58, s59, 768
  s_add_u32 s58, s58, 458752
  v_min_u32 v15, 5, v1
  v_lshl_add_u32 v15, v15, 7, s58
  v_add_u32 v19, 49152, v17
  v_xor_b32 v14, 64, v13
  v_add_u32 v20, 49152, v18
  s_mul_i32 s58, s59, 768
  s_add_u32 s58, s58, 688128
  v_add_u32 v21, 65536, v13
  s_mov_b32 s11, 0x20000
  s_mov_b32 s6, 401408
  s_mov_b32 s7, 0x20000
  v_add_u32 v22, 65536, v14
  v_mov_b32 v58, 0
  s_lshl_b32 s37, s37, 5
  s_add_u32 s37, s37, 9764864
  s_mov_b32 s27, 0x20000
  s_mov_b32 s26, 9797632
  s_mov_b32 s66, 1463426304
  s_mov_b32 s67, 488447261
  s_cmp_ge_u32 s56, 4
  s_cselect_b32 s66, 3417215348, s66
  s_cselect_b32 s67, 471670045, s67
  s_waitcnt lgkmcnt(2)
  v_mfma_f32_16x16x32_bf16 v[68:71], a[4:7], v[36:39], 0
  s_lshl_b32 s47, s56, 3
  buffer_load_dword v35, v16, s[68:71], 0 offen offset:0
  v_min_u32 v16, 5, v1
  s_lshr_b32 s66, s66, s47
  s_lshr_b32 s67, s67, s47
  s_and_b32 s47, s66, 255
  v_mfma_f32_16x16x32_bf16 v[72:75], a[8:11], v[36:39], 0
  v_lshl_add_u32 v16, v16, 7, s58
  s_mul_i32 s58, s59, 1024
  s_add_u32 s58, s58, 917504
  s_add_u32 s47, s47, s57
  s_mul_i32 s66, s47, 9363
  s_waitcnt lgkmcnt(0)
  v_mfma_f32_16x16x32_bf16 v[76:79], a[12:15], v[36:39], 0
  s_mul_i32 s52, s29, 135168
  v_mul_u32_u24 v4, 33792, v3
  s_and_b32 s77, s67, 255
  s_lshr_b32 s66, s66, 16
  s_add_u32 s46, s46, s52
  s_mul_i32 s67, s66, 7
  v_mfma_f32_16x16x32_bf16 v[80:83], a[0:3], v[40:43], 0
  s_lshl_b32 s52, s29, 8
  buffer_load_dword v35, v15, s[16:19], 0 offen offset:0
  s_add_u32 m0, s41, 71168
  s_sub_u32 s67, s47, s67
  s_add_u32 s52, s52, 1536
  s_lshl_b32 s72, s67, 2
  v_mfma_f32_16x16x32_bf16 v[84:87], a[4:7], v[40:43], 0
  s_mul_i32 s47, s31, 14336
  ds_read_b128 v[36:39], v14 offset:48640
  v_min_u32 v15, 7, v1
  s_cmp_ge_u32 s30, 6
  s_mov_b32 s42, 9474192
  s_cselect_b32 s42, 8421504, s42
  v_mfma_f32_16x16x32_bf16 v[88:91], a[8:11], v[40:43], 0
  s_lshr_b32 s42, s42, s72
  buffer_load_dwordx4 v32, s[16:19], s64 offen offset:0 lds
  s_add_u32 m0, s41, 79360
  s_cmp_ge_u32 s30, 6
  s_cselect_b32 s75, 28, 32
  s_cselect_b32 s73, 16, 19
  s_cselect_b32 s74, 0, s32
  v_mfma_f32_16x16x32_bf16 v[92:95], a[12:15], v[40:43], 0
  s_mul_i32 s75, s75, 896
  v_lshl_add_u32 v15, v15, 7, s58
  s_mul_i32 s58, s59, 1280
  s_add_u32 s58, s58, 0
  s_and_b32 s42, s42, 15
  s_mul_i32 s74, s74, 544768
  v_mfma_f32_16x16x32_bf16 v[96:99], a[0:3], v[44:47], 0
  s_mul_i32 s72, s42, s75
  buffer_load_dwordx4 v32, s[20:23], s64 offen offset:0 lds
  s_add_u32 m0, s41, 120192
  s_add_u32 s72, s72, s74
  s_lshl_b32 s76, s30, 11
  s_mul_i32 s73, s73, s75
  v_mfma_f32_16x16x32_bf16 v[100:103], a[4:7], v[44:47], 0
  s_add_u32 s73, s73, s74
  ds_read_b128 v[40:43], v14 offset:50688
  v_lshl_add_u32 v23, v2, 4, v4
  s_mov_b32 s3, 896
  s_mov_b32 s62, 0x80008000
  s_mov_b32 s63, 0x80008000
  v_mfma_f32_16x16x32_bf16 v[104:107], a[8:11], v[44:47], 0
  v_lshlrev_b32 v4, 1, v3
  v_and_b32 v5, 7, v1
  v_mfma_f32_16x16x32_bf16 v[108:111], a[12:15], v[44:47], 0
  buffer_load_dwordx4 v10, s[12:15], s34 offen offset:128 lds
  s_add_u32 m0, s41, 128384
  v_mfma_f32_16x16x32_bf16 v[112:115], a[0:3], v[164:167], 0
  ds_read_b128 v[44:47], v14 offset:52736
  v_xor_b32 v4, v4, v5
  v_mfma_f32_16x16x32_bf16 v[116:119], a[4:7], v[164:167], 0
  buffer_load_dwordx4 v10, s[12:15], s35 offen offset:128 lds
  s_add_u32 m0, s41, 136576
  v_mfma_f32_16x16x32_bf16 v[120:123], a[8:11], v[164:167], 0
  v_lshl_add_u32 v34, v3, 6, s52
  v_lshrrev_b32 v5, 3, v1
  s_lshl_b32 s52, s67, 7
  s_add_u32 s47, s47, s52
  v_mfma_f32_16x16x32_bf16 v[124:127], a[12:15], v[164:167], 0
  v_mul_u32_u24 v6, 896, v5
  v_lshl_add_u32 v6, v4, 4, v6
  v_mfma_f32_16x16x32_bf16 v[128:131], a[0:3], v[168:171], 0
  buffer_load_dwordx4 v10, s[12:15], s36 offen offset:128 lds
  s_add_u32 m0, s41, 87552
  v_mfma_f32_16x16x32_bf16 v[132:135], a[4:7], v[168:171], 0
  ds_read_b128 v[164:167], v14 offset:54784
  v_add_u32 v11, s47, v6
  s_lshl_b32 s47, s32, 12
  s_add_u32 s47, s47, 26112
  v_mfma_f32_16x16x32_bf16 v[136:139], a[8:11], v[168:171], 0
  s_waitcnt vmcnt(7)
  s_barrier
  ds_read_b64_tr_b16 a[16:17], v19 offset:22528
  v_mfma_f32_16x16x32_bf16 v[140:143], a[12:15], v[168:171], 0
  ds_read_b64_tr_b16 a[18:19], v19 offset:23552
  v_add_u32 v12, s72, v11
  s_add_u32 s72, s72, s75
  s_cmp_eq_u32 s72, s73
  s_cselect_b32 s72, s74, s72
  v_mfma_f32_16x16x32_bf16 v[144:147], a[0:3], v[172:175], 0
  buffer_load_dwordx4 v33, s[16:19], s64 offen offset:0 lds
  s_add_u32 m0, s41, 95744
  v_mfma_f32_16x16x32_bf16 v[148:151], a[4:7], v[172:175], 0
  ds_read_b64_tr_b16 a[20:21], v20 offset:22528
  v_add_u32 v9, 7168, v12
  v_mfma_f32_16x16x32_bf16 v[152:155], a[8:11], v[172:175], 0
  ds_read_b64_tr_b16 a[22:23], v20 offset:23552
  v_lshrrev_b32 v6, 2, v1
  ds_read_b64_tr_b16 a[24:25], v19 offset:30720
  v_mfma_f32_16x16x32_bf16 v[156:159], a[12:15], v[172:175], 0
  s_waitcnt lgkmcnt(3)
  ds_read_b64_tr_b16 a[26:27], v19 offset:31744
  v_lshlrev_b32 v6, 7, v6
  ds_read_b64_tr_b16 a[28:29], v20 offset:30720
  v_mfma_f32_16x16x32_bf16 v[64:67], a[16:19], v[36:39], v[64:67]
  ds_read_b64_tr_b16 a[30:31], v20 offset:31744
  v_and_b32 v7, 3, v1
  ds_read_b128 v[168:171], v14 offset:56832
  ds_read_b128 v[172:175], v14 offset:58880
  v_lshl_add_u32 v6, v7, 3, v6
  v_bfe_u32 v7, v1, 3, 2
  v_xor_b32 v7, s32, v7
  v_lshl_add_u32 v6, v7, 5, v6
  s_waitcnt lgkmcnt(6)
  v_mfma_f32_16x16x32_bf16 v[68:71], a[20:23], v[36:39], v[68:71]
  s_waitcnt lgkmcnt(4)
  buffer_load_dwordx4 v33, s[20:23], s64 offen offset:0 lds
  s_mov_b32 s64, 458752
  s_add_u32 m0, s41, 103936
  v_mfma_f32_16x16x32_bf16 v[72:75], a[24:27], v[36:39], v[72:75]
  s_waitcnt lgkmcnt(2)
  v_add_u32 v4, s47, v6
  v_xor_b32 v5, 32, v4
  v_mfma_f32_16x16x32_bf16 v[76:79], a[28:31], v[36:39], v[76:79]
  v_xor_b32 v6, 64, v4
  v_xor_b32 v7, 96, v4
  v_mfma_f32_16x16x32_bf16 v[80:83], a[16:19], v[40:43], v[80:83]
  v_lshlrev_b32 v27, 3, v2
  v_mfma_f32_16x16x32_bf16 v[84:87], a[20:23], v[40:43], v[84:87]
  v_mfma_f32_16x16x32_bf16 v[88:91], a[24:27], v[40:43], v[88:91]
  buffer_load_dwordx4 v32, s[16:19], s64 offen offset:0 lds
  s_add_u32 m0, s41, 112128
  v_mfma_f32_16x16x32_bf16 v[92:95], a[28:31], v[40:43], v[92:95]
  v_mfma_f32_16x16x32_bf16 v[96:99], a[16:19], v[44:47], v[96:99]
  v_mfma_f32_16x16x32_bf16 v[100:103], a[20:23], v[44:47], v[100:103]
  v_mfma_f32_16x16x32_bf16 v[104:107], a[24:27], v[44:47], v[104:107]
  v_mfma_f32_16x16x32_bf16 v[108:111], a[28:31], v[44:47], v[108:111]
  v_mfma_f32_16x16x32_bf16 v[112:115], a[16:19], v[164:167], v[112:115]
  buffer_load_dwordx4 v32, s[20:23], s64 offen offset:0 lds
  v_mfma_f32_16x16x32_bf16 v[116:119], a[20:23], v[164:167], v[116:119]
  v_mfma_f32_16x16x32_bf16 v[120:123], a[24:27], v[164:167], v[120:123]
  v_mfma_f32_16x16x32_bf16 v[124:127], a[28:31], v[164:167], v[124:127]
  s_waitcnt lgkmcnt(1)
  v_mfma_f32_16x16x32_bf16 v[128:131], a[16:19], v[168:171], v[128:131]
  v_mfma_f32_16x16x32_bf16 v[132:135], a[20:23], v[168:171], v[132:135]
  v_mfma_f32_16x16x32_bf16 v[136:139], a[24:27], v[168:171], v[136:139]
  v_mfma_f32_16x16x32_bf16 v[140:143], a[28:31], v[168:171], v[140:143]
  s_waitcnt lgkmcnt(0)
  v_mfma_f32_16x16x32_bf16 v[144:147], a[16:19], v[172:175], v[144:147]
  s_waitcnt vmcnt(4)
  s_barrier
  v_mov_b32 v56, 0
  v_mov_b32 v57, 0
  s_mov_b32 s65, 0x3f803f80
  v_dot2c_f32_bf16 v56, s65, v48
  v_dot2c_f32_bf16 v57, v48, v48
  v_dot2c_f32_bf16 v56, s65, v49
  v_dot2c_f32_bf16 v57, v49, v49
  v_dot2c_f32_bf16 v56, s65, v50
  v_dot2c_f32_bf16 v57, v50, v50
  v_dot2c_f32_bf16 v56, s65, v51
  v_dot2c_f32_bf16 v57, v51, v51
  v_dot2c_f32_bf16 v56, s65, v52
  v_dot2c_f32_bf16 v57, v52, v52
  v_dot2c_f32_bf16 v56, s65, v53
  v_dot2c_f32_bf16 v57, v53, v53
  v_dot2c_f32_bf16 v56, s65, v54
  v_dot2c_f32_bf16 v57, v54, v54
  v_dot2c_f32_bf16 v56, s65, v55
  v_dot2c_f32_bf16 v57, v55, v55
  s_nop 2
  buffer_load_dword v35, v16, s[68:71], 0 offen offset:0
  s_cmp_ge_u32 s30, 6
  s_cselect_b32 s68, s4, s8
  s_cselect_b32 s69, s5, s9
  s_cselect_b32 s70, s6, s10
  ds_read_b64_tr_b16 a[32:33], v17 offset:0
  v_mfma_f32_16x16x32_bf16 v[148:151], a[20:23], v[172:175], v[148:151]
  s_mov_b32 s71, 0x20000
  ds_read_b64_tr_b16 a[34:35], v17 offset:1024
  v_min_u32 v16, 4, v1
  s_cmp_ge_u32 s57, s77
  s_cselect_b32 s70, 0, s70
  ds_read_b128 v[36:39], v21 offset:54784
  buffer_load_dword v35, v15, s[16:19], 0 offen offset:0
  ds_read_b64_tr_b16 a[36:37], v18 offset:0
  v_mfma_f32_16x16x32_bf16 v[152:155], a[24:27], v[172:175], v[152:155]
  s_add_u32 m0, s41, 25856
  ds_read_b64_tr_b16 a[38:39], v18 offset:1024
  v_min_u32 v15, 9, v1
  ds_read_b64_tr_b16 a[40:41], v17 offset:8192
  v_mfma_f32_16x16x32_bf16 v[156:159], a[28:31], v[172:175], v[156:159]
  ds_read_b64_tr_b16 a[42:43], v17 offset:9216
  v_lshl_add_u32 v15, v15, 7, s58
  s_mul_i32 s58, s59, 640
  s_add_u32 s58, s58, 0
  ds_read_b64_tr_b16 a[44:45], v18 offset:8192
  ds_read_b64_tr_b16 a[46:47], v18 offset:9216
  buffer_load_dwordx4 v10, s[12:15], s34 offen offset:256 lds
  ds_read_b128 v[40:43], v21 offset:56832
  s_add_u32 m0, s41, 34048
  ds_read_b128 v[44:47], v21 offset:58880
  ds_read_b128 v[164:167], v21 offset:60928
  ds_read_b128 v[168:171], v21 offset:62976
  ds_read_b128 v[172:175], v21 offset:65024
  v_lshl_add_u32 v16, v16, 7, s58
  s_waitcnt lgkmcnt(11)
  v_mfma_f32_16x16x32_bf16 v[64:67], a[32:35], v[36:39], v[64:67]
  s_waitcnt lgkmcnt(9)
  s_mul_i32 s58, s59, 1280
  s_add_u32 s58, s58, 0
  v_mfma_f32_16x16x32_bf16 v[68:71], a[36:39], v[36:39], v[68:71]
  s_waitcnt lgkmcnt(7)
  v_permlane16_swap_b32 v56, v57
  v_mfma_f32_16x16x32_bf16 v[72:75], a[40:43], v[36:39], v[72:75]
  s_waitcnt lgkmcnt(5)
  buffer_load_dwordx4 v10, s[12:15], s35 offen offset:256 lds
  s_add_u32 m0, s41, 42240
  v_mfma_f32_16x16x32_bf16 v[76:79], a[44:47], v[36:39], v[76:79]
  s_waitcnt lgkmcnt(4)
  v_add_f32 v52, v56, v57
  v_lshrrev_b32 v55, 1, v1
  v_mfma_f32_16x16x32_bf16 v[80:83], a[32:35], v[40:43], v[80:83]
  ds_read_b128 v[36:39], v22 offset:54784
  v_add_f32_dpp v52, v52, v52 row_ror:8 row_mask:0xf bank_mask:0xf
  v_mfma_f32_16x16x32_bf16 v[84:87], a[36:39], v[40:43], v[84:87]
  buffer_load_dwordx4 v10, s[12:15], s36 offen offset:256 lds
  s_add_u32 m0, s41, 142848
  v_mfma_f32_16x16x32_bf16 v[88:91], a[40:43], v[40:43], v[88:91]
  v_add_f32_dpp v52, v52, v52 row_ror:4 row_mask:0xf bank_mask:0xf
  v_and_b32 v56, 31, v1
  v_mfma_f32_16x16x32_bf16 v[92:95], a[44:47], v[40:43], v[92:95]
  s_waitcnt lgkmcnt(4)
  v_add_f32_dpp v52, v52, v52 row_ror:2 row_mask:0xf bank_mask:0xf
  v_add_u32 v55, s37, v55
  v_mfma_f32_16x16x32_bf16 v[96:99], a[32:35], v[44:47], v[96:99]
  buffer_load_dwordx4 v33, s[16:19], s64 offen offset:0 lds
  s_add_u32 m0, s41, 151040
  v_mfma_f32_16x16x32_bf16 v[100:103], a[36:39], v[44:47], v[100:103]
  ds_read_b128 v[40:43], v22 offset:56832
  v_add_f32_dpp v52, v52, v52 row_ror:1 row_mask:0xf bank_mask:0xf
  v_mfma_f32_16x16x32_bf16 v[104:107], a[40:43], v[44:47], v[104:107]
  v_mov_b32 v53, v52
  v_cmp_eq_u32 vcc, 0, v56
  v_mfma_f32_16x16x32_bf16 v[108:111], a[44:47], v[44:47], v[108:111]
  s_waitcnt lgkmcnt(4)
  buffer_load_dwordx4 v33, s[20:23], s64 offen offset:0 lds
  s_mov_b32 s64, 688128
  v_mfma_f32_16x16x32_bf16 v[112:115], a[32:35], v[164:167], v[112:115]
  ds_read_b128 v[44:47], v22 offset:58880
  v_cndmask_b32 v55, -16, v55, vcc
  v_mfma_f32_16x16x32_bf16 v[116:119], a[36:39], v[164:167], v[116:119]
  v_permlane16_swap_b32 v52, v53
  v_mfma_f32_16x16x32_bf16 v[120:123], a[40:43], v[164:167], v[120:123]
  s_waitcnt vmcnt(9)
  s_barrier
  ds_read_b64_tr_b16 a[0:1], v17 offset:16384
  v_mfma_f32_16x16x32_bf16 v[124:127], a[44:47], v[164:167], v[124:127]
  s_waitcnt lgkmcnt(5)
  s_and_b32 s50, s57, 3
  s_cmp_eq_u32 s50, 0
  s_cbranch_scc0 L_sk1
  buffer_load_dword v35, v15, s[8:11], 0 offen offset:0
L_sk1:
  v_mfma_f32_16x16x32_bf16 v[128:131], a[32:35], v[168:171], v[128:131]
  ds_read_b64_tr_b16 a[2:3], v17 offset:17408
  v_min_u32 v15, 9, v1
  v_mfma_f32_16x16x32_bf16 v[132:135], a[36:39], v[168:171], v[132:135]
  ds_read_b64_tr_b16 a[4:5], v18 offset:16384
  v_lshl_add_u32 v15, v15, 7, s58
  s_mul_i32 s58, s59, 640
  s_add_u32 s58, s58, 0
  v_mfma_f32_16x16x32_bf16 v[136:139], a[40:43], v[168:171], v[136:139]
  s_and_b32 s50, s57, 3
  s_cmp_eq_u32 s50, 0
  s_cbranch_scc0 L_sk2
  buffer_load_dword v35, v16, s[4:7], 0 offen offset:0
L_sk2:
  v_mfma_f32_16x16x32_bf16 v[140:143], a[44:47], v[168:171], v[140:143]
  s_waitcnt lgkmcnt(6)
  s_add_u32 m0, s41, 71168
  v_min_u32 v16, 4, v1
  v_mfma_f32_16x16x32_bf16 v[144:147], a[32:35], v[172:175], v[144:147]
  buffer_load_dwordx4 v32, s[16:19], s64 offen offset:0 lds
  s_add_u32 m0, s41, 79360
  v_mfma_f32_16x16x32_bf16 v[148:151], a[36:39], v[172:175], v[148:151]
  ds_read_b64_tr_b16 a[6:7], v18 offset:17408
  v_lshl_add_u32 v16, v16, 7, s58
  s_mul_i32 s58, s59, 1280
  s_add_u32 s58, s58, 0
  v_mfma_f32_16x16x32_bf16 v[152:155], a[40:43], v[172:175], v[152:155]
  ds_read_b64_tr_b16 a[8:9], v17 offset:24576
  v_mul_f32 v52, 0x3b124925, v52
  v_mfma_f32_16x16x32_bf16 v[156:159], a[44:47], v[172:175], v[156:159]
  s_waitcnt lgkmcnt(3)
  ds_read_b64_tr_b16 a[10:11], v17 offset:25600
  v_mul_f32 v54, v52, v52
  ds_read_b64_tr_b16 a[12:13], v18 offset:24576
  v_mfma_f32_16x16x32_bf16 v[64:67], a[0:3], v[36:39], v[64:67]
  s_waitcnt lgkmcnt(3)
  buffer_load_dwordx4 v32, s[20:23], s64 offen offset:0 lds
  s_add_u32 m0, s41, 3200
  ds_read_b64_tr_b16 a[14:15], v18 offset:25600
  v_mfma_f32_16x16x32_bf16 v[68:71], a[4:7], v[36:39], v[68:71]
  ds_read_b128 v[164:167], v22 offset:60928
  v_mul_f32 v53, 0x3b124925, v53
  ds_read_b128 v[168:171], v22 offset:62976
  ds_read_b128 v[172:175], v22 offset:65024
  v_sub_f32 v53, v53, v54
  v_max_f32 v53, 0, v53
  v_cvt_pk_bf16_f32 v54, -v52, v53
  v_lshlrev_b32 v48, 16, v54
  s_waitcnt lgkmcnt(5)
  v_mfma_f32_16x16x32_bf16 v[72:75], a[8:11], v[36:39], v[72:75]
  buffer_load_dwordx4 v10, s[12:15], s34 offen offset:384 lds
  s_add_u32 m0, s41, 11392
  v_and_b32 v53, 0xffff0000, v54
  v_add_f32 v53, 0x3727c5ac, v53
  s_waitcnt lgkmcnt(3)
  v_mfma_f32_16x16x32_bf16 v[76:79], a[12:15], v[36:39], v[76:79]
  v_cvt_pk_bf16_f32 v53, v53, v53
  v_and_b32 v53, 0xffff0000, v53
  v_mfma_f32_16x16x32_bf16 v[80:83], a[0:3], v[40:43], v[80:83]
  buffer_load_dwordx4 v10, s[12:15], s35 offen offset:384 lds
  s_add_u32 m0, s41, 19584
  v_mfma_f32_16x16x32_bf16 v[84:87], a[4:7], v[40:43], v[84:87]
  v_sqrt_f32 v53, v53
  v_mfma_f32_16x16x32_bf16 v[88:91], a[8:11], v[40:43], v[88:91]
  v_cvt_pk_bf16_f32 v53, v53, v53
  v_and_b32 v53, 0xffff0000, v53
  v_mfma_f32_16x16x32_bf16 v[92:95], a[12:15], v[40:43], v[92:95]
  buffer_load_dwordx4 v10, s[12:15], s36 offen offset:384 lds
  v_mfma_f32_16x16x32_bf16 v[96:99], a[0:3], v[44:47], v[96:99]
  v_rcp_f32 v50, v53
  v_mfma_f32_16x16x32_bf16 v[100:103], a[4:7], v[44:47], v[100:103]
  v_mfma_f32_16x16x32_bf16 v[104:107], a[8:11], v[44:47], v[104:107]
  global_load_dwordx2 v[58:59], v58, s[60:61] sc1
  v_mfma_f32_16x16x32_bf16 v[108:111], a[12:15], v[44:47], v[108:111]
  s_waitcnt lgkmcnt(2)
  v_mfma_f32_16x16x32_bf16 v[112:115], a[0:3], v[164:167], v[112:115]
  s_waitcnt vmcnt(8)
  s_barrier
  ds_read_b64_tr_b16 a[16:17], v17 offset:32768
  v_mfma_f32_16x16x32_bf16 v[116:119], a[4:7], v[164:167], v[116:119]
  s_and_b32 s50, s57, 3
  s_cmp_eq_u32 s50, 1
  s_cbranch_scc0 L_sk3
  buffer_load_dword v35, v15, s[8:11], 0 offen offset:0
L_sk3:
  v_mfma_f32_16x16x32_bf16 v[120:123], a[8:11], v[164:167], v[120:123]
  ds_read_b64_tr_b16 a[18:19], v17 offset:33792
  v_min_u32 v15, 9, v1
  v_mfma_f32_16x16x32_bf16 v[124:127], a[12:15], v[164:167], v[124:127]
  ds_read_b128 v[36:39], v13 offset:26112
  v_lshl_add_u32 v15, v15, 7, s58
  s_mul_i32 s58, s59, 640
  s_add_u32 s58, s58, 0
  s_waitcnt lgkmcnt(4)
  v_mfma_f32_16x16x32_bf16 v[128:131], a[0:3], v[168:171], v[128:131]
  s_and_b32 s50, s57, 3
  s_cmp_eq_u32 s50, 1
  s_cbranch_scc0 L_sk4
  buffer_load_dword v35, v16, s[4:7], 0 offen offset:0
L_sk4:
  v_mfma_f32_16x16x32_bf16 v[132:135], a[4:7], v[168:171], v[132:135]
  s_add_u32 m0, s41, 87552
  ds_read_b64_tr_b16 a[20:21], v18 offset:32768
  v_min_u32 v16, 4, v1
  v_mfma_f32_16x16x32_bf16 v[136:139], a[8:11], v[168:171], v[136:139]
  ds_read_b64_tr_b16 a[22:23], v18 offset:33792
  v_lshl_add_u32 v16, v16, 7, s58
  s_mul_i32 s58, s59, 1280
  s_add_u32 s58, s58, 0
  v_mfma_f32_16x16x32_bf16 v[140:143], a[12:15], v[168:171], v[140:143]
  s_waitcnt lgkmcnt(5)
  buffer_load_dwordx4 v33, s[16:19], s64 offen offset:0 lds
  s_add_u32 m0, s41, 95744
  v_mfma_f32_16x16x32_bf16 v[144:147], a[0:3], v[172:175], v[144:147]
  ds_read_b64_tr_b16 a[24:25], v17 offset:40960
  v_mfma_f32_16x16x32_bf16 v[148:151], a[4:7], v[172:175], v[148:151]
  ds_read_b64_tr_b16 a[26:27], v17 offset:41984
  v_mfma_f32_16x16x32_bf16 v[152:155], a[8:11], v[172:175], v[152:155]
  buffer_load_dwordx4 v33, s[20:23], s64 offen offset:0 lds
  s_add_u32 m0, s41, 48128
  s_mov_b32 s64, 917504
  v_mfma_f32_16x16x32_bf16 v[156:159], a[12:15], v[172:175], v[156:159]
  s_waitcnt lgkmcnt(4)
  ds_read_b64_tr_b16 a[28:29], v18 offset:40960
  v_mfma_f32_16x16x32_bf16 v[64:67], a[16:19], v[36:39], v[64:67]
  s_waitcnt lgkmcnt(3)
  ds_read_b64_tr_b16 a[30:31], v18 offset:41984
  v_mfma_f32_16x16x32_bf16 v[68:71], a[20:23], v[36:39], v[68:71]
  s_waitcnt lgkmcnt(2)
  ds_read_b128 v[40:43], v13 offset:28160
  v_mfma_f32_16x16x32_bf16 v[72:75], a[24:27], v[36:39], v[72:75]
  buffer_load_dwordx4 v10, s[12:15], s34 offen offset:512 lds
  s_add_u32 m0, s41, 56320
  ds_read_b128 v[44:47], v13 offset:30208
  ds_read_b128 v[164:167], v13 offset:32256
  ds_read_b128 v[168:171], v13 offset:34304
  ds_read_b128 v[172:175], v13 offset:36352
  s_waitcnt lgkmcnt(5)
  v_mfma_f32_16x16x32_bf16 v[76:79], a[28:31], v[36:39], v[76:79]
  s_waitcnt lgkmcnt(4)
  v_mfma_f32_16x16x32_bf16 v[80:83], a[16:19], v[40:43], v[80:83]
  buffer_load_dwordx4 v10, s[12:15], s35 offen offset:512 lds
  s_add_u32 m0, s41, 64512
  v_mfma_f32_16x16x32_bf16 v[84:87], a[20:23], v[40:43], v[84:87]
  ds_read_b128 v[36:39], v14 offset:26112
  v_mfma_f32_16x16x32_bf16 v[88:91], a[24:27], v[40:43], v[88:91]
  v_mfma_f32_16x16x32_bf16 v[92:95], a[28:31], v[40:43], v[92:95]
  s_waitcnt lgkmcnt(4)
  buffer_load_dwordx4 v10, s[12:15], s36 offen offset:512 lds
  v_mfma_f32_16x16x32_bf16 v[96:99], a[16:19], v[44:47], v[96:99]
  ds_read_b128 v[40:43], v14 offset:28160
  v_mfma_f32_16x16x32_bf16 v[100:103], a[20:23], v[44:47], v[100:103]
  v_mfma_f32_16x16x32_bf16 v[104:107], a[24:27], v[44:47], v[104:107]
  s_waitcnt vmcnt(11)
  s_barrier
  ds_read_b64_tr_b16 a[32:33], v19 offset:22528
  v_mfma_f32_16x16x32_bf16 v[108:111], a[28:31], v[44:47], v[108:111]
  s_waitcnt lgkmcnt(5)
  s_and_b32 s50, s57, 3
  s_cmp_eq_u32 s50, 2
  s_cbranch_scc0 L_sk5
  buffer_load_dword v35, v15, s[8:11], 0 offen offset:0
L_sk5:
  v_mfma_f32_16x16x32_bf16 v[112:115], a[16:19], v[164:167], v[112:115]
  ds_read_b64_tr_b16 a[34:35], v19 offset:23552
  v_min_u32 v15, 9, v1
  v_mfma_f32_16x16x32_bf16 v[116:119], a[20:23], v[164:167], v[116:119]
  ds_read_b64_tr_b16 a[36:37], v20 offset:22528
  v_lshl_add_u32 v15, v15, 7, s58
  s_mul_i32 s58, s59, 640
  s_add_u32 s58, s58, 0
  s_waitcnt vmcnt(5)
  v_cmp_ne_u32 vcc, 0, v58
  s_nop 4
  s_cbranch_vccz L_pns00
L_pss00:
  v_mfma_f32_16x16x32_bf16 v[120:123], a[24:27], v[164:167], v[120:123]
  s_and_b32 s50, s57, 3
  s_cmp_eq_u32 s50, 2
  s_cbranch_scc0 L_sk6
  buffer_load_dword v35, v16, s[4:7], 0 offen offset:0
L_sk6:
  v_mfma_f32_16x16x32_bf16 v[124:127], a[28:31], v[164:167], v[124:127]
  s_waitcnt lgkmcnt(6)
  s_add_u32 m0, s41, 103936
  v_mov_b32 v49, v58
  v_mfma_f32_16x16x32_bf16 v[128:131], a[16:19], v[168:171], v[128:131]
  ds_read_b64_tr_b16 a[38:39], v20 offset:23552
  v_mov_b32 v51, v59
  v_mfma_f32_16x16x32_bf16 v[132:135], a[20:23], v[168:171], v[132:135]
  buffer_load_dwordx4 v32, s[16:19], s64 offen offset:0 lds
  s_add_u32 m0, s41, 112128
  v_mfma_f32_16x16x32_bf16 v[136:139], a[24:27], v[168:171], v[136:139]
  ds_read_b64_tr_b16 a[40:41], v19 offset:30720
  v_min_u32 v16, 4, v1
  v_mfma_f32_16x16x32_bf16 v[140:143], a[28:31], v[168:171], v[140:143]
  s_waitcnt lgkmcnt(7)
  ds_read_b64_tr_b16 a[42:43], v19 offset:31744
  v_lshl_add_u32 v16, v16, 7, s58
  v_mfma_f32_16x16x32_bf16 v[144:147], a[16:19], v[172:175], v[144:147]
  buffer_load_dwordx4 v32, s[20:23], s64 offen offset:0 lds
  s_add_u32 m0, s41, 119680
  v_mfma_f32_16x16x32_bf16 v[148:151], a[20:23], v[172:175], v[148:151]
  ds_read_b64_tr_b16 a[44:45], v20 offset:30720
  v_mfma_f32_16x16x32_bf16 v[152:155], a[24:27], v[172:175], v[152:155]
  ds_read_b64_tr_b16 a[46:47], v20 offset:31744
  v_mfma_f32_16x16x32_bf16 v[156:159], a[28:31], v[172:175], v[156:159]
  s_waitcnt lgkmcnt(6)
  buffer_load_dwordx4 v10, s[12:15], s34 offen offset:640 lds
  s_add_u32 m0, s41, 127872
  v_mfma_f32_16x16x32_bf16 v[64:67], a[32:35], v[36:39], v[64:67]
  s_waitcnt lgkmcnt(4)
  ds_read_b128 v[44:47], v14 offset:30208
  v_mfma_f32_16x16x32_bf16 v[68:71], a[36:39], v[36:39], v[68:71]
  s_waitcnt lgkmcnt(3)
  ds_read_b128 v[164:167], v14 offset:32256
  v_mfma_f32_16x16x32_bf16 v[72:75], a[40:43], v[36:39], v[72:75]
  s_waitcnt lgkmcnt(2)
  buffer_load_dwordx4 v10, s[12:15], s35 offen offset:640 lds
  v_mfma_f32_16x16x32_bf16 v[76:79], a[44:47], v[36:39], v[76:79]
  ds_read_b128 v[168:171], v14 offset:34304
  v_mfma_f32_16x16x32_bf16 v[80:83], a[32:35], v[40:43], v[80:83]
  ds_read_b128 v[172:175], v14 offset:36352
  v_mfma_f32_16x16x32_bf16 v[84:87], a[36:39], v[40:43], v[84:87]
  buffer_store_dwordx4 v[48:51], v55, s[24:27], 0 offen sc1
  v_mfma_f32_16x16x32_bf16 v[88:91], a[40:43], v[40:43], v[88:91]
  v_mfma_f32_16x16x32_bf16 v[92:95], a[44:47], v[40:43], v[92:95]
  s_waitcnt lgkmcnt(3)
  v_mfma_f32_16x16x32_bf16 v[96:99], a[32:35], v[44:47], v[96:99]
  s_barrier
  ds_read_b64_tr_b16 a[0:1], v17 offset:0
  v_mfma_f32_16x16x32_bf16 v[100:103], a[36:39], v[44:47], v[100:103]
  ds_read_b64_tr_b16 a[2:3], v17 offset:1024
  v_mfma_f32_16x16x32_bf16 v[104:107], a[40:43], v[44:47], v[104:107]
  s_and_b32 s50, s57, 3
  s_cmp_eq_u32 s50, 3
  s_cbranch_scc0 L_sk7
  buffer_load_dword v35, v15, s[8:11], 0 offen offset:0
L_sk7:
  v_mfma_f32_16x16x32_bf16 v[108:111], a[44:47], v[44:47], v[108:111]
  s_waitcnt lgkmcnt(4)
  ds_read_b128 v[36:39], v13 offset:3584
  v_mfma_f32_16x16x32_bf16 v[112:115], a[32:35], v[164:167], v[112:115]
  ds_read_b64_tr_b16 a[4:5], v18 offset:0
  v_mfma_f32_16x16x32_bf16 v[116:119], a[36:39], v[164:167], v[116:119]
  ds_read_b64_tr_b16 a[6:7], v18 offset:1024
  v_mfma_f32_16x16x32_bf16 v[120:123], a[40:43], v[164:167], v[120:123]
  s_and_b32 s50, s57, 3
  s_cmp_eq_u32 s50, 3
  s_cbranch_scc0 L_sk8
  buffer_load_dword v35, v16, s[4:7], 0 offen offset:0
L_sk8:
  v_mfma_f32_16x16x32_bf16 v[124:127], a[44:47], v[164:167], v[124:127]
  s_waitcnt lgkmcnt(6)
  s_add_u32 m0, s41, 142848
  v_mfma_f32_16x16x32_bf16 v[128:131], a[32:35], v[168:171], v[128:131]
  ds_read_b64_tr_b16 a[8:9], v17 offset:8192
  v_mfma_f32_16x16x32_bf16 v[132:135], a[36:39], v[168:171], v[132:135]
  ds_read_b64_tr_b16 a[10:11], v17 offset:9216
  v_mfma_f32_16x16x32_bf16 v[136:139], a[40:43], v[168:171], v[136:139]
  buffer_load_dwordx4 v33, s[16:19], s64 offen offset:0 lds
  s_add_u32 m0, s41, 151040
  v_mfma_f32_16x16x32_bf16 v[140:143], a[44:47], v[168:171], v[140:143]
  s_waitcnt lgkmcnt(7)
  ds_read_b64_tr_b16 a[12:13], v18 offset:8192
  v_mfma_f32_16x16x32_bf16 v[144:147], a[32:35], v[172:175], v[144:147]
  ds_read_b64_tr_b16 a[14:15], v18 offset:9216
  v_mfma_f32_16x16x32_bf16 v[148:151], a[36:39], v[172:175], v[148:151]
  ds_read_b128 v[40:43], v13 offset:5632
  v_mfma_f32_16x16x32_bf16 v[152:155], a[40:43], v[172:175], v[152:155]
  buffer_load_dwordx4 v33, s[20:23], s64 offen offset:0 lds
  s_add_u32 m0, s41, 136064
  s_mov_b32 s64, 1146880
  v_mfma_f32_16x16x32_bf16 v[156:159], a[44:47], v[172:175], v[156:159]
  s_waitcnt lgkmcnt(7)
  ds_read_b128 v[44:47], v13 offset:7680
  v_mfma_f32_16x16x32_bf16 v[64:67], a[0:3], v[36:39], v[64:67]
  s_waitcnt lgkmcnt(6)
  ds_read_b128 v[164:167], v13 offset:9728
  v_mfma_f32_16x16x32_bf16 v[68:71], a[4:7], v[36:39], v[68:71]
  s_waitcnt lgkmcnt(5)
  ds_read_b128 v[168:171], v13 offset:11776
  v_mfma_f32_16x16x32_bf16 v[72:75], a[8:11], v[36:39], v[72:75]
  s_waitcnt lgkmcnt(4)
  buffer_load_dwordx4 v10, s[12:15], s36 offen offset:640 lds
  s_add_u32 m0, s76, 26112
  v_mfma_f32_16x16x32_bf16 v[76:79], a[12:15], v[36:39], v[76:79]
  s_waitcnt lgkmcnt(3)
  ds_read_b128 v[172:175], v13 offset:13824
  v_mfma_f32_16x16x32_bf16 v[80:83], a[0:3], v[40:43], v[80:83]
  ds_read_b128 v[36:39], v14 offset:3584
  v_mfma_f32_16x16x32_bf16 v[84:87], a[4:7], v[40:43], v[84:87]
  v_mfma_f32_16x16x32_bf16 v[88:91], a[8:11], v[40:43], v[88:91]
  s_waitcnt vmcnt(11)
  s_barrier
  ds_read_b64_tr_b16 a[16:17], v17 offset:16384
  v_mfma_f32_16x16x32_bf16 v[92:95], a[12:15], v[40:43], v[92:95]
  s_waitcnt lgkmcnt(5)
  ds_read_b64_tr_b16 a[18:19], v17 offset:17408
  v_mfma_f32_16x16x32_bf16 v[96:99], a[0:3], v[44:47], v[96:99]
  buffer_load_dwordx4 v12, s[68:71], 0 offen lds
  s_add_u32 m0, s76, 27136
  v_mfma_f32_16x16x32_bf16 v[100:103], a[4:7], v[44:47], v[100:103]
  ds_read_b64_tr_b16 a[20:21], v18 offset:16384
  v_add_u32 v12, s72, v11
  s_add_u32 s72, s72, s75
  s_cmp_eq_u32 s72, s73
  s_cselect_b32 s72, s74, s72
  v_mfma_f32_16x16x32_bf16 v[104:107], a[8:11], v[44:47], v[104:107]
  ds_read_b64_tr_b16 a[22:23], v18 offset:17408
  v_mfma_f32_16x16x32_bf16 v[108:111], a[12:15], v[44:47], v[108:111]
  s_waitcnt lgkmcnt(7)
  ds_read_b64_tr_b16 a[24:25], v17 offset:24576
  v_mfma_f32_16x16x32_bf16 v[112:115], a[0:3], v[164:167], v[112:115]
  ds_read_b64_tr_b16 a[26:27], v17 offset:25600
  v_mfma_f32_16x16x32_bf16 v[116:119], a[4:7], v[164:167], v[116:119]
  ds_read_b64_tr_b16 a[28:29], v18 offset:24576
  v_mfma_f32_16x16x32_bf16 v[120:123], a[8:11], v[164:167], v[120:123]
  buffer_load_dwordx4 v9, s[68:71], 0 offen lds
  s_add_u32 m0, s41, 71168
  v_mfma_f32_16x16x32_bf16 v[124:127], a[12:15], v[164:167], v[124:127]
  s_waitcnt lgkmcnt(9)
  ds_read_b64_tr_b16 a[30:31], v18 offset:25600
  v_add_u32 v9, 7168, v12
  v_mfma_f32_16x16x32_bf16 v[128:131], a[0:3], v[168:171], v[128:131]
  ds_read_b128 v[40:43], v14 offset:5632
  v_mfma_f32_16x16x32_bf16 v[132:135], a[4:7], v[168:171], v[132:135]
  ds_read_b128 v[44:47], v14 offset:7680
  v_mfma_f32_16x16x32_bf16 v[136:139], a[8:11], v[168:171], v[136:139]
  ds_read_b128 v[164:167], v14 offset:9728
  v_mfma_f32_16x16x32_bf16 v[140:143], a[12:15], v[168:171], v[140:143]
  s_waitcnt lgkmcnt(12)
  buffer_load_dwordx4 v32, s[16:19], s64 offen offset:0 lds
  s_add_u32 m0, s41, 79360
  v_mfma_f32_16x16x32_bf16 v[144:147], a[0:3], v[172:175], v[144:147]
  ds_read_b128 v[168:171], v14 offset:11776
  v_mfma_f32_16x16x32_bf16 v[148:151], a[4:7], v[172:175], v[148:151]
  v_mfma_f32_16x16x32_bf16 v[152:155], a[8:11], v[172:175], v[152:155]
  v_mfma_f32_16x16x32_bf16 v[156:159], a[12:15], v[172:175], v[156:159]
  s_waitcnt lgkmcnt(10)
  v_mfma_f32_16x16x32_bf16 v[64:67], a[16:19], v[36:39], v[64:67]
  s_waitcnt lgkmcnt(8)
  ds_read_b128 v[172:175], v14 offset:13824
  v_mfma_f32_16x16x32_bf16 v[68:71], a[20:23], v[36:39], v[68:71]
  s_waitcnt lgkmcnt(7)
  buffer_load_dwordx4 v32, s[20:23], s64 offen offset:0 lds
  s_add_u32 m0, s41, 87552
  v_mfma_f32_16x16x32_bf16 v[72:75], a[24:27], v[36:39], v[72:75]
  s_waitcnt lgkmcnt(5)
  v_mfma_f32_16x16x32_bf16 v[76:79], a[28:31], v[36:39], v[76:79]
  s_waitcnt lgkmcnt(4)
  v_mfma_f32_16x16x32_bf16 v[80:83], a[16:19], v[40:43], v[80:83]
  v_mfma_f32_16x16x32_bf16 v[84:87], a[20:23], v[40:43], v[84:87]
  v_mfma_f32_16x16x32_bf16 v[88:91], a[24:27], v[40:43], v[88:91]
  s_waitcnt vmcnt(10)
  s_barrier
  ds_read_b64_tr_b16 a[32:33], v17 offset:32768
  v_mfma_f32_16x16x32_bf16 v[92:95], a[28:31], v[40:43], v[92:95]
  s_waitcnt lgkmcnt(4)
  ds_read_b64_tr_b16 a[34:35], v17 offset:33792
  v_mfma_f32_16x16x32_bf16 v[96:99], a[16:19], v[44:47], v[96:99]
  ds_read_b128 v[36:39], v13 offset:48640
  v_mfma_f32_16x16x32_bf16 v[100:103], a[20:23], v[44:47], v[100:103]
  buffer_load_dwordx4 v33, s[16:19], s64 offen offset:0 lds
  s_add_u32 m0, s41, 95744
  v_mfma_f32_16x16x32_bf16 v[104:107], a[24:27], v[44:47], v[104:107]
  ds_read_b64_tr_b16 a[36:37], v18 offset:32768
  v_mfma_f32_16x16x32_bf16 v[108:111], a[28:31], v[44:47], v[108:111]
  s_waitcnt lgkmcnt(6)
  ds_read_b64_tr_b16 a[38:39], v18 offset:33792
  v_mfma_f32_16x16x32_bf16 v[112:115], a[16:19], v[164:167], v[112:115]
  ds_read_b64_tr_b16 a[40:41], v17 offset:40960
  v_mfma_f32_16x16x32_bf16 v[116:119], a[20:23], v[164:167], v[116:119]
  ds_read_b64_tr_b16 a[42:43], v17 offset:41984
  v_mfma_f32_16x16x32_bf16 v[120:123], a[24:27], v[164:167], v[120:123]
  ds_read_b64_tr_b16 a[44:45], v18 offset:40960
  v_mfma_f32_16x16x32_bf16 v[124:127], a[28:31], v[164:167], v[124:127]
  s_waitcnt lgkmcnt(9)
  ds_read_b64_tr_b16 a[46:47], v18 offset:41984
  v_mfma_f32_16x16x32_bf16 v[128:131], a[16:19], v[168:171], v[128:131]
  ds_read_b128 v[40:43], v13 offset:50688
  v_mfma_f32_16x16x32_bf16 v[132:135], a[20:23], v[168:171], v[132:135]
  ds_read_b128 v[44:47], v13 offset:52736
  v_mfma_f32_16x16x32_bf16 v[136:139], a[24:27], v[168:171], v[136:139]
  ds_read_b128 v[164:167], v13 offset:54784
  v_mfma_f32_16x16x32_bf16 v[140:143], a[28:31], v[168:171], v[140:143]
  s_waitcnt lgkmcnt(12)
  v_mfma_f32_16x16x32_bf16 v[144:147], a[16:19], v[172:175], v[144:147]
  ds_read_b128 v[168:171], v13 offset:56832
  v_mfma_f32_16x16x32_bf16 v[148:151], a[20:23], v[172:175], v[148:151]
  buffer_load_dwordx4 v33, s[20:23], s64 offen offset:0 lds
  s_mov_b32 s64, 1376256
  s_add_u32 m0, s41, 103936
  v_mfma_f32_16x16x32_bf16 v[152:155], a[24:27], v[172:175], v[152:155]
  v_mfma_f32_16x16x32_bf16 v[156:159], a[28:31], v[172:175], v[156:159]
  s_waitcnt lgkmcnt(10)
  v_mfma_f32_16x16x32_bf16 v[64:67], a[32:35], v[36:39], v[64:67]
  s_waitcnt lgkmcnt(8)
  ds_read_b128 v[172:175], v13 offset:58880
  v_mfma_f32_16x16x32_bf16 v[68:71], a[36:39], v[36:39], v[68:71]
  s_waitcnt lgkmcnt(7)
  v_mfma_f32_16x16x32_bf16 v[72:75], a[40:43], v[36:39], v[72:75]
  s_waitcnt lgkmcnt(5)
  v_mfma_f32_16x16x32_bf16 v[76:79], a[44:47], v[36:39], v[76:79]
  s_waitcnt lgkmcnt(4)
  v_mfma_f32_16x16x32_bf16 v[80:83], a[32:35], v[40:43], v[80:83]
  ds_read_b128 v[36:39], v14 offset:48640
  v_mfma_f32_16x16x32_bf16 v[84:87], a[36:39], v[40:43], v[84:87]
  v_mfma_f32_16x16x32_bf16 v[88:91], a[40:43], v[40:43], v[88:91]
  s_waitcnt vmcnt(4)
  s_barrier
  ds_read_b64_tr_b16 a[0:1], v19 offset:22528
  v_mfma_f32_16x16x32_bf16 v[92:95], a[44:47], v[40:43], v[92:95]
  s_waitcnt lgkmcnt(5)
  ds_read_b64_tr_b16 a[2:3], v19 offset:23552
  v_mfma_f32_16x16x32_bf16 v[96:99], a[32:35], v[44:47], v[96:99]
  buffer_load_dwordx4 v32, s[16:19], s64 offen offset:0 lds
  s_add_u32 m0, s41, 112128
  v_mfma_f32_16x16x32_bf16 v[100:103], a[36:39], v[44:47], v[100:103]
  ds_read_b64_tr_b16 a[4:5], v20 offset:22528
  v_mfma_f32_16x16x32_bf16 v[104:107], a[40:43], v[44:47], v[104:107]
  ds_read_b64_tr_b16 a[6:7], v20 offset:23552
  v_mfma_f32_16x16x32_bf16 v[108:111], a[44:47], v[44:47], v[108:111]
  s_waitcnt lgkmcnt(7)
  ds_read_b64_tr_b16 a[8:9], v19 offset:30720
  v_mfma_f32_16x16x32_bf16 v[112:115], a[32:35], v[164:167], v[112:115]
  ds_read_b64_tr_b16 a[10:11], v19 offset:31744
  v_mfma_f32_16x16x32_bf16 v[116:119], a[36:39], v[164:167], v[116:119]
  ds_read_b64_tr_b16 a[12:13], v20 offset:30720
  v_mfma_f32_16x16x32_bf16 v[120:123], a[40:43], v[164:167], v[120:123]
  buffer_load_dwordx4 v32, s[20:23], s64 offen offset:0 lds
  s_add_u32 m0, s41, 2816
  v_mfma_f32_16x16x32_bf16 v[124:127], a[44:47], v[164:167], v[124:127]
  s_waitcnt lgkmcnt(9)
  ds_read_b64_tr_b16 a[14:15], v20 offset:31744
  v_mfma_f32_16x16x32_bf16 v[128:131], a[32:35], v[168:171], v[128:131]
  ds_read_b128 v[40:43], v14 offset:50688
  v_mfma_f32_16x16x32_bf16 v[132:135], a[36:39], v[168:171], v[132:135]
  ds_read_b64_tr_b16 a[48:49], v4 offset:0
  v_mfma_f32_16x16x32_bf16 v[136:139], a[40:43], v[168:171], v[136:139]
  ds_read_b64_tr_b16 a[50:51], v4 offset:2048
  v_mfma_f32_16x16x32_bf16 v[140:143], a[44:47], v[168:171], v[140:143]
  s_waitcnt lgkmcnt(12)
  buffer_load_dwordx4 v10, s[12:15], s34 offen offset:768 lds
  s_add_u32 m0, s41, 11008
  v_mfma_f32_16x16x32_bf16 v[144:147], a[32:35], v[172:175], v[144:147]
  ds_read_b64_tr_b16 a[52:53], v5 offset:0
  v_mfma_f32_16x16x32_bf16 v[148:151], a[36:39], v[172:175], v[148:151]
  ds_read_b64_tr_b16 a[54:55], v5 offset:2048
  v_mfma_f32_16x16x32_bf16 v[152:155], a[40:43], v[172:175], v[152:155]
  ds_read_b64_tr_b16 a[56:57], v6 offset:0
  v_mfma_f32_16x16x32_bf16 v[156:159], a[44:47], v[172:175], v[156:159]
  s_waitcnt lgkmcnt(12)
  ds_read_b64_tr_b16 a[58:59], v6 offset:2048
  v_mfma_f32_16x16x32_bf16 v[64:67], a[0:3], v[36:39], v[64:67]
  s_waitcnt lgkmcnt(11)
  ds_read_b64_tr_b16 a[60:61], v7 offset:0
  v_mfma_f32_16x16x32_bf16 v[68:71], a[4:7], v[36:39], v[68:71]
  s_waitcnt lgkmcnt(10)
  buffer_load_dwordx4 v10, s[12:15], s35 offen offset:768 lds
  s_add_u32 m0, s76, 26112
  v_mfma_f32_16x16x32_bf16 v[72:75], a[8:11], v[36:39], v[72:75]
  s_waitcnt lgkmcnt(8)
  ds_read_b64_tr_b16 a[62:63], v7 offset:2048
  v_mfma_f32_16x16x32_bf16 v[76:79], a[12:15], v[36:39], v[76:79]
  s_waitcnt lgkmcnt(8)
  ds_read_b128 v[44:47], v14 offset:52736
  v_mfma_f32_16x16x32_bf16 v[80:83], a[0:3], v[40:43], v[80:83]
  ds_read_b128 v[164:167], v14 offset:54784
  v_mfma_f32_16x16x32_bf16 v[84:87], a[4:7], v[40:43], v[84:87]
  ds_read_b128 v[168:171], v14 offset:56832
  v_mfma_f32_16x16x32_bf16 v[88:91], a[8:11], v[40:43], v[88:91]
  s_waitcnt vmcnt(6) lgkmcnt(3)
  s_barrier
  ds_read_b128 v[172:175], v14 offset:58880
  v_mfma_f32_16x16x32_bf16 v[92:95], a[12:15], v[40:43], v[92:95]
  s_waitcnt lgkmcnt(3)
  ds_read_b64_tr_b16 a[16:17], v17 offset:0
  v_mfma_f32_16x16x32_bf16 v[96:99], a[0:3], v[44:47], v[96:99]
  buffer_load_dwordx4 v12, s[68:71], 0 offen lds
  s_add_u32 m0, s76, 27136
  v_mfma_f32_16x16x32_bf16 v[100:103], a[4:7], v[44:47], v[100:103]
  ds_read_b64_tr_b16 a[18:19], v17 offset:1024
  v_add_u32 v12, s72, v11
  s_add_u32 s72, s72, s75
  s_cmp_eq_u32 s72, s73
  s_cselect_b32 s72, s74, s72
  v_mfma_f32_16x16x32_bf16 v[104:107], a[8:11], v[44:47], v[104:107]
  ds_read_b128 v[36:39], v21 offset:54784
  v_mfma_f32_16x16x32_bf16 v[108:111], a[12:15], v[44:47], v[108:111]
  s_waitcnt lgkmcnt(5)
  ds_read_b64_tr_b16 a[20:21], v18 offset:0
  v_mfma_f32_16x16x32_bf16 v[112:115], a[0:3], v[164:167], v[112:115]
  buffer_load_dwordx4 v9, s[68:71], 0 offen lds
  s_add_u32 m0, s41, 19200
  v_mfma_f32_16x16x32_bf16 v[116:119], a[4:7], v[164:167], v[116:119]
  ds_read_b64_tr_b16 a[22:23], v18 offset:1024
  v_add_u32 v9, 7168, v12
  v_mfma_f32_16x16x32_bf16 v[120:123], a[8:11], v[164:167], v[120:123]
  ds_read_b64_tr_b16 a[24:25], v17 offset:8192
  v_mfma_f32_16x16x32_bf16 v[124:127], a[12:15], v[164:167], v[124:127]
  s_waitcnt lgkmcnt(7)
  ds_read_b64_tr_b16 a[26:27], v17 offset:9216
  v_mfma_f32_16x16x32_bf16 v[128:131], a[0:3], v[168:171], v[128:131]
  buffer_load_dwordx4 v10, s[12:15], s36 offen offset:768 lds
  s_add_u32 m0, s41, 142848
  v_mfma_f32_16x16x32_bf16 v[132:135], a[4:7], v[168:171], v[132:135]
  ds_read_b64_tr_b16 a[28:29], v18 offset:8192
  v_mfma_f32_16x16x32_bf16 v[136:139], a[8:11], v[168:171], v[136:139]
  ds_read_b64_tr_b16 a[30:31], v18 offset:9216
  v_mfma_f32_16x16x32_bf16 v[140:143], a[12:15], v[168:171], v[140:143]
  s_waitcnt lgkmcnt(9)
  ds_read_b128 v[40:43], v21 offset:56832
  v_mfma_f32_16x16x32_bf16 v[144:147], a[0:3], v[172:175], v[144:147]
  buffer_load_dwordx4 v33, s[16:19], s64 offen offset:0 lds
  s_add_u32 m0, s41, 151040
  v_mfma_f32_16x16x32_bf16 v[148:151], a[4:7], v[172:175], v[148:151]
  ds_read_b128 v[44:47], v21 offset:58880
  v_mfma_f32_16x16x32_bf16 v[152:155], a[8:11], v[172:175], v[152:155]
  ds_read_b128 v[164:167], v21 offset:60928
  v_mfma_f32_16x16x32_bf16 v[156:159], a[12:15], v[172:175], v[156:159]
  s_waitcnt lgkmcnt(9)
  ds_read_b128 v[168:171], v21 offset:62976
  v_mfma_f32_16x16x32_bf16 v[64:67], a[16:19], v[36:39], v[64:67]
  s_waitcnt lgkmcnt(8)
  buffer_load_dwordx4 v33, s[20:23], s64 offen offset:0 lds
  s_add_u32 m0, s76, 42496
  v_mfma_f32_16x16x32_bf16 v[68:71], a[20:23], v[36:39], v[68:71]
  s_waitcnt lgkmcnt(6)
  ds_read_b128 v[172:175], v21 offset:65024
  v_mfma_f32_16x16x32_bf16 v[72:75], a[24:27], v[36:39], v[72:75]
  s_waitcnt lgkmcnt(5)
  v_mfma_f32_16x16x32_bf16 v[76:79], a[28:31], v[36:39], v[76:79]
  s_waitcnt lgkmcnt(4)
  v_mfma_f32_16x16x32_bf16 v[80:83], a[16:19], v[40:43], v[80:83]
  s_waitcnt vmcnt(9)
  s_barrier
  ds_read_b64_tr_b16 a[32:33], v17 offset:16384
  v_mfma_f32_16x16x32_bf16 v[84:87], a[20:23], v[40:43], v[84:87]
  buffer_load_dwordx4 v12, s[68:71], 0 offen lds
  s_add_u32 m0, s76, 43520
  v_mfma_f32_16x16x32_bf16 v[88:91], a[24:27], v[40:43], v[88:91]
  v_add_u32 v12, s72, v11
  s_add_u32 s72, s72, s75
  s_cmp_eq_u32 s72, s73
  s_cselect_b32 s72, s74, s72
  v_mfma_f32_16x16x32_bf16 v[92:95], a[28:31], v[40:43], v[92:95]
  s_waitcnt lgkmcnt(4)
  ds_read_b64_tr_b16 a[40:41], v17 offset:24576
  v_mfma_f32_16x16x32_bf16 v[96:99], a[16:19], v[44:47], v[96:99]
  ds_read_b64_tr_b16 a[34:35], v17 offset:17408
  v_mfma_f32_16x16x32_bf16 v[100:103], a[20:23], v[44:47], v[100:103]
  buffer_load_dwordx4 v9, s[68:71], 0 offen lds
  s_add_u32 m0, s76, 58880
  v_mfma_f32_16x16x32_bf16 v[104:107], a[24:27], v[44:47], v[104:107]
  v_add_u32 v9, 7168, v12
  v_mfma_f32_16x16x32_bf16 v[108:111], a[28:31], v[44:47], v[108:111]
  s_waitcnt lgkmcnt(5)
  ds_read_b64_tr_b16 a[42:43], v17 offset:25600
  v_mfma_f32_16x16x32_bf16 v[112:115], a[16:19], v[164:167], v[112:115]
  ds_read_b64_tr_b16 a[36:37], v18 offset:16384
  v_mfma_f32_16x16x32_bf16 v[116:119], a[20:23], v[164:167], v[116:119]
  buffer_load_dwordx4 v12, s[68:71], 0 offen lds
  s_add_u32 m0, s76, 59904
  v_mfma_f32_16x16x32_bf16 v[120:123], a[24:27], v[164:167], v[120:123]
  ds_read_b64_tr_b16 a[44:45], v18 offset:24576
  v_add_u32 v12, s72, v11
  s_add_u32 s72, s72, s75
  s_cmp_eq_u32 s72, s73
  s_cselect_b32 s72, s74, s72
  v_mfma_f32_16x16x32_bf16 v[124:127], a[28:31], v[164:167], v[124:127]
  s_waitcnt lgkmcnt(7)
  ds_read_b64_tr_b16 a[38:39], v18 offset:17408
  v_mfma_f32_16x16x32_bf16 v[128:131], a[16:19], v[168:171], v[128:131]
  ds_read_b64_tr_b16 a[46:47], v18 offset:25600
  v_mfma_f32_16x16x32_bf16 v[132:135], a[20:23], v[168:171], v[132:135]
  buffer_load_dwordx4 v9, s[68:71], 0 offen lds
  s_add_u32 m0, s76, 75264
  v_mfma_f32_16x16x32_bf16 v[136:139], a[24:27], v[168:171], v[136:139]
  ds_read_b128 v[36:39], v22 offset:54784
  v_add_u32 v9, 7168, v12
  v_mfma_f32_16x16x32_bf16 v[140:143], a[28:31], v[168:171], v[140:143]
  s_waitcnt lgkmcnt(9)
  ds_read_b128 v[40:43], v22 offset:56832
  v_mfma_f32_16x16x32_bf16 v[144:147], a[16:19], v[172:175], v[144:147]
  ds_read_b128 v[44:47], v22 offset:58880
  v_mfma_f32_16x16x32_bf16 v[148:151], a[20:23], v[172:175], v[148:151]
  s_waitcnt vmcnt(6) lgkmcnt(3)
  s_barrier
  ds_read_b128 v[164:167], v22 offset:60928
  v_mfma_f32_16x16x32_bf16 v[152:155], a[24:27], v[172:175], v[152:155]
  ds_read_b64_tr_b16 a[64:65], v4 offset:0
  v_mfma_f32_16x16x32_bf16 v[156:159], a[28:31], v[172:175], v[156:159]
  s_waitcnt lgkmcnt(4)
  buffer_load_dwordx4 v12, s[68:71], 0 offen lds
  s_add_u32 m0, s76, 76288
  v_mfma_f32_16x16x32_bf16 v[64:67], a[32:35], v[36:39], v[64:67]
  ds_read_b64_tr_b16 a[66:67], v4 offset:2048
  v_add_u32 v12, s72, v11
  s_add_u32 s72, s72, s75
  s_cmp_eq_u32 s72, s73
  s_cselect_b32 s72, s74, s72
  v_mfma_f32_16x16x32_bf16 v[68:71], a[36:39], v[36:39], v[68:71]
  ds_read_b64_tr_b16 a[68:69], v5 offset:0
  v_mfma_f32_16x16x32_bf16 v[72:75], a[40:43], v[36:39], v[72:75]
  ds_read_b64_tr_b16 a[70:71], v5 offset:2048
  v_mfma_f32_16x16x32_bf16 v[76:79], a[44:47], v[36:39], v[76:79]
  s_waitcnt lgkmcnt(6)
  ds_read_b64_tr_b16 a[72:73], v6 offset:0
  v_mfma_f32_16x16x32_bf16 v[80:83], a[32:35], v[40:43], v[80:83]
  ds_read_b64_tr_b16 a[0:1], v17 offset:32768
  v_mfma_f32_16x16x32_bf16 v[84:87], a[36:39], v[40:43], v[84:87]
  ds_read_b64_tr_b16 a[8:9], v17 offset:40960
  v_mfma_f32_16x16x32_bf16 v[88:91], a[40:43], v[40:43], v[88:91]
  ds_read_b64_tr_b16 a[74:75], v6 offset:2048
  v_mfma_f32_16x16x32_bf16 v[92:95], a[44:47], v[40:43], v[92:95]
  s_waitcnt lgkmcnt(9)
  buffer_load_dwordx4 v9, s[68:71], 0 offen lds
  s_add_u32 m0, s76, 91648
  v_mfma_f32_16x16x32_bf16 v[96:99], a[32:35], v[44:47], v[96:99]
  ds_read_b64_tr_b16 a[2:3], v17 offset:33792
  v_add_u32 v9, 7168, v12
  v_mfma_f32_16x16x32_bf16 v[100:103], a[36:39], v[44:47], v[100:103]
  ds_read_b64_tr_b16 a[10:11], v17 offset:41984
  v_mfma_f32_16x16x32_bf16 v[104:107], a[40:43], v[44:47], v[104:107]
  ds_read_b64_tr_b16 a[76:77], v7 offset:0
  v_mfma_f32_16x16x32_bf16 v[108:111], a[44:47], v[44:47], v[108:111]
  s_waitcnt lgkmcnt(11)
  ds_read_b64_tr_b16 a[4:5], v18 offset:32768
  v_mfma_f32_16x16x32_bf16 v[112:115], a[32:35], v[164:167], v[112:115]
  ds_read_b64_tr_b16 a[12:13], v18 offset:40960
  v_mfma_f32_16x16x32_bf16 v[116:119], a[36:39], v[164:167], v[116:119]
  ds_read_b128 v[168:171], v22 offset:62976
  ds_read_b64_tr_b16 a[78:79], v7 offset:2048
  ds_read_b64_tr_b16 a[6:7], v18 offset:33792
  ds_read_b64_tr_b16 a[14:15], v18 offset:41984
  v_mfma_f32_16x16x32_bf16 v[120:123], a[40:43], v[164:167], v[120:123]
  ds_read_b128 v[172:175], v22 offset:65024
  v_mfma_f32_16x16x32_bf16 v[124:127], a[44:47], v[164:167], v[124:127]
  ds_read_b128 v[36:39], v13 offset:3584
  ds_read_b128 v[40:43], v14 offset:3584
  ds_read_b128 v[44:47], v13 offset:5632
  ds_read_b128 v[164:167], v14 offset:5632
  s_waitcnt lgkmcnt(8)
  v_mfma_f32_16x16x32_bf16 v[128:131], a[32:35], v[168:171], v[128:131]
  v_mfma_f32_16x16x32_bf16 v[132:135], a[36:39], v[168:171], v[132:135]
  s_waitcnt vmcnt(6) lgkmcnt(5)
  s_barrier
  buffer_load_dwordx4 v12, s[68:71], 0 offen lds
  s_add_u32 m0, s76, 92672
  v_mfma_f32_16x16x32_bf16 v[136:139], a[40:43], v[168:171], v[136:139]
  ds_read_b64_tr_b16 a[16:17], v19 offset:22528
  v_add_u32 v12, s72, v11
  s_add_u32 s72, s72, s75
  s_cmp_eq_u32 s72, s73
  s_cselect_b32 s72, s74, s72
  v_mfma_f32_16x16x32_bf16 v[140:143], a[44:47], v[168:171], v[140:143]
  s_waitcnt lgkmcnt(5)
  ds_read_b64_tr_b16 a[18:19], v19 offset:23552
  v_mfma_f32_16x16x32_bf16 v[144:147], a[32:35], v[172:175], v[144:147]
  ds_read_b64_tr_b16 a[20:21], v20 offset:22528
  v_mfma_f32_16x16x32_bf16 v[148:151], a[36:39], v[172:175], v[148:151]
  buffer_load_dwordx4 v9, s[68:71], 0 offen lds
  s_add_u32 m0, s76, 26112
  v_mfma_f32_16x16x32_bf16 v[152:155], a[40:43], v[172:175], v[152:155]
  ds_read_b64_tr_b16 a[22:23], v20 offset:23552
  v_add_u32 v9, 7168, v12
  v_mfma_f32_16x16x32_bf16 v[156:159], a[44:47], v[172:175], v[156:159]
  s_waitcnt lgkmcnt(7)
  ds_read_b64_tr_b16 a[24:25], v19 offset:30720
  v_mfma_f32_16x16x32_bf16 v[64:67], a[0:3], v[36:39], v[64:67]
  ds_read_b64_tr_b16 a[26:27], v19 offset:31744
  v_mfma_f32_16x16x32_bf16 v[68:71], a[4:7], v[36:39], v[68:71]
  ds_read_b64_tr_b16 a[28:29], v20 offset:30720
  v_mfma_f32_16x16x32_bf16 v[72:75], a[8:11], v[36:39], v[72:75]
  buffer_load_dwordx4 v12, s[68:71], 0 offen lds
  s_add_u32 m0, s76, 27136
  v_mfma_f32_16x16x32_bf16 v[76:79], a[12:15], v[36:39], v[76:79]
  s_waitcnt lgkmcnt(5)
  ds_read_b64_tr_b16 a[30:31], v20 offset:31744
  v_add_u32 v12, s72, v11
  s_add_u32 s72, s72, s75
  s_cmp_eq_u32 s72, s73
  s_cselect_b32 s72, s74, s72
  v_mfma_f32_16x16x32_bf16 v[64:67], a[16:19], v[40:43], v[64:67]
  s_waitcnt lgkmcnt(4)
  ds_read_b128 v[168:171], v13 offset:7680
  v_mfma_f32_16x16x32_bf16 v[68:71], a[20:23], v[40:43], v[68:71]
  s_waitcnt lgkmcnt(3)
  ds_read_b128 v[172:175], v14 offset:7680
  v_mfma_f32_16x16x32_bf16 v[72:75], a[24:27], v[40:43], v[72:75]
  s_waitcnt lgkmcnt(2)
  ds_read_b128 v[36:39], v13 offset:9728
  v_mfma_f32_16x16x32_bf16 v[76:79], a[28:31], v[40:43], v[76:79]
  v_mfma_f32_16x16x32_bf16 v[80:83], a[0:3], v[44:47], v[80:83]
  buffer_load_dwordx4 v9, s[68:71], 0 offen lds
  s_add_u32 m0, s76, 108032
  v_mfma_f32_16x16x32_bf16 v[84:87], a[4:7], v[44:47], v[84:87]
  v_add_u32 v9, 7168, v12
  v_mfma_f32_16x16x32_bf16 v[88:91], a[8:11], v[44:47], v[88:91]
  ds_read_b128 v[40:43], v14 offset:9728
  v_mfma_f32_16x16x32_bf16 v[92:95], a[12:15], v[44:47], v[92:95]
  v_mfma_f32_16x16x32_bf16 v[80:83], a[16:19], v[164:167], v[80:83]
  s_barrier
  ds_read_b128 v[48:51], v34 offset:0
  v_mfma_f32_16x16x32_bf16 v[84:87], a[20:23], v[164:167], v[84:87]
  ds_read_b128 v[52:55], v34 offset:16
  v_mfma_f32_16x16x32_bf16 v[88:91], a[24:27], v[164:167], v[88:91]
  ds_read_b128 v[56:59], v34 offset:32
  ds_read_b128 v[60:63], v34 offset:48
  buffer_load_dwordx4 v12, s[68:71], 0 offen lds
  v_mfma_f32_16x16x32_bf16 v[92:95], a[28:31], v[164:167], v[92:95]
  ds_read_b64 v[160:161], v27 offset:0
  s_add_u32 m0, s76, 109056
  v_add_u32 v12, s72, v11
  s_add_u32 s72, s72, s75
  s_cmp_eq_u32 s72, s73
  s_cselect_b32 s72, s74, s72
  s_waitcnt lgkmcnt(8)
  v_mfma_f32_16x16x32_bf16 v[96:99], a[0:3], v[168:171], v[96:99]
  ds_read_b64 v[162:163], v27 offset:128
  buffer_load_dwordx4 v9, s[68:71], 0 offen lds
  v_mfma_f32_16x16x32_bf16 v[100:103], a[4:7], v[168:171], v[100:103]
  s_add_u32 m0, s76, 124416
  ds_read_b64 v[24:25], v27 offset:256
  v_add_u32 v9, 7168, v12
  v_mfma_f32_16x16x32_bf16 v[104:107], a[8:11], v[168:171], v[104:107]
  ds_read_b64 v[28:29], v27 offset:384
  buffer_load_dwordx4 v12, s[68:71], 0 offen lds
  v_mfma_f32_16x16x32_bf16 v[108:111], a[12:15], v[168:171], v[108:111]
  s_waitcnt lgkmcnt(3)
  ds_read_b64 v[30:31], v27 offset:512
  s_add_u32 m0, s76, 125440
  v_add_u32 v12, s72, v11
  v_fmac_f32 v64, v48, v160
  v_fmac_f32 v65, v49, v160
  v_mfma_f32_16x16x32_bf16 v[96:99], a[16:19], v[172:175], v[96:99]
  ds_read_b64 v[4:5], v27 offset:640
  v_fmac_f32 v66, v50, v160
  v_fmac_f32 v67, v51, v160
  v_fmac_f32 v68, v52, v160
  v_fmac_f32 v69, v53, v160
  buffer_load_dwordx4 v9, s[68:71], 0 offen lds
  v_mfma_f32_16x16x32_bf16 v[100:103], a[20:23], v[172:175], v[100:103]
  s_add_u32 m0, s76, 140800
  s_nop 0
  buffer_load_dwordx4 v12, s[68:71], 0 offen lds
  v_add_u32 v9, 7168, v12
  s_add_u32 m0, s76, 141824
  v_fmac_f32 v70, v54, v160
  v_fmac_f32 v71, v55, v160
  v_mfma_f32_16x16x32_bf16 v[104:107], a[24:27], v[172:175], v[104:107]
  ds_read_b128 v[44:47], v13 offset:11776
  v_fmac_f32 v72, v56, v160
  v_fmac_f32 v73, v57, v160
  v_fmac_f32 v74, v58, v160
  v_fmac_f32 v75, v59, v160
  v_mfma_f32_16x16x32_bf16 v[108:111], a[28:31], v[172:175], v[108:111]
  buffer_load_dwordx4 v9, s[68:71], 0 offen lds
  v_fmac_f32 v76, v60, v160
  v_fmac_f32 v77, v61, v160
  v_fmac_f32 v78, v62, v160
  v_fmac_f32 v79, v63, v160
  v_mfma_f32_16x16x32_bf16 v[112:115], a[0:3], v[36:39], v[112:115]
  ds_read_b128 v[164:167], v14 offset:11776
  v_mul_f32 v64, v64, v72
  v_mul_f32 v65, v65, v73
  v_mul_f32 v66, v66, v74
  v_mul_f32 v67, v67, v75
  v_mfma_f32_16x16x32_bf16 v[116:119], a[4:7], v[36:39], v[116:119]
  ds_read_b128 v[168:171], v13 offset:13824
  v_mul_f32 v68, v68, v76
  v_mul_f32 v69, v69, v77
  v_mul_f32 v70, v70, v78
  v_mul_f32 v71, v71, v79
  v_mfma_f32_16x16x32_bf16 v[120:123], a[8:11], v[36:39], v[120:123]
  ds_read_b128 v[172:175], v14 offset:13824
  v_mul_f32 v64, v64, v161
  v_mul_f32 v65, v65, v161
  v_mul_f32 v66, v66, v161
  v_mul_f32 v67, v67, v161
  v_mfma_f32_16x16x32_bf16 v[124:127], a[12:15], v[36:39], v[124:127]
  v_mul_f32 v68, v68, v161
  v_mul_f32 v69, v69, v161
  v_mul_f32 v70, v70, v161
  v_mul_f32 v71, v71, v161
  v_cvt_pk_bf16_f32 v72, v64, v65
  v_mfma_f32_16x16x32_bf16 v[112:115], a[16:19], v[40:43], v[112:115]
  s_waitcnt lgkmcnt(8)
  v_cvt_pk_bf16_f32 v73, v66, v67
  v_cvt_pk_bf16_f32 v74, v68, v69
  v_cvt_pk_bf16_f32 v75, v70, v71
  v_fmac_f32 v80, v48, v162
  v_fmac_f32 v81, v49, v162
  v_mfma_f32_16x16x32_bf16 v[116:119], a[20:23], v[40:43], v[116:119]
  buffer_store_dwordx4 v[72:75], v23, s[24:27], s46 offen offset:0 sc1
  v_fmac_f32 v82, v50, v162
  v_fmac_f32 v83, v51, v162
  v_fmac_f32 v84, v52, v162
  v_fmac_f32 v85, v53, v162
  v_mfma_f32_16x16x32_bf16 v[120:123], a[24:27], v[40:43], v[120:123]
  v_fmac_f32 v86, v54, v162
  v_fmac_f32 v87, v55, v162
  v_fmac_f32 v88, v56, v162
  v_fmac_f32 v89, v57, v162
  v_fmac_f32 v90, v58, v162
  v_mfma_f32_16x16x32_bf16 v[124:127], a[28:31], v[40:43], v[124:127]
  v_fmac_f32 v91, v59, v162
  v_fmac_f32 v92, v60, v162
  v_fmac_f32 v93, v61, v162
  v_fmac_f32 v94, v62, v162
  v_fmac_f32 v95, v63, v162
  s_waitcnt lgkmcnt(3)
  v_mfma_f32_16x16x32_bf16 v[128:131], a[0:3], v[44:47], v[128:131]
  v_mul_f32 v80, v80, v88
  v_mul_f32 v81, v81, v89
  v_mul_f32 v82, v82, v90
  v_mul_f32 v83, v83, v91
  v_mul_f32 v84, v84, v92
  v_mfma_f32_16x16x32_bf16 v[132:135], a[4:7], v[44:47], v[132:135]
  v_mul_f32 v85, v85, v93
  v_mul_f32 v86, v86, v94
  v_mul_f32 v87, v87, v95
  v_mul_f32 v80, v80, v163
  v_mul_f32 v81, v81, v163
  v_mfma_f32_16x16x32_bf16 v[136:139], a[8:11], v[44:47], v[136:139]
  v_mul_f32 v82, v82, v163
  v_mul_f32 v83, v83, v163
  v_mul_f32 v84, v84, v163
  v_mul_f32 v85, v85, v163
  v_mul_f32 v86, v86, v163
  v_mfma_f32_16x16x32_bf16 v[140:143], a[12:15], v[44:47], v[140:143]
  v_mul_f32 v87, v87, v163
  v_cvt_pk_bf16_f32 v88, v80, v81
  v_cvt_pk_bf16_f32 v89, v82, v83
  v_cvt_pk_bf16_f32 v90, v84, v85
  v_cvt_pk_bf16_f32 v91, v86, v87
  s_waitcnt lgkmcnt(2)
  v_mfma_f32_16x16x32_bf16 v[128:131], a[16:19], v[164:167], v[128:131]
  buffer_store_dwordx4 v[88:91], v23, s[24:27], s46 offen offset:256 sc1
  v_fmac_f32 v96, v48, v24
  v_fmac_f32 v97, v49, v24
  v_fmac_f32 v98, v50, v24
  v_fmac_f32 v99, v51, v24
  v_mfma_f32_16x16x32_bf16 v[132:135], a[20:23], v[164:167], v[132:135]
  v_fmac_f32 v100, v52, v24
  v_fmac_f32 v101, v53, v24
  v_fmac_f32 v102, v54, v24
  v_fmac_f32 v103, v55, v24
  v_fmac_f32 v104, v56, v24
  v_mfma_f32_16x16x32_bf16 v[136:139], a[24:27], v[164:167], v[136:139]
  v_fmac_f32 v105, v57, v24
  v_fmac_f32 v106, v58, v24
  v_fmac_f32 v107, v59, v24
  v_fmac_f32 v108, v60, v24
  v_fmac_f32 v109, v61, v24
  v_mfma_f32_16x16x32_bf16 v[140:143], a[28:31], v[164:167], v[140:143]
  v_fmac_f32 v110, v62, v24
  v_fmac_f32 v111, v63, v24
  v_mul_f32 v96, v96, v104
  v_mul_f32 v97, v97, v105
  v_mul_f32 v98, v98, v106
  s_waitcnt lgkmcnt(1)
  v_mfma_f32_16x16x32_bf16 v[144:147], a[0:3], v[168:171], v[144:147]
  v_mul_f32 v99, v99, v107
  v_mul_f32 v100, v100, v108
  v_mul_f32 v101, v101, v109
  v_mul_f32 v102, v102, v110
  v_mul_f32 v103, v103, v111
  v_mfma_f32_16x16x32_bf16 v[148:151], a[4:7], v[168:171], v[148:151]
  v_mul_f32 v96, v96, v25
  v_mul_f32 v97, v97, v25
  v_mul_f32 v98, v98, v25
  v_mul_f32 v99, v99, v25
  v_mul_f32 v100, v100, v25
  v_mfma_f32_16x16x32_bf16 v[152:155], a[8:11], v[168:171], v[152:155]
  v_mul_f32 v101, v101, v25
  v_mul_f32 v102, v102, v25
  v_mul_f32 v103, v103, v25
  v_cvt_pk_bf16_f32 v104, v96, v97
  v_cvt_pk_bf16_f32 v105, v98, v99
  v_mfma_f32_16x16x32_bf16 v[156:159], a[12:15], v[168:171], v[156:159]
  v_cvt_pk_bf16_f32 v106, v100, v101
  v_cvt_pk_bf16_f32 v107, v102, v103
  v_fmac_f32 v112, v48, v28
  v_fmac_f32 v113, v49, v28
  v_fmac_f32 v114, v50, v28
  s_waitcnt lgkmcnt(0)
  v_mfma_f32_16x16x32_bf16 v[144:147], a[16:19], v[172:175], v[144:147]
  buffer_store_dwordx4 v[104:107], v23, s[24:27], s46 offen offset:512 sc1
  v_fmac_f32 v115, v51, v28
  v_fmac_f32 v116, v52, v28
  v_fmac_f32 v117, v53, v28
  v_fmac_f32 v118, v54, v28
  v_mfma_f32_16x16x32_bf16 v[148:151], a[20:23], v[172:175], v[148:151]
  v_fmac_f32 v119, v55, v28
  v_fmac_f32 v120, v56, v28
  v_fmac_f32 v121, v57, v28
  v_fmac_f32 v122, v58, v28
  v_fmac_f32 v123, v59, v28
  v_mfma_f32_16x16x32_bf16 v[152:155], a[24:27], v[172:175], v[152:155]
  v_fmac_f32 v124, v60, v28
  v_fmac_f32 v125, v61, v28
  v_fmac_f32 v126, v62, v28
  v_fmac_f32 v127, v63, v28
  v_mul_f32 v112, v112, v120
  v_mfma_f32_16x16x32_bf16 v[156:159], a[28:31], v[172:175], v[156:159]
  v_mul_f32 v113, v113, v121
  v_mul_f32 v114, v114, v122
  v_mul_f32 v115, v115, v123
  v_mul_f32 v116, v116, v124
  v_mul_f32 v117, v117, v125
  v_mul_f32 v118, v118, v126
  v_mul_f32 v119, v119, v127
  v_mul_f32 v112, v112, v29
  v_mul_f32 v113, v113, v29
  v_mul_f32 v114, v114, v29
  v_mul_f32 v115, v115, v29
  v_mul_f32 v116, v116, v29
  v_mul_f32 v117, v117, v29
  v_mul_f32 v118, v118, v29
  v_mul_f32 v119, v119, v29
  v_cvt_pk_bf16_f32 v120, v112, v113
  v_cvt_pk_bf16_f32 v121, v114, v115
  v_cvt_pk_bf16_f32 v122, v116, v117
  v_cvt_pk_bf16_f32 v123, v118, v119
  buffer_store_dwordx4 v[120:123], v23, s[24:27], s46 offen offset:768 sc1
  v_fmac_f32 v128, v48, v30
  v_fmac_f32 v129, v49, v30
  v_fmac_f32 v130, v50, v30
  v_fmac_f32 v131, v51, v30
  v_fmac_f32 v132, v52, v30
  v_fmac_f32 v133, v53, v30
  v_fmac_f32 v134, v54, v30
  v_fmac_f32 v135, v55, v30
  v_fmac_f32 v136, v56, v30
  v_fmac_f32 v137, v57, v30
  v_fmac_f32 v138, v58, v30
  v_fmac_f32 v139, v59, v30
  v_fmac_f32 v140, v60, v30
  v_fmac_f32 v141, v61, v30
  v_fmac_f32 v142, v62, v30
  v_fmac_f32 v143, v63, v30
  v_mul_f32 v128, v128, v136
  v_mul_f32 v129, v129, v137
  v_mul_f32 v130, v130, v138
  v_mul_f32 v131, v131, v139
  v_mul_f32 v132, v132, v140
  v_mul_f32 v133, v133, v141
  v_mul_f32 v134, v134, v142
  v_mul_f32 v135, v135, v143
  v_mul_f32 v128, v128, v31
  v_mul_f32 v129, v129, v31
  v_mul_f32 v130, v130, v31
  v_mul_f32 v131, v131, v31
  v_mul_f32 v132, v132, v31
  v_mul_f32 v133, v133, v31
  v_mul_f32 v134, v134, v31
  v_mul_f32 v135, v135, v31
  v_cvt_pk_bf16_f32 v136, v128, v129
  v_cvt_pk_bf16_f32 v137, v130, v131
  v_cvt_pk_bf16_f32 v138, v132, v133
  v_cvt_pk_bf16_f32 v139, v134, v135
  buffer_store_dwordx4 v[136:139], v23, s[24:27], s46 offen offset:1024 sc1
  v_fmac_f32 v144, v48, v4
  v_fmac_f32 v145, v49, v4
  v_fmac_f32 v146, v50, v4
  v_fmac_f32 v147, v51, v4
  v_fmac_f32 v148, v52, v4
  v_fmac_f32 v149, v53, v4
  v_fmac_f32 v150, v54, v4
  v_fmac_f32 v151, v55, v4
  v_fmac_f32 v152, v56, v4
  v_fmac_f32 v153, v57, v4
  v_fmac_f32 v154, v58, v4
  v_fmac_f32 v155, v59, v4
  v_fmac_f32 v156, v60, v4
  v_fmac_f32 v157, v61, v4
  v_fmac_f32 v158, v62, v4
  v_fmac_f32 v159, v63, v4
  v_mul_f32 v144, v144, v152
  v_mul_f32 v145, v145, v153
  v_mul_f32 v146, v146, v154
  v_mul_f32 v147, v147, v155
  v_mul_f32 v148, v148, v156
  v_mul_f32 v149, v149, v157
  v_mul_f32 v150, v150, v158
  v_mul_f32 v151, v151, v159
  v_mul_f32 v144, v144, v5
  v_mul_f32 v145, v145, v5
  v_mul_f32 v146, v146, v5
  v_mul_f32 v147, v147, v5
  v_mul_f32 v148, v148, v5
  v_mul_f32 v149, v149, v5
  v_mul_f32 v150, v150, v5
  v_mul_f32 v151, v151, v5
  v_cvt_pk_bf16_f32 v152, v144, v145
  v_cvt_pk_bf16_f32 v153, v146, v147
  v_cvt_pk_bf16_f32 v154, v148, v149
  v_cvt_pk_bf16_f32 v155, v150, v151
  buffer_store_dwordx4 v[152:155], v23, s[24:27], s46 offen offset:1280 sc1
  s_waitcnt vmcnt(14)
  s_add_u32 s72, s72, s75
  s_cmp_eq_u32 s72, s73
  s_cselect_b32 s72, s74, s72
  s_branch L_s2
L_ffn1:
  v_mov_b32 v60, 0x40000000
  s_lshl_b32 s37, s2, 3
  s_add_u32 s37, s37, s30
  s_mul_i32 s58, s37, 1792
  v_and_b32 v56, 31, v1
  v_cmp_gt_u32 vcc, 28, v56
  v_lshrrev_b32 v57, 5, v1
  v_mul_u32_u24 v57, 896, v57
  v_lshl_add_u32 v56, v56, 4, v57
  v_add_u32 v56, s58, v56
  v_cndmask_b32 v56, v60, v56, vcc
  buffer_load_dwordx4 v[48:51], v56, s[12:15], 0 offen
  buffer_load_dwordx4 v[52:55], v56, s[12:15], 0 offen offset:448
  s_add_u32 m0, s41, 142848
  s_nop 0
  buffer_load_dwordx4 v33, s[16:19], s64 offen offset:0 lds
  s_add_u32 m0, s41, 151040
  s_nop 0
  buffer_load_dwordx4 v33, s[20:23], s64 offen offset:0 lds
  v_lshlrev_b32 v5, 7, v2
  v_add_u32 v5, 12288, v5
  v_lshrrev_b32 v4, 1, v2
  v_xor_b32 v4, v4, v3
  v_lshl_add_u32 v13, v4, 4, v5
  v_bfe_u32 v4, v1, 2, 2
  v_lshl_add_u32 v5, v3, 3, v4
  v_lshlrev_b32 v5, 8, v5
  v_add_u32 v5, 71168, v5
  v_and_b32 v6, 1, v3
  v_lshl_add_u32 v4, v6, 2, v4
  v_lshlrev_b32 v4, 5, v4
  v_and_b32 v6, 3, v1
  s_mul_i32 s52, s29, 64
  v_lshl_add_u32 v7, v6, 3, s52
  v_xor_b32 v8, v7, v4
  v_add_u32 v17, v8, v5
  v_add_u32 v7, 32, v7
  v_xor_b32 v8, v7, v4
  v_and_b32 v4, 7, v1
  v_lshlrev_b32 v4, 4, v4
  v_add_u32 v4, 22400, v4
  v_mov_b32 v6, 0x3f803f80
  v_mov_b32 v7, 0x3f803f80
  v_add_u32 v18, v8, v5
  v_mov_b32 v8, 0x3f803f80
  v_mov_b32 v9, 0x3f803f80
  v_add_u32 v5, 65536, v4
  ds_write_b128 v4, v[6:9] offset:48640
  ds_write_b128 v5, v[6:9] offset:54784
  ds_write_b128 v4, v[6:9] offset:26112
  ds_write_b128 v4, v[6:9] offset:3584
  s_waitcnt vmcnt(4) lgkmcnt(0)
  s_barrier
  ds_read_b64_tr_b16 a[0:1], v17 offset:32768
  ds_read_b64_tr_b16 a[2:3], v17 offset:33792
  ds_read_b128 v[144:147], v13 offset:56832
  ds_read_b64_tr_b16 a[4:5], v18 offset:32768
  ds_read_b64_tr_b16 a[6:7], v18 offset:33792
  ds_read_b64_tr_b16 a[8:9], v17 offset:40960
  ds_read_b64_tr_b16 a[10:11], v17 offset:41984
  ds_read_b64_tr_b16 a[12:13], v18 offset:40960
  ds_read_b64_tr_b16 a[14:15], v18 offset:41984
  ds_read_b128 v[148:151], v13 offset:48640
  ds_read_b128 v[152:155], v13 offset:50688
  ds_read_b128 v[156:159], v13 offset:52736
  ds_read_b128 v[168:171], v13 offset:54784
  s_waitcnt lgkmcnt(10)
  v_mfma_f32_16x16x32_bf16 v[128:131], a[0:3], v[144:147], 0
  s_lshl_b32 s59, s2, 2
  s_add_u32 s59, s59, s29
  s_mul_i32 s58, s59, 768
  s_add_u32 s58, s58, 458752
  s_mov_b32 s64, 229376
  s_waitcnt lgkmcnt(8)
  v_mfma_f32_16x16x32_bf16 v[132:135], a[4:7], v[144:147], 0
  v_min_u32 v15, 5, v1
  v_lshl_add_u32 v15, v15, 7, s58
  s_mul_i32 s58, s59, 1024
  s_add_u32 s58, s58, 917504
  s_mov_b32 s10, 1605632
  s_waitcnt lgkmcnt(6)
  v_mfma_f32_16x16x32_bf16 v[136:139], a[8:11], v[144:147], 0
  buffer_load_dword v35, v15, s[20:23], 0 offen offset:0
  s_add_u32 m0, s41, 71168
  s_mov_b32 s11, 0x20000
  s_lshl_b32 s37, s37, 5
  s_add_u32 s37, s37, 9764864
  s_waitcnt lgkmcnt(4)
  v_mfma_f32_16x16x32_bf16 v[140:143], a[12:15], v[144:147], 0
  v_add_u32 v19, 49152, v17
  v_xor_b32 v14, 64, v13
  s_mov_b32 s27, 0x20000
  s_mov_b32 s26, 9797632
  s_mov_b32 s66, 1463426304
  s_waitcnt lgkmcnt(3)
  v_mfma_f32_16x16x32_bf16 v[64:67], a[0:3], v[148:151], 0
  s_mov_b32 s67, 488447261
  ds_read_b128 v[172:175], v14 offset:56832
  v_add_u32 v20, 49152, v18
  s_cmp_ge_u32 s56, 4
  s_cselect_b32 s66, 3417215348, s66
  s_cselect_b32 s67, 471670045, s67
  v_mfma_f32_16x16x32_bf16 v[68:71], a[4:7], v[148:151], 0
  s_lshl_b32 s47, s56, 3
  buffer_load_dwordx4 v32, s[16:19], s64 offen offset:0 lds
  s_add_u32 m0, s41, 79360
  s_lshr_b32 s66, s66, s47
  s_lshr_b32 s67, s67, s47
  s_and_b32 s47, s66, 255
  v_mfma_f32_16x16x32_bf16 v[72:75], a[8:11], v[148:151], 0
  s_add_u32 s47, s47, s57
  ds_read_b128 v[144:147], v14 offset:48640
  v_min_u32 v15, 7, v1
  s_mul_i32 s66, s47, 9363
  s_mul_i32 s52, s29, 135168
  s_and_b32 s77, s67, 255
  v_mfma_f32_16x16x32_bf16 v[76:79], a[12:15], v[148:151], 0
  buffer_load_dwordx4 v32, s[20:23], s64 offen offset:0 lds
  s_add_u32 m0, s41, 120192
  s_lshr_b32 s66, s66, 16
  s_add_u32 s46, s46, s52
  s_mul_i32 s67, s66, 7
  s_waitcnt lgkmcnt(4)
  v_mfma_f32_16x16x32_bf16 v[80:83], a[0:3], v[152:155], 0
  s_lshl_b32 s52, s29, 8
  ds_read_b128 v[148:151], v14 offset:50688
  v_lshl_add_u32 v15, v15, 7, s58
  s_mul_i32 s58, s59, 1280
  s_add_u32 s58, s58, 802816
  s_sub_u32 s67, s47, s67
  v_mfma_f32_16x16x32_bf16 v[84:87], a[4:7], v[152:155], 0
  s_add_u32 s52, s52, 1536
  buffer_load_dwordx4 v10, s[12:15], s34 offen offset:128 lds
  s_add_u32 m0, s41, 128384
  s_cmp_ge_u32 s30, 6
  s_mov_b32 s42, 9474192
  s_cselect_b32 s42, 8421504, s42
  v_mfma_f32_16x16x32_bf16 v[88:91], a[8:11], v[152:155], 0
  s_lshl_b32 s72, s67, 2
  v_add_u32 v21, 65536, v13
  v_add_u32 v22, 65536, v14
  s_cmp_ge_u32 s30, 6
  s_cselect_b32 s75, 28, 32
  s_cselect_b32 s73, 16, 19
  s_cselect_b32 s74, 0, s32
  v_mfma_f32_16x16x32_bf16 v[92:95], a[12:15], v[152:155], 0
  v_mov_b32 v58, 0
  v_mul_u32_u24 v4, 33792, v3
  s_lshr_b32 s42, s42, s72
  s_mul_i32 s75, s75, 896
  s_and_b32 s42, s42, 15
  s_waitcnt lgkmcnt(4)
  v_mfma_f32_16x16x32_bf16 v[96:99], a[0:3], v[156:159], 0
  s_mul_i32 s47, s31, 14336
  buffer_load_dwordx4 v10, s[12:15], s35 offen offset:128 lds
  s_add_u32 m0, s41, 136576
  s_mov_b32 s6, 401408
  s_mov_b32 s70, 1204224
  s_mul_i32 s74, s74, 544768
  v_mfma_f32_16x16x32_bf16 v[100:103], a[4:7], v[156:159], 0
  s_mul_i32 s72, s42, s75
  ds_read_b128 v[152:155], v14 offset:52736
  v_lshl_add_u32 v23, v2, 4, v4
  s_mov_b32 s71, 0x20000
  s_cmp_ge_u32 s30, 6
  s_cselect_b32 s68, s4, s8
  s_cselect_b32 s69, s5, s9
  s_cselect_b32 s70, s6, s10
  v_mfma_f32_16x16x32_bf16 v[104:107], a[8:11], v[156:159], 0
  s_add_u32 s72, s72, s74
  s_mov_b64 exec, s[44:45]
  buffer_load_dwordx4 v10, s[12:15], s36 offen offset:128 lds
  s_mov_b64 exec, -1
  s_add_u32 m0, s41, 87552
  s_lshl_b32 s76, s30, 11
  v_mfma_f32_16x16x32_bf16 v[108:111], a[12:15], v[156:159], 0
  s_waitcnt vmcnt(5)
  s_barrier
  s_cmp_ge_u32 s57, s77
  s_cselect_b32 s70, 0, s70
  s_mov_b32 s71, 0x20000
  s_waitcnt lgkmcnt(4)
  v_mfma_f32_16x16x32_bf16 v[112:115], a[0:3], v[168:171], 0
  s_mul_i32 s73, s73, s75
  ds_read_b64_tr_b16 a[16:17], v19 offset:22528
  v_lshlrev_b32 v4, 1, v3
  s_add_u32 s73, s73, s74
  s_mov_b32 s62, 0x80008000
  s_mov_b32 s63, 0x80008000
  v_mfma_f32_16x16x32_bf16 v[116:119], a[4:7], v[168:171], 0
  s_mov_b32 s7, 0x20000
  ds_read_b64_tr_b16 a[18:19], v19 offset:23552
  v_and_b32 v5, 7, v1
  s_mov_b32 s3, 896
  ds_read_b64_tr_b16 a[20:21], v20 offset:22528
  v_mfma_f32_16x16x32_bf16 v[120:123], a[8:11], v[168:171], 0
  ds_read_b64_tr_b16 a[22:23], v20 offset:23552
  v_xor_b32 v4, v4, v5
  ds_read_b64_tr_b16 a[24:25], v19 offset:30720
  v_mfma_f32_16x16x32_bf16 v[124:127], a[12:15], v[168:171], 0
  ds_read_b64_tr_b16 a[26:27], v19 offset:31744
  v_lshl_add_u32 v34, v3, 6, s52
  s_lshl_b32 s52, s67, 7
  s_add_u32 s47, s47, s52
  buffer_load_dwordx4 v33, s[16:19], s64 offen offset:0 lds
  ds_read_b64_tr_b16 a[28:29], v20 offset:30720
  ds_read_b64_tr_b16 a[30:31], v20 offset:31744
  s_add_u32 m0, s41, 95744
  ds_read_b128 v[156:159], v14 offset:54784
  v_lshrrev_b32 v5, 3, v1
  v_mul_u32_u24 v6, 896, v5
  v_lshl_add_u32 v6, v4, 4, v6
  s_waitcnt lgkmcnt(7)
  v_mfma_f32_16x16x32_bf16 v[128:131], a[16:19], v[172:175], v[128:131]
  v_add_u32 v11, s47, v6
  v_add_u32 v12, s72, v11
  s_lshl_b32 s47, s32, 12
  s_add_u32 s47, s47, 26112
  s_waitcnt lgkmcnt(5)
  v_mfma_f32_16x16x32_bf16 v[132:135], a[20:23], v[172:175], v[132:135]
  s_waitcnt lgkmcnt(3)
  v_add_u32 v9, 7168, v12
  v_lshrrev_b32 v6, 2, v1
  s_add_u32 s72, s72, s75
  s_cmp_eq_u32 s72, s73
  s_cselect_b32 s72, s74, s72
  v_mfma_f32_16x16x32_bf16 v[136:139], a[24:27], v[172:175], v[136:139]
  s_waitcnt lgkmcnt(1)
  v_lshlrev_b32 v6, 7, v6
  v_and_b32 v7, 3, v1
  v_mfma_f32_16x16x32_bf16 v[140:143], a[28:31], v[172:175], v[140:143]
  buffer_load_dwordx4 v33, s[20:23], s64 offen offset:0 lds
  s_mov_b32 s64, 458752
  s_add_u32 m0, s41, 103936
  v_mfma_f32_16x16x32_bf16 v[64:67], a[16:19], v[144:147], v[64:67]
  v_lshl_add_u32 v6, v7, 3, v6
  v_bfe_u32 v7, v1, 3, 2
  v_mfma_f32_16x16x32_bf16 v[68:71], a[20:23], v[144:147], v[68:71]
  v_xor_b32 v7, s32, v7
  v_lshl_add_u32 v6, v7, 5, v6
  v_mfma_f32_16x16x32_bf16 v[72:75], a[24:27], v[144:147], v[72:75]
  v_add_u32 v4, s47, v6
  v_xor_b32 v5, 32, v4
  v_mfma_f32_16x16x32_bf16 v[76:79], a[28:31], v[144:147], v[76:79]
  buffer_load_dwordx4 v32, s[16:19], s64 offen offset:0 lds
  s_add_u32 m0, s41, 112128
  v_mfma_f32_16x16x32_bf16 v[80:83], a[16:19], v[148:151], v[80:83]
  v_xor_b32 v6, 64, v4
  v_xor_b32 v7, 96, v4
  v_mfma_f32_16x16x32_bf16 v[84:87], a[20:23], v[148:151], v[84:87]
  v_lshlrev_b32 v27, 3, v2
  v_mfma_f32_16x16x32_bf16 v[88:91], a[24:27], v[148:151], v[88:91]
  v_mfma_f32_16x16x32_bf16 v[92:95], a[28:31], v[148:151], v[92:95]
  v_mfma_f32_16x16x32_bf16 v[96:99], a[16:19], v[152:155], v[96:99]
  buffer_load_dwordx4 v32, s[20:23], s64 offen offset:0 lds
  v_mfma_f32_16x16x32_bf16 v[100:103], a[20:23], v[152:155], v[100:103]
  v_mfma_f32_16x16x32_bf16 v[104:107], a[24:27], v[152:155], v[104:107]
  v_mfma_f32_16x16x32_bf16 v[108:111], a[28:31], v[152:155], v[108:111]
  s_waitcnt lgkmcnt(0)
  v_mfma_f32_16x16x32_bf16 v[112:115], a[16:19], v[156:159], v[112:115]
  v_mfma_f32_16x16x32_bf16 v[116:119], a[20:23], v[156:159], v[116:119]
  v_mfma_f32_16x16x32_bf16 v[120:123], a[24:27], v[156:159], v[120:123]
  v_mfma_f32_16x16x32_bf16 v[124:127], a[28:31], v[156:159], v[124:127]
  s_waitcnt vmcnt(4)
  s_barrier
  v_mov_b32 v56, 0
  v_mov_b32 v57, 0
  s_mov_b32 s65, 0x3f803f80
  v_dot2c_f32_bf16 v56, s65, v48
  v_dot2c_f32_bf16 v57, v48, v48
  v_dot2c_f32_bf16 v56, s65, v49
  v_dot2c_f32_bf16 v57, v49, v49
  v_dot2c_f32_bf16 v56, s65, v50
  v_dot2c_f32_bf16 v57, v50, v50
  v_dot2c_f32_bf16 v56, s65, v51
  v_dot2c_f32_bf16 v57, v51, v51
  v_dot2c_f32_bf16 v56, s65, v52
  v_dot2c_f32_bf16 v57, v52, v52
  v_dot2c_f32_bf16 v56, s65, v53
  v_dot2c_f32_bf16 v57, v53, v53
  v_dot2c_f32_bf16 v56, s65, v54
  v_dot2c_f32_bf16 v57, v54, v54
  v_dot2c_f32_bf16 v56, s65, v55
  v_dot2c_f32_bf16 v57, v55, v55
  s_nop 2
  ds_read_b64_tr_b16 a[32:33], v17 offset:0
  ds_read_b64_tr_b16 a[34:35], v17 offset:1024
  ds_read_b128 v[168:171], v21 offset:62976
  buffer_load_dword v35, v15, s[20:23], 0 offen offset:0
  ds_read_b64_tr_b16 a[36:37], v18 offset:0
  ds_read_b64_tr_b16 a[38:39], v18 offset:1024
  ds_read_b64_tr_b16 a[40:41], v17 offset:8192
  ds_read_b64_tr_b16 a[42:43], v17 offset:9216
  s_add_u32 m0, s41, 25856
  s_nop 0
  buffer_load_dwordx4 v10, s[12:15], s34 offen offset:256 lds
  ds_read_b64_tr_b16 a[44:45], v18 offset:8192
  ds_read_b64_tr_b16 a[46:47], v18 offset:9216
  ds_read_b128 v[172:175], v21 offset:54784
  s_add_u32 m0, s41, 34048
  ds_read_b128 v[144:147], v21 offset:56832
  ds_read_b128 v[148:151], v21 offset:58880
  ds_read_b128 v[152:155], v21 offset:60928
  v_min_u32 v15, 9, v1
  v_lshl_add_u32 v15, v15, 7, s58
  ds_read_b128 v[156:159], v22 offset:62976
  s_mul_i32 s58, s59, 1280
  s_add_u32 s58, s58, 802816
  v_permlane16_swap_b32 v56, v57
  v_add_f32 v52, v56, v57
  v_lshrrev_b32 v55, 1, v1
  v_and_b32 v56, 31, v1
  v_add_f32_dpp v52, v52, v52 row_ror:8 row_mask:0xf bank_mask:0xf
  v_add_u32 v55, s37, v55
  v_cmp_eq_u32 vcc, 0, v56
  s_waitcnt lgkmcnt(11)
  v_mfma_f32_16x16x32_bf16 v[128:131], a[32:35], v[168:171], v[128:131]
  s_waitcnt lgkmcnt(9)
  v_add_f32_dpp v52, v52, v52 row_ror:4 row_mask:0xf bank_mask:0xf
  v_cndmask_b32 v55, -16, v55, vcc
  v_mfma_f32_16x16x32_bf16 v[132:135], a[36:39], v[168:171], v[132:135]
  s_waitcnt lgkmcnt(7)
  v_add_f32_dpp v52, v52, v52 row_ror:2 row_mask:0xf bank_mask:0xf
  v_mfma_f32_16x16x32_bf16 v[136:139], a[40:43], v[168:171], v[136:139]
  s_waitcnt lgkmcnt(5)
  buffer_load_dwordx4 v10, s[12:15], s35 offen offset:256 lds
  s_add_u32 m0, s41, 42240
  v_mfma_f32_16x16x32_bf16 v[140:143], a[44:47], v[168:171], v[140:143]
  s_waitcnt lgkmcnt(4)
  v_add_f32_dpp v52, v52, v52 row_ror:1 row_mask:0xf bank_mask:0xf
  v_mov_b32 v53, v52
  v_mfma_f32_16x16x32_bf16 v[64:67], a[32:35], v[172:175], v[64:67]
  ds_read_b128 v[168:171], v22 offset:54784
  v_mfma_f32_16x16x32_bf16 v[68:71], a[36:39], v[172:175], v[68:71]
  s_mov_b64 exec, s[44:45]
  buffer_load_dwordx4 v10, s[12:15], s36 offen offset:256 lds
  s_mov_b64 exec, -1
  s_add_u32 m0, s41, 142848
  v_mfma_f32_16x16x32_bf16 v[72:75], a[40:43], v[172:175], v[72:75]
  v_permlane16_swap_b32 v52, v53
  v_mfma_f32_16x16x32_bf16 v[76:79], a[44:47], v[172:175], v[76:79]
  s_waitcnt lgkmcnt(4)
  v_mul_f32 v52, 0x3b124925, v52
  v_mul_f32 v54, v52, v52
  v_mfma_f32_16x16x32_bf16 v[80:83], a[32:35], v[144:147], v[80:83]
  buffer_load_dwordx4 v33, s[16:19], s64 offen offset:0 lds
  s_add_u32 m0, s41, 151040
  v_mfma_f32_16x16x32_bf16 v[84:87], a[36:39], v[144:147], v[84:87]
  ds_read_b128 v[172:175], v22 offset:56832
  v_mul_f32 v53, 0x3b124925, v53
  v_mfma_f32_16x16x32_bf16 v[88:91], a[40:43], v[144:147], v[88:91]
  buffer_load_dwordx4 v33, s[20:23], s64 offen offset:0 lds
  s_mov_b32 s64, 688128
  v_mfma_f32_16x16x32_bf16 v[92:95], a[44:47], v[144:147], v[92:95]
  s_waitcnt lgkmcnt(4)
  v_sub_f32 v53, v53, v54
  v_max_f32 v53, 0, v53
  v_mfma_f32_16x16x32_bf16 v[96:99], a[32:35], v[148:151], v[96:99]
  s_waitcnt vmcnt(7)
  s_barrier
  ds_read_b64_tr_b16 a[0:1], v17 offset:16384
  v_mfma_f32_16x16x32_bf16 v[100:103], a[36:39], v[148:151], v[100:103]
  ds_read_b64_tr_b16 a[2:3], v17 offset:17408
  v_cvt_pk_bf16_f32 v54, -v52, v53
  v_mfma_f32_16x16x32_bf16 v[104:107], a[40:43], v[148:151], v[104:107]
  s_and_b32 s50, s57, 3
  s_cmp_eq_u32 s50, 0
  s_cbranch_scc0 L_sk9
  buffer_load_dword v35, v15, s[8:11], 0 offen offset:0
L_sk9:
  v_mfma_f32_16x16x32_bf16 v[108:111], a[44:47], v[148:151], v[108:111]
  s_waitcnt lgkmcnt(5)
  s_add_u32 m0, s41, 71168
  v_min_u32 v15, 9, v1
  v_mfma_f32_16x16x32_bf16 v[112:115], a[32:35], v[152:155], v[112:115]
  buffer_load_dwordx4 v32, s[16:19], s64 offen offset:0 lds
  s_add_u32 m0, s41, 79360
  v_mfma_f32_16x16x32_bf16 v[116:119], a[36:39], v[152:155], v[116:119]
  ds_read_b64_tr_b16 a[4:5], v18 offset:16384
  v_lshl_add_u32 v15, v15, 7, s58
  s_mul_i32 s58, s59, 1280
  s_add_u32 s58, s58, 802816
  v_mfma_f32_16x16x32_bf16 v[120:123], a[40:43], v[152:155], v[120:123]
  ds_read_b64_tr_b16 a[6:7], v18 offset:17408
  v_lshlrev_b32 v48, 16, v54
  ds_read_b64_tr_b16 a[8:9], v17 offset:24576
  v_mfma_f32_16x16x32_bf16 v[124:127], a[44:47], v[152:155], v[124:127]
  ds_read_b64_tr_b16 a[10:11], v17 offset:25600
  v_and_b32 v53, 0xffff0000, v54
  ds_read_b64_tr_b16 a[12:13], v18 offset:24576
  buffer_load_dwordx4 v32, s[20:23], s64 offen offset:0 lds
  s_waitcnt lgkmcnt(5)
  v_mfma_f32_16x16x32_bf16 v[128:131], a[0:3], v[156:159], v[128:131]
  ds_read_b64_tr_b16 a[14:15], v18 offset:25600
  s_add_u32 m0, s41, 3200
  ds_read_b128 v[144:147], v22 offset:58880
  ds_read_b128 v[148:151], v22 offset:60928
  v_add_f32 v53, 0x3727c5ac, v53
  v_cvt_pk_bf16_f32 v53, v53, v53
  v_and_b32 v53, 0xffff0000, v53
  v_sqrt_f32 v53, v53
  s_waitcnt lgkmcnt(6)
  v_mfma_f32_16x16x32_bf16 v[132:135], a[4:7], v[156:159], v[132:135]
  s_waitcnt lgkmcnt(4)
  buffer_load_dwordx4 v10, s[12:15], s34 offen offset:384 lds
  s_add_u32 m0, s41, 11392
  v_mfma_f32_16x16x32_bf16 v[136:139], a[8:11], v[156:159], v[136:139]
  s_waitcnt lgkmcnt(2)
  v_cvt_pk_bf16_f32 v53, v53, v53
  v_and_b32 v53, 0xffff0000, v53
  v_mfma_f32_16x16x32_bf16 v[140:143], a[12:15], v[156:159], v[140:143]
  v_rcp_f32 v50, v53
  v_mfma_f32_16x16x32_bf16 v[64:67], a[0:3], v[168:171], v[64:67]
  buffer_load_dwordx4 v10, s[12:15], s35 offen offset:384 lds
  s_add_u32 m0, s41, 19584
  v_mfma_f32_16x16x32_bf16 v[68:71], a[4:7], v[168:171], v[68:71]
  v_mfma_f32_16x16x32_bf16 v[72:75], a[8:11], v[168:171], v[72:75]
  s_mov_b64 exec, s[44:45]
  buffer_load_dwordx4 v10, s[12:15], s36 offen offset:384 lds
  s_mov_b64 exec, -1
  v_mfma_f32_16x16x32_bf16 v[76:79], a[12:15], v[168:171], v[76:79]
  v_mfma_f32_16x16x32_bf16 v[80:83], a[0:3], v[172:175], v[80:83]
  v_mfma_f32_16x16x32_bf16 v[84:87], a[4:7], v[172:175], v[84:87]
  global_load_dwordx2 v[58:59], v58, s[60:61] sc1
  v_mfma_f32_16x16x32_bf16 v[88:91], a[8:11], v[172:175], v[88:91]
  v_mfma_f32_16x16x32_bf16 v[92:95], a[12:15], v[172:175], v[92:95]
  s_waitcnt lgkmcnt(1)
  v_mfma_f32_16x16x32_bf16 v[96:99], a[0:3], v[144:147], v[96:99]
  v_mfma_f32_16x16x32_bf16 v[100:103], a[4:7], v[144:147], v[100:103]
  s_waitcnt vmcnt(7)
  s_barrier
  ds_read_b64_tr_b16 a[16:17], v17 offset:32768
  s_and_b32 s50, s57, 3
  s_cmp_eq_u32 s50, 1
  s_cbranch_scc0 L_sk10
  buffer_load_dword v35, v15, s[8:11], 0 offen offset:0
L_sk10:
  v_mfma_f32_16x16x32_bf16 v[104:107], a[8:11], v[144:147], v[104:107]
  s_add_u32 m0, s41, 87552
  ds_read_b64_tr_b16 a[18:19], v17 offset:33792
  v_min_u32 v15, 9, v1
  v_mfma_f32_16x16x32_bf16 v[108:111], a[12:15], v[144:147], v[108:111]
  ds_read_b128 v[152:155], v13 offset:34304
  v_lshl_add_u32 v15, v15, 7, s58
  s_mul_i32 s58, s59, 1280
  s_add_u32 s58, s58, 802816
  s_waitcnt lgkmcnt(3)
  v_mfma_f32_16x16x32_bf16 v[112:115], a[0:3], v[148:151], v[112:115]
  buffer_load_dwordx4 v33, s[16:19], s64 offen offset:0 lds
  s_add_u32 m0, s41, 95744
  v_mfma_f32_16x16x32_bf16 v[116:119], a[4:7], v[148:151], v[116:119]
  ds_read_b64_tr_b16 a[20:21], v18 offset:32768
  v_mfma_f32_16x16x32_bf16 v[120:123], a[8:11], v[148:151], v[120:123]
  ds_read_b64_tr_b16 a[22:23], v18 offset:33792
  ds_read_b64_tr_b16 a[24:25], v17 offset:40960
  v_mfma_f32_16x16x32_bf16 v[124:127], a[12:15], v[148:151], v[124:127]
  s_waitcnt lgkmcnt(3)
  ds_read_b64_tr_b16 a[26:27], v17 offset:41984
  buffer_load_dwordx4 v33, s[20:23], s64 offen offset:0 lds
  ds_read_b64_tr_b16 a[28:29], v18 offset:40960
  v_mfma_f32_16x16x32_bf16 v[128:131], a[16:19], v[152:155], v[128:131]
  ds_read_b64_tr_b16 a[30:31], v18 offset:41984
  s_add_u32 m0, s41, 48128
  s_mov_b32 s64, 917504
  ds_read_b128 v[156:159], v13 offset:26112
  ds_read_b128 v[168:171], v13 offset:28160
  ds_read_b128 v[172:175], v13 offset:30208
  ds_read_b128 v[144:147], v13 offset:32256
  ds_read_b128 v[148:151], v14 offset:34304
  s_waitcnt lgkmcnt(9)
  v_mfma_f32_16x16x32_bf16 v[132:135], a[20:23], v[152:155], v[132:135]
  s_waitcnt lgkmcnt(7)
  buffer_load_dwordx4 v10, s[12:15], s34 offen offset:512 lds
  s_add_u32 m0, s41, 56320
  v_mfma_f32_16x16x32_bf16 v[136:139], a[24:27], v[152:155], v[136:139]
  s_waitcnt lgkmcnt(5)
  v_mfma_f32_16x16x32_bf16 v[140:143], a[28:31], v[152:155], v[140:143]
  s_waitcnt lgkmcnt(4)
  v_mfma_f32_16x16x32_bf16 v[64:67], a[16:19], v[156:159], v[64:67]
  buffer_load_dwordx4 v10, s[12:15], s35 offen offset:512 lds
  s_add_u32 m0, s41, 64512
  v_mfma_f32_16x16x32_bf16 v[68:71], a[20:23], v[156:159], v[68:71]
  ds_read_b128 v[152:155], v14 offset:26112
  v_mfma_f32_16x16x32_bf16 v[72:75], a[24:27], v[156:159], v[72:75]
  v_mfma_f32_16x16x32_bf16 v[76:79], a[28:31], v[156:159], v[76:79]
  s_waitcnt lgkmcnt(4)
  s_mov_b64 exec, s[44:45]
  buffer_load_dwordx4 v10, s[12:15], s36 offen offset:512 lds
  s_mov_b64 exec, -1
  v_mfma_f32_16x16x32_bf16 v[80:83], a[16:19], v[168:171], v[80:83]
  ds_read_b128 v[156:159], v14 offset:28160
  v_mfma_f32_16x16x32_bf16 v[84:87], a[20:23], v[168:171], v[84:87]
  s_waitcnt vmcnt(9)
  s_barrier
  ds_read_b64_tr_b16 a[32:33], v19 offset:22528
  v_mfma_f32_16x16x32_bf16 v[88:91], a[24:27], v[168:171], v[88:91]
  ds_read_b64_tr_b16 a[34:35], v19 offset:23552
  v_mfma_f32_16x16x32_bf16 v[92:95], a[28:31], v[168:171], v[92:95]
  s_waitcnt lgkmcnt(6)
  s_and_b32 s50, s57, 3
  s_cmp_eq_u32 s50, 2
  s_cbranch_scc0 L_sk11
  buffer_load_dword v35, v15, s[8:11], 0 offen offset:0
L_sk11:
  v_mfma_f32_16x16x32_bf16 v[96:99], a[16:19], v[172:175], v[96:99]
  s_add_u32 m0, s41, 103936
  ds_read_b64_tr_b16 a[36:37], v20 offset:22528
  v_min_u32 v15, 9, v1
  v_mfma_f32_16x16x32_bf16 v[100:103], a[20:23], v[172:175], v[100:103]
  ds_read_b64_tr_b16 a[38:39], v20 offset:23552
  v_lshl_add_u32 v15, v15, 7, s58
  s_lshl_b32 s58, s29, 6
  v_mfma_f32_16x16x32_bf16 v[104:107], a[24:27], v[172:175], v[104:107]
  buffer_load_dwordx4 v32, s[16:19], s64 offen offset:0 lds
  s_add_u32 m0, s41, 112128
  v_mfma_f32_16x16x32_bf16 v[108:111], a[28:31], v[172:175], v[108:111]
  s_waitcnt lgkmcnt(7)
  ds_read_b64_tr_b16 a[40:41], v19 offset:30720
  v_add_u32 v52, s58, v1
  v_mfma_f32_16x16x32_bf16 v[112:115], a[16:19], v[144:147], v[112:115]
  ds_read_b64_tr_b16 a[42:43], v19 offset:31744
  v_min_u32 v52, 190, v52
  v_mfma_f32_16x16x32_bf16 v[116:119], a[20:23], v[144:147], v[116:119]
  s_waitcnt vmcnt(5)
  v_cmp_ne_u32 vcc, 0, v58
  s_nop 4
  s_cbranch_vccz L_pns01
L_pss01:
  buffer_load_dwordx4 v32, s[20:23], s64 offen offset:0 lds
  v_mfma_f32_16x16x32_bf16 v[120:123], a[24:27], v[144:147], v[120:123]
  s_add_u32 m0, s41, 119680
  ds_read_b64_tr_b16 a[44:45], v20 offset:30720
  v_mov_b32 v49, v58
  v_mfma_f32_16x16x32_bf16 v[124:127], a[28:31], v[144:147], v[124:127]
  s_waitcnt lgkmcnt(5)
  ds_read_b64_tr_b16 a[46:47], v20 offset:31744
  v_mov_b32 v51, v59
  v_mfma_f32_16x16x32_bf16 v[128:131], a[32:35], v[148:151], v[128:131]
  s_waitcnt lgkmcnt(4)
  buffer_load_dwordx4 v10, s[12:15], s34 offen offset:640 lds
  s_add_u32 m0, s41, 127872
  v_mfma_f32_16x16x32_bf16 v[132:135], a[36:39], v[148:151], v[132:135]
  s_waitcnt lgkmcnt(2)
  ds_read_b128 v[168:171], v14 offset:30208
  v_lshlrev_b32 v30, 3, v52
  v_mfma_f32_16x16x32_bf16 v[136:139], a[40:43], v[148:151], v[136:139]
  s_waitcnt lgkmcnt(1)
  ds_read_b128 v[172:175], v14 offset:32256
  v_add_u32 v52, s33, v52
  v_mfma_f32_16x16x32_bf16 v[140:143], a[44:47], v[148:151], v[140:143]
  buffer_load_dwordx4 v10, s[12:15], s35 offen offset:640 lds
  v_max_i32 v52, 0, v52
  v_mfma_f32_16x16x32_bf16 v[64:67], a[32:35], v[152:155], v[64:67]
  v_min_u32 v52, 2047, v52
  v_lshlrev_b32 v52, 4, v52
  v_mfma_f32_16x16x32_bf16 v[68:71], a[36:39], v[152:155], v[68:71]
  buffer_store_dwordx4 v[48:51], v55, s[24:27], 0 offen sc1
  v_add_u32 v52, 9764864, v52
  v_mfma_f32_16x16x32_bf16 v[72:75], a[40:43], v[152:155], v[72:75]
  v_mov_b32 v164, v58
  v_mov_b32 v165, v59
  v_mfma_f32_16x16x32_bf16 v[76:79], a[44:47], v[152:155], v[76:79]
  s_barrier
  ds_read_b64_tr_b16 a[0:1], v17 offset:0
  v_mfma_f32_16x16x32_bf16 v[80:83], a[32:35], v[156:159], v[80:83]
  ds_read_b64_tr_b16 a[2:3], v17 offset:1024
  v_mfma_f32_16x16x32_bf16 v[84:87], a[36:39], v[156:159], v[84:87]
  ds_read_b128 v[144:147], v13 offset:11776
  v_mfma_f32_16x16x32_bf16 v[88:91], a[40:43], v[156:159], v[88:91]
  s_and_b32 s50, s57, 3
  s_cmp_eq_u32 s50, 3
  s_cbranch_scc0 L_sk12
  buffer_load_dword v35, v15, s[8:11], 0 offen offset:0
L_sk12:
  v_mfma_f32_16x16x32_bf16 v[92:95], a[44:47], v[156:159], v[92:95]
  s_waitcnt lgkmcnt(4)
  s_add_u32 m0, s41, 142848
  v_mfma_f32_16x16x32_bf16 v[96:99], a[32:35], v[168:171], v[96:99]
  ds_read_b64_tr_b16 a[4:5], v18 offset:0
  v_mfma_f32_16x16x32_bf16 v[100:103], a[36:39], v[168:171], v[100:103]
  ds_read_b64_tr_b16 a[6:7], v18 offset:1024
  v_mfma_f32_16x16x32_bf16 v[104:107], a[40:43], v[168:171], v[104:107]
  ds_read_b64_tr_b16 a[8:9], v17 offset:8192
  v_mfma_f32_16x16x32_bf16 v[108:111], a[44:47], v[168:171], v[108:111]
  s_waitcnt lgkmcnt(6)
  buffer_load_dwordx4 v33, s[16:19], s64 offen offset:0 lds
  s_add_u32 m0, s41, 151040
  v_mfma_f32_16x16x32_bf16 v[112:115], a[32:35], v[172:175], v[112:115]
  ds_read_b64_tr_b16 a[10:11], v17 offset:9216
  v_mfma_f32_16x16x32_bf16 v[116:119], a[36:39], v[172:175], v[116:119]
  ds_read_b64_tr_b16 a[12:13], v18 offset:8192
  v_mfma_f32_16x16x32_bf16 v[120:123], a[40:43], v[172:175], v[120:123]
  ds_read_b64_tr_b16 a[14:15], v18 offset:9216
  v_mfma_f32_16x16x32_bf16 v[124:127], a[44:47], v[172:175], v[124:127]
  s_waitcnt lgkmcnt(6)
  buffer_load_dwordx4 v33, s[20:23], s64 offen offset:0 lds
  s_add_u32 m0, s41, 136064
  s_mov_b32 s64, 1146880
  v_mfma_f32_16x16x32_bf16 v[128:131], a[0:3], v[144:147], v[128:131]
  s_waitcnt lgkmcnt(4)
  ds_read_b128 v[148:151], v13 offset:3584
  v_mfma_f32_16x16x32_bf16 v[132:135], a[4:7], v[144:147], v[132:135]
  s_waitcnt lgkmcnt(3)
  ds_read_b128 v[152:155], v13 offset:5632
  v_mfma_f32_16x16x32_bf16 v[136:139], a[8:11], v[144:147], v[136:139]
  s_waitcnt lgkmcnt(2)
  ds_read_b128 v[156:159], v13 offset:7680
  v_mfma_f32_16x16x32_bf16 v[140:143], a[12:15], v[144:147], v[140:143]
  s_mov_b64 exec, s[44:45]
  buffer_load_dwordx4 v10, s[12:15], s36 offen offset:640 lds
  s_mov_b64 exec, -1
  s_add_u32 m0, s76, 26112
  s_waitcnt lgkmcnt(2)
  v_mfma_f32_16x16x32_bf16 v[64:67], a[0:3], v[148:151], v[64:67]
  ds_read_b128 v[168:171], v13 offset:9728
  v_mfma_f32_16x16x32_bf16 v[68:71], a[4:7], v[148:151], v[68:71]
  s_waitcnt vmcnt(9)
  s_barrier
  ds_read_b64_tr_b16 a[16:17], v17 offset:16384
  v_mfma_f32_16x16x32_bf16 v[72:75], a[8:11], v[148:151], v[72:75]
  ds_read_b64_tr_b16 a[18:19], v17 offset:17408
  v_mfma_f32_16x16x32_bf16 v[76:79], a[12:15], v[148:151], v[76:79]
  s_waitcnt lgkmcnt(4)
  ds_read_b128 v[172:175], v14 offset:11776
  v_mfma_f32_16x16x32_bf16 v[80:83], a[0:3], v[152:155], v[80:83]
  ds_read_b64_tr_b16 a[20:21], v18 offset:16384
  v_mfma_f32_16x16x32_bf16 v[84:87], a[4:7], v[152:155], v[84:87]
  buffer_load_dwordx4 v12, s[68:71], 0 offen lds
  s_add_u32 m0, s76, 27136
  v_mfma_f32_16x16x32_bf16 v[88:91], a[8:11], v[152:155], v[88:91]
  ds_read_b64_tr_b16 a[22:23], v18 offset:17408
  v_add_u32 v12, s72, v11
  s_add_u32 s72, s72, s75
  s_cmp_eq_u32 s72, s73
  s_cselect_b32 s72, s74, s72
  v_mfma_f32_16x16x32_bf16 v[92:95], a[12:15], v[152:155], v[92:95]
  s_waitcnt lgkmcnt(6)
  ds_read_b64_tr_b16 a[24:25], v17 offset:24576
  v_mfma_f32_16x16x32_bf16 v[96:99], a[0:3], v[156:159], v[96:99]
  ds_read_b64_tr_b16 a[26:27], v17 offset:25600
  v_mfma_f32_16x16x32_bf16 v[100:103], a[4:7], v[156:159], v[100:103]
  ds_read_b64_tr_b16 a[28:29], v18 offset:24576
  v_mfma_f32_16x16x32_bf16 v[104:107], a[8:11], v[156:159], v[104:107]
  buffer_load_dwordx4 v9, s[68:71], 0 offen lds
  s_add_u32 m0, s41, 71168
  v_mfma_f32_16x16x32_bf16 v[108:111], a[12:15], v[156:159], v[108:111]
  s_waitcnt lgkmcnt(8)
  ds_read_b64_tr_b16 a[30:31], v18 offset:25600
  v_add_u32 v9, 7168, v12
  v_mfma_f32_16x16x32_bf16 v[112:115], a[0:3], v[168:171], v[112:115]
  ds_read_b128 v[144:147], v14 offset:3584
  v_mfma_f32_16x16x32_bf16 v[116:119], a[4:7], v[168:171], v[116:119]
  ds_read_b128 v[148:151], v14 offset:5632
  v_mfma_f32_16x16x32_bf16 v[120:123], a[8:11], v[168:171], v[120:123]
  ds_read_b128 v[152:155], v14 offset:7680
  v_mfma_f32_16x16x32_bf16 v[124:127], a[12:15], v[168:171], v[124:127]
  s_waitcnt lgkmcnt(9)
  buffer_load_dwordx4 v32, s[16:19], s64 offen offset:0 lds
  s_add_u32 m0, s41, 79360
  v_mfma_f32_16x16x32_bf16 v[128:131], a[16:19], v[172:175], v[128:131]
  s_waitcnt lgkmcnt(7)
  ds_read_b128 v[156:159], v14 offset:9728
  v_mfma_f32_16x16x32_bf16 v[132:135], a[20:23], v[172:175], v[132:135]
  s_waitcnt lgkmcnt(6)
  v_mfma_f32_16x16x32_bf16 v[136:139], a[24:27], v[172:175], v[136:139]
  s_waitcnt lgkmcnt(4)
  v_mfma_f32_16x16x32_bf16 v[140:143], a[28:31], v[172:175], v[140:143]
  s_waitcnt lgkmcnt(3)
  buffer_load_dwordx4 v32, s[20:23], s64 offen offset:0 lds
  s_add_u32 m0, s41, 87552
  v_mfma_f32_16x16x32_bf16 v[64:67], a[16:19], v[144:147], v[64:67]
  v_mfma_f32_16x16x32_bf16 v[68:71], a[20:23], v[144:147], v[68:71]
  s_waitcnt vmcnt(9)
  s_barrier
  ds_read_b64_tr_b16 a[32:33], v17 offset:32768
  v_mfma_f32_16x16x32_bf16 v[72:75], a[24:27], v[144:147], v[72:75]
  ds_read_b64_tr_b16 a[34:35], v17 offset:33792
  v_mfma_f32_16x16x32_bf16 v[76:79], a[28:31], v[144:147], v[76:79]
  s_waitcnt lgkmcnt(4)
  ds_read_b128 v[168:171], v13 offset:56832
  v_mfma_f32_16x16x32_bf16 v[80:83], a[16:19], v[148:151], v[80:83]
  ds_read_b64_tr_b16 a[36:37], v18 offset:32768
  v_mfma_f32_16x16x32_bf16 v[84:87], a[20:23], v[148:151], v[84:87]
  ds_read_b64_tr_b16 a[38:39], v18 offset:33792
  v_mfma_f32_16x16x32_bf16 v[88:91], a[24:27], v[148:151], v[88:91]
  ds_read_b64_tr_b16 a[40:41], v17 offset:40960
  v_mfma_f32_16x16x32_bf16 v[92:95], a[28:31], v[148:151], v[92:95]
  s_waitcnt lgkmcnt(7)
  ds_read_b64_tr_b16 a[42:43], v17 offset:41984
  v_mfma_f32_16x16x32_bf16 v[96:99], a[16:19], v[152:155], v[96:99]
  ds_read_b64_tr_b16 a[44:45], v18 offset:40960
  v_mfma_f32_16x16x32_bf16 v[100:103], a[20:23], v[152:155], v[100:103]
  buffer_load_dwordx4 v33, s[16:19], s64 offen offset:0 lds
  s_add_u32 m0, s41, 95744
  v_mfma_f32_16x16x32_bf16 v[104:107], a[24:27], v[152:155], v[104:107]
  ds_read_b64_tr_b16 a[46:47], v18 offset:41984
  v_mfma_f32_16x16x32_bf16 v[108:111], a[28:31], v[152:155], v[108:111]
  s_waitcnt lgkmcnt(9)
  ds_read_b128 v[172:175], v13 offset:48640
  v_mfma_f32_16x16x32_bf16 v[112:115], a[16:19], v[156:159], v[112:115]
  ds_read_b128 v[144:147], v13 offset:50688
  v_mfma_f32_16x16x32_bf16 v[116:119], a[20:23], v[156:159], v[116:119]
  ds_read_b128 v[148:151], v13 offset:52736
  v_mfma_f32_16x16x32_bf16 v[120:123], a[24:27], v[156:159], v[120:123]
  ds_read_b128 v[152:155], v13 offset:54784
  v_mfma_f32_16x16x32_bf16 v[124:127], a[28:31], v[156:159], v[124:127]
  s_waitcnt lgkmcnt(10)
  v_mfma_f32_16x16x32_bf16 v[128:131], a[32:35], v[168:171], v[128:131]
  s_waitcnt lgkmcnt(8)
  ds_read_b128 v[156:159], v14 offset:56832
  v_mfma_f32_16x16x32_bf16 v[132:135], a[36:39], v[168:171], v[132:135]
  s_waitcnt lgkmcnt(7)
  v_mfma_f32_16x16x32_bf16 v[136:139], a[40:43], v[168:171], v[136:139]
  s_waitcnt lgkmcnt(5)
  buffer_load_dwordx4 v33, s[20:23], s64 offen offset:0 lds
  s_mov_b32 s64, 1376256
  s_add_u32 m0, s41, 103936
  v_mfma_f32_16x16x32_bf16 v[140:143], a[44:47], v[168:171], v[140:143]
  s_waitcnt lgkmcnt(4)
  v_mfma_f32_16x16x32_bf16 v[64:67], a[32:35], v[172:175], v[64:67]
  ds_read_b128 v[168:171], v14 offset:48640
  v_mfma_f32_16x16x32_bf16 v[68:71], a[36:39], v[172:175], v[68:71]
  s_waitcnt vmcnt(4)
  s_barrier
  ds_read_b64_tr_b16 a[0:1], v19 offset:22528
  v_mfma_f32_16x16x32_bf16 v[72:75], a[40:43], v[172:175], v[72:75]
  ds_read_b64_tr_b16 a[2:3], v19 offset:23552
  v_mfma_f32_16x16x32_bf16 v[76:79], a[44:47], v[172:175], v[76:79]
  s_waitcnt lgkmcnt(6)
  ds_read_b64_tr_b16 a[4:5], v20 offset:22528
  v_mfma_f32_16x16x32_bf16 v[80:83], a[32:35], v[144:147], v[80:83]
  buffer_load_dwordx4 v32, s[16:19], s64 offen offset:0 lds
  s_add_u32 m0, s41, 112128
  v_mfma_f32_16x16x32_bf16 v[84:87], a[36:39], v[144:147], v[84:87]
  ds_read_b64_tr_b16 a[6:7], v20 offset:23552
  v_mfma_f32_16x16x32_bf16 v[88:91], a[40:43], v[144:147], v[88:91]
  ds_read_b64_tr_b16 a[8:9], v19 offset:30720
  v_mfma_f32_16x16x32_bf16 v[92:95], a[44:47], v[144:147], v[92:95]
  s_waitcnt lgkmcnt(8)
  ds_read_b64_tr_b16 a[10:11], v19 offset:31744
  v_mfma_f32_16x16x32_bf16 v[96:99], a[32:35], v[148:151], v[96:99]
  buffer_load_dwordx4 v32, s[20:23], s64 offen offset:0 lds
  s_add_u32 m0, s41, 2816
  v_mfma_f32_16x16x32_bf16 v[100:103], a[36:39], v[148:151], v[100:103]
  ds_read_b64_tr_b16 a[12:13], v20 offset:30720
  v_mfma_f32_16x16x32_bf16 v[104:107], a[40:43], v[148:151], v[104:107]
  ds_read_b64_tr_b16 a[14:15], v20 offset:31744
  v_mfma_f32_16x16x32_bf16 v[108:111], a[44:47], v[148:151], v[108:111]
  s_waitcnt lgkmcnt(10)
  ds_read_b64_tr_b16 a[48:49], v4 offset:0
  v_mfma_f32_16x16x32_bf16 v[112:115], a[32:35], v[152:155], v[112:115]
  buffer_load_dwordx4 v10, s[12:15], s34 offen offset:768 lds
  s_add_u32 m0, s41, 11008
  v_mfma_f32_16x16x32_bf16 v[116:119], a[36:39], v[152:155], v[116:119]
  ds_read_b64_tr_b16 a[50:51], v4 offset:2048
  v_mfma_f32_16x16x32_bf16 v[120:123], a[40:43], v[152:155], v[120:123]
  ds_read_b64_tr_b16 a[52:53], v5 offset:0
  v_mfma_f32_16x16x32_bf16 v[124:127], a[44:47], v[152:155], v[124:127]
  s_waitcnt lgkmcnt(9)
  ds_read_b64_tr_b16 a[54:55], v5 offset:2048
  v_mfma_f32_16x16x32_bf16 v[128:131], a[0:3], v[156:159], v[128:131]
  s_waitcnt lgkmcnt(8)
  buffer_load_dwordx4 v10, s[12:15], s35 offen offset:768 lds
  v_mfma_f32_16x16x32_bf16 v[132:135], a[4:7], v[156:159], v[132:135]
  s_waitcnt lgkmcnt(6)
  ds_read_b64_tr_b16 a[56:57], v6 offset:0
  v_mfma_f32_16x16x32_bf16 v[136:139], a[8:11], v[156:159], v[136:139]
  s_waitcnt lgkmcnt(5)
  ds_read_b64_tr_b16 a[58:59], v6 offset:2048
  v_mfma_f32_16x16x32_bf16 v[140:143], a[12:15], v[156:159], v[140:143]
  ds_read_b64_tr_b16 a[60:61], v7 offset:0
  v_mfma_f32_16x16x32_bf16 v[64:67], a[0:3], v[168:171], v[64:67]
  buffer_load_dwordx4 v[48:51], v52, s[24:27], 0 offen sc1
  s_add_u32 m0, s76, 26112
  ds_read_b64_tr_b16 a[62:63], v7 offset:2048
  v_mfma_f32_16x16x32_bf16 v[68:71], a[4:7], v[168:171], v[68:71]
  ds_read_b128 v[172:175], v14 offset:50688
  v_mfma_f32_16x16x32_bf16 v[72:75], a[8:11], v[168:171], v[72:75]
  ds_read_b128 v[144:147], v14 offset:52736
  v_mfma_f32_16x16x32_bf16 v[76:79], a[12:15], v[168:171], v[76:79]
  s_waitcnt vmcnt(7) lgkmcnt(2)
  ds_read_b128 v[148:151], v14 offset:54784
  s_barrier
  ds_read_b64_tr_b16 a[16:17], v17 offset:0
  ds_read_b64_tr_b16 a[18:19], v17 offset:1024
  ds_read_b128 v[152:155], v21 offset:62976
  ds_read_b64_tr_b16 a[20:21], v18 offset:0
  ds_read_b64_tr_b16 a[22:23], v18 offset:1024
  s_waitcnt lgkmcnt(7)
  v_mfma_f32_16x16x32_bf16 v[80:83], a[0:3], v[172:175], v[80:83]
  buffer_load_dwordx4 v12, s[68:71], 0 offen lds
  s_add_u32 m0, s76, 27136
  v_mfma_f32_16x16x32_bf16 v[84:87], a[4:7], v[172:175], v[84:87]
  ds_read_b64_tr_b16 a[24:25], v17 offset:8192
  v_add_u32 v12, s72, v11
  s_add_u32 s72, s72, s75
  s_cmp_eq_u32 s72, s73
  s_cselect_b32 s72, s74, s72
  v_mfma_f32_16x16x32_bf16 v[88:91], a[8:11], v[172:175], v[88:91]
  ds_read_b64_tr_b16 a[26:27], v17 offset:9216
  v_mfma_f32_16x16x32_bf16 v[92:95], a[12:15], v[172:175], v[92:95]
  s_waitcnt lgkmcnt(8)
  ds_read_b64_tr_b16 a[28:29], v18 offset:8192
  v_mfma_f32_16x16x32_bf16 v[96:99], a[0:3], v[144:147], v[96:99]
  buffer_load_dwordx4 v9, s[68:71], 0 offen lds
  s_add_u32 m0, s41, 19200
  v_mfma_f32_16x16x32_bf16 v[100:103], a[4:7], v[144:147], v[100:103]
  ds_read_b64_tr_b16 a[30:31], v18 offset:9216
  v_add_u32 v9, 7168, v12
  v_mfma_f32_16x16x32_bf16 v[104:107], a[8:11], v[144:147], v[104:107]
  ds_read_b128 v[156:159], v21 offset:54784
  v_mfma_f32_16x16x32_bf16 v[108:111], a[12:15], v[144:147], v[108:111]
  s_mov_b64 exec, s[44:45]
  buffer_load_dwordx4 v10, s[12:15], s36 offen offset:768 lds
  s_mov_b64 exec, -1
  s_add_u32 m0, s41, 142848
  s_waitcnt lgkmcnt(10)
  v_mfma_f32_16x16x32_bf16 v[112:115], a[0:3], v[148:151], v[112:115]
  ds_read_b128 v[168:171], v21 offset:56832
  v_mfma_f32_16x16x32_bf16 v[116:119], a[4:7], v[148:151], v[116:119]
  ds_read_b128 v[172:175], v21 offset:58880
  v_mfma_f32_16x16x32_bf16 v[120:123], a[8:11], v[148:151], v[120:123]
  buffer_load_dwordx4 v33, s[16:19], s64 offen offset:0 lds
  s_add_u32 m0, s41, 151040
  v_mfma_f32_16x16x32_bf16 v[124:127], a[12:15], v[148:151], v[124:127]
  s_waitcnt lgkmcnt(9)
  ds_read_b128 v[144:147], v21 offset:60928
  v_mfma_f32_16x16x32_bf16 v[128:131], a[16:19], v[152:155], v[128:131]
  s_waitcnt lgkmcnt(8)
  ds_read_b128 v[148:151], v22 offset:62976
  v_mfma_f32_16x16x32_bf16 v[132:135], a[20:23], v[152:155], v[132:135]
  s_waitcnt lgkmcnt(7)
  v_mfma_f32_16x16x32_bf16 v[136:139], a[24:27], v[152:155], v[136:139]
  s_waitcnt lgkmcnt(5)
  buffer_load_dwordx4 v33, s[20:23], s64 offen offset:0 lds
  s_add_u32 m0, s76, 42496
  v_mfma_f32_16x16x32_bf16 v[140:143], a[28:31], v[152:155], v[140:143]
  s_waitcnt lgkmcnt(4)
  v_mfma_f32_16x16x32_bf16 v[64:67], a[16:19], v[156:159], v[64:67]
  s_waitcnt vmcnt(9)
  s_barrier
  ds_read_b64_tr_b16 a[32:33], v17 offset:16384
  v_mfma_f32_16x16x32_bf16 v[68:71], a[20:23], v[156:159], v[68:71]
  ds_read_b64_tr_b16 a[40:41], v17 offset:24576
  v_mfma_f32_16x16x32_bf16 v[72:75], a[24:27], v[156:159], v[72:75]
  buffer_load_dwordx4 v12, s[68:71], 0 offen lds
  s_add_u32 m0, s76, 43520
  v_mfma_f32_16x16x32_bf16 v[76:79], a[28:31], v[156:159], v[76:79]
  s_waitcnt lgkmcnt(5)
  v_add_u32 v12, s72, v11
  s_add_u32 s72, s72, s75
  s_cmp_eq_u32 s72, s73
  s_cselect_b32 s72, s74, s72
  v_mfma_f32_16x16x32_bf16 v[80:83], a[16:19], v[168:171], v[80:83]
  ds_read_b64_tr_b16 a[34:35], v17 offset:17408
  v_mfma_f32_16x16x32_bf16 v[84:87], a[20:23], v[168:171], v[84:87]
  ds_read_b64_tr_b16 a[42:43], v17 offset:25600
  v_mfma_f32_16x16x32_bf16 v[88:91], a[24:27], v[168:171], v[88:91]
  buffer_load_dwordx4 v9, s[68:71], 0 offen lds
  s_add_u32 m0, s76, 58880
  v_mfma_f32_16x16x32_bf16 v[92:95], a[28:31], v[168:171], v[92:95]
  s_waitcnt lgkmcnt(6)
  ds_read_b64_tr_b16 a[36:37], v18 offset:16384
  v_add_u32 v9, 7168, v12
  v_mfma_f32_16x16x32_bf16 v[96:99], a[16:19], v[172:175], v[96:99]
  s_waitcnt vmcnt(6)
  v_cmp_ne_u32 vcc, v49, v58
  v_cmp_ne_u32 s[48:49], v51, v59
  s_nop 2
  s_or_b64 vcc, vcc, s[48:49]
  s_cbranch_scc1 L_qt0
L_rt0:
  v_mul_f32 v49, v50, v50
  ds_write_b64 v30, v[48:49]
  v_mfma_f32_16x16x32_bf16 v[100:103], a[20:23], v[172:175], v[100:103]
  buffer_load_dwordx4 v12, s[68:71], 0 offen lds
  s_add_u32 m0, s76, 59904
  v_mfma_f32_16x16x32_bf16 v[104:107], a[24:27], v[172:175], v[104:107]
  ds_read_b64_tr_b16 a[44:45], v18 offset:24576
  v_add_u32 v12, s72, v11
  s_add_u32 s72, s72, s75
  s_cmp_eq_u32 s72, s73
  s_cselect_b32 s72, s74, s72
  v_mfma_f32_16x16x32_bf16 v[108:111], a[28:31], v[172:175], v[108:111]
  s_waitcnt lgkmcnt(8)
  ds_read_b64_tr_b16 a[38:39], v18 offset:17408
  v_mfma_f32_16x16x32_bf16 v[112:115], a[16:19], v[144:147], v[112:115]
  ds_read_b64_tr_b16 a[46:47], v18 offset:25600
  v_mfma_f32_16x16x32_bf16 v[116:119], a[20:23], v[144:147], v[116:119]
  buffer_load_dwordx4 v9, s[68:71], 0 offen lds
  s_add_u32 m0, s76, 75264
  v_mfma_f32_16x16x32_bf16 v[120:123], a[24:27], v[144:147], v[120:123]
  ds_read_b128 v[152:155], v22 offset:54784
  v_add_u32 v9, 7168, v12
  v_mfma_f32_16x16x32_bf16 v[124:127], a[28:31], v[144:147], v[124:127]
  s_waitcnt lgkmcnt(7)
  ds_read_b128 v[156:159], v22 offset:56832
  v_mfma_f32_16x16x32_bf16 v[128:131], a[32:35], v[148:151], v[128:131]
  s_waitcnt lgkmcnt(3)
  ds_read_b128 v[168:171], v22 offset:58880
  v_mfma_f32_16x16x32_bf16 v[132:135], a[36:39], v[148:151], v[132:135]
  ds_read_b128 v[172:175], v22 offset:60928
  v_mfma_f32_16x16x32_bf16 v[136:139], a[40:43], v[148:151], v[136:139]
  s_waitcnt lgkmcnt(4)
  v_mfma_f32_16x16x32_bf16 v[140:143], a[44:47], v[148:151], v[140:143]
  s_waitcnt vmcnt(6)
  s_barrier
  buffer_load_dwordx4 v12, s[68:71], 0 offen lds
  s_waitcnt lgkmcnt(3)
  v_mfma_f32_16x16x32_bf16 v[64:67], a[32:35], v[152:155], v[64:67]
  s_add_u32 m0, s76, 76288
  ds_read_b64_tr_b16 a[64:65], v4 offset:0
  v_add_u32 v12, s72, v11
  s_add_u32 s72, s72, s75
  s_cmp_eq_u32 s72, s73
  s_cselect_b32 s72, s74, s72
  v_mfma_f32_16x16x32_bf16 v[68:71], a[36:39], v[152:155], v[68:71]
  ds_read_b64_tr_b16 a[66:67], v4 offset:2048
  v_mfma_f32_16x16x32_bf16 v[72:75], a[40:43], v[152:155], v[72:75]
  ds_read_b64_tr_b16 a[68:69], v5 offset:0
  v_mfma_f32_16x16x32_bf16 v[76:79], a[44:47], v[152:155], v[76:79]
  s_waitcnt lgkmcnt(5)
  ds_read_b64_tr_b16 a[70:71], v5 offset:2048
  v_mfma_f32_16x16x32_bf16 v[80:83], a[32:35], v[156:159], v[80:83]
  ds_read_b64_tr_b16 a[72:73], v6 offset:0
  v_mfma_f32_16x16x32_bf16 v[84:87], a[36:39], v[156:159], v[84:87]
  ds_read_b64_tr_b16 a[0:1], v17 offset:32768
  v_mfma_f32_16x16x32_bf16 v[88:91], a[40:43], v[156:159], v[88:91]
  ds_read_b64_tr_b16 a[8:9], v17 offset:40960
  ds_read_b64_tr_b16 a[74:75], v6 offset:2048
  ds_read_b64_tr_b16 a[2:3], v17 offset:33792
  ds_read_b64_tr_b16 a[10:11], v17 offset:41984
  buffer_load_dwordx4 v9, s[68:71], 0 offen lds
  ds_read_b64_tr_b16 a[76:77], v7 offset:0
  ds_read_b64_tr_b16 a[4:5], v18 offset:32768
  ds_read_b64_tr_b16 a[12:13], v18 offset:40960
  ds_read_b64_tr_b16 a[78:79], v7 offset:2048
  ds_read_b64_tr_b16 a[6:7], v18 offset:33792
  ds_read_b64_tr_b16 a[14:15], v18 offset:41984
  v_mfma_f32_16x16x32_bf16 v[92:95], a[44:47], v[156:159], v[92:95]
  s_waitcnt lgkmcnt(15)
  s_add_u32 m0, s76, 91648
  v_add_u32 v9, 7168, v12
  v_mfma_f32_16x16x32_bf16 v[96:99], a[32:35], v[168:171], v[96:99]
  ds_read_b128 v[144:147], v13 offset:11776
  v_mfma_f32_16x16x32_bf16 v[100:103], a[36:39], v[168:171], v[100:103]
  ds_read_b128 v[148:151], v14 offset:11776
  v_mfma_f32_16x16x32_bf16 v[104:107], a[40:43], v[168:171], v[104:107]
  s_waitcnt vmcnt(6) lgkmcnt(2)
  ds_read_b128 v[152:155], v13 offset:3584
  s_barrier
  v_mfma_f32_16x16x32_bf16 v[108:111], a[44:47], v[168:171], v[108:111]
  ds_read_b64_tr_b16 a[16:17], v19 offset:22528
  v_mfma_f32_16x16x32_bf16 v[112:115], a[32:35], v[172:175], v[112:115]
  buffer_load_dwordx4 v12, s[68:71], 0 offen lds
  s_add_u32 m0, s76, 92672
  v_mfma_f32_16x16x32_bf16 v[116:119], a[36:39], v[172:175], v[116:119]
  ds_read_b64_tr_b16 a[18:19], v19 offset:23552
  v_add_u32 v12, s72, v11
  s_add_u32 s72, s72, s75
  s_cmp_eq_u32 s72, s73
  s_cselect_b32 s72, s74, s72
  v_mfma_f32_16x16x32_bf16 v[120:123], a[40:43], v[172:175], v[120:123]
  ds_read_b64_tr_b16 a[20:21], v20 offset:22528
  v_mfma_f32_16x16x32_bf16 v[124:127], a[44:47], v[172:175], v[124:127]
  s_waitcnt lgkmcnt(5)
  ds_read_b64_tr_b16 a[22:23], v20 offset:23552
  v_mfma_f32_16x16x32_bf16 v[128:131], a[0:3], v[144:147], v[128:131]
  ds_read_b64_tr_b16 a[24:25], v19 offset:30720
  v_mfma_f32_16x16x32_bf16 v[132:135], a[4:7], v[144:147], v[132:135]
  buffer_load_dwordx4 v9, s[68:71], 0 offen lds
  s_add_u32 m0, s76, 26112
  v_mfma_f32_16x16x32_bf16 v[136:139], a[8:11], v[144:147], v[136:139]
  ds_read_b64_tr_b16 a[26:27], v19 offset:31744
  v_add_u32 v9, 7168, v12
  v_mfma_f32_16x16x32_bf16 v[140:143], a[12:15], v[144:147], v[140:143]
  s_waitcnt lgkmcnt(4)
  ds_read_b64_tr_b16 a[28:29], v20 offset:30720
  v_mfma_f32_16x16x32_bf16 v[128:131], a[16:19], v[148:151], v[128:131]
  s_waitcnt lgkmcnt(3)
  ds_read_b64_tr_b16 a[30:31], v20 offset:31744
  v_mfma_f32_16x16x32_bf16 v[132:135], a[20:23], v[148:151], v[132:135]
  s_waitcnt lgkmcnt(2)
  buffer_load_dwordx4 v12, s[68:71], 0 offen lds
  s_add_u32 m0, s76, 27136
  v_mfma_f32_16x16x32_bf16 v[136:139], a[24:27], v[148:151], v[136:139]
  ds_read_b128 v[156:159], v14 offset:3584
  v_add_u32 v12, s72, v11
  s_add_u32 s72, s72, s75
  s_cmp_eq_u32 s72, s73
  s_cselect_b32 s72, s74, s72
  s_mov_b64 exec, s[62:63]
  ds_write_b128 v34, v[128:131] offset:0
  s_mov_b64 exec, -1
  s_mov_b64 exec, s[62:63]
  ds_write_b128 v34, v[132:135] offset:16
  s_mov_b64 exec, -1
  s_waitcnt lgkmcnt(3)
  v_mfma_f32_16x16x32_bf16 v[140:143], a[28:31], v[148:151], v[140:143]
  s_mov_b64 exec, s[62:63]
  ds_write_b128 v34, v[136:139] offset:32
  s_mov_b64 exec, -1
  v_mfma_f32_16x16x32_bf16 v[64:67], a[0:3], v[152:155], v[64:67]
  ds_read_b128 v[168:171], v13 offset:5632
  v_mfma_f32_16x16x32_bf16 v[68:71], a[4:7], v[152:155], v[68:71]
  s_mov_b64 exec, s[62:63]
  s_nop 0
  ds_write_b128 v34, v[140:143] offset:48
  s_mov_b64 exec, -1
  v_mfma_f32_16x16x32_bf16 v[72:75], a[8:11], v[152:155], v[72:75]
  buffer_load_dwordx4 v9, s[68:71], 0 offen lds
  s_add_u32 m0, s76, 108032
  v_add_u32 v9, 7168, v12
  v_mfma_f32_16x16x32_bf16 v[76:79], a[12:15], v[152:155], v[76:79]
  s_waitcnt lgkmcnt(5)
  ds_read_b128 v[172:175], v14 offset:5632
  v_mfma_f32_16x16x32_bf16 v[64:67], a[16:19], v[156:159], v[64:67]
  ds_read_b128 v[144:147], v13 offset:7680
  v_mfma_f32_16x16x32_bf16 v[68:71], a[20:23], v[156:159], v[68:71]
  s_waitcnt lgkmcnt(2)
  s_barrier
  ds_read_b128 v[48:51], v34 offset:0
  v_mfma_f32_16x16x32_bf16 v[72:75], a[24:27], v[156:159], v[72:75]
  ds_read_b128 v[52:55], v34 offset:16
  ds_read_b128 v[56:59], v34 offset:32
  ds_read_b128 v[60:63], v34 offset:48
  buffer_load_dwordx4 v12, s[68:71], 0 offen lds
  v_mfma_f32_16x16x32_bf16 v[76:79], a[28:31], v[156:159], v[76:79]
  s_add_u32 m0, s76, 109056
  ds_read_b64 v[160:161], v27 offset:1280
  v_add_u32 v12, s72, v11
  s_add_u32 s72, s72, s75
  s_cmp_eq_u32 s72, s73
  s_cselect_b32 s72, s74, s72
  v_mfma_f32_16x16x32_bf16 v[80:83], a[0:3], v[168:171], v[80:83]
  ds_read_b64 v[162:163], v27 offset:768
  buffer_load_dwordx4 v9, s[68:71], 0 offen lds
  v_mfma_f32_16x16x32_bf16 v[84:87], a[4:7], v[168:171], v[84:87]
  s_add_u32 m0, s76, 124416
  ds_read_b64 v[24:25], v27 offset:896
  v_add_u32 v9, 7168, v12
  v_mfma_f32_16x16x32_bf16 v[88:91], a[8:11], v[168:171], v[88:91]
  ds_read_b64 v[28:29], v27 offset:1024
  buffer_load_dwordx4 v12, s[68:71], 0 offen lds
  v_mfma_f32_16x16x32_bf16 v[92:95], a[12:15], v[168:171], v[92:95]
  s_waitcnt lgkmcnt(3)
  ds_read_b64 v[30:31], v27 offset:1152
  s_add_u32 m0, s76, 125440
  v_add_u32 v12, s72, v11
  v_fmac_f32 v128, v48, v160
  v_fmac_f32 v129, v49, v160
  v_mfma_f32_16x16x32_bf16 v[80:83], a[16:19], v[172:175], v[80:83]
  buffer_load_dwordx4 v9, s[68:71], 0 offen lds
  s_add_u32 m0, s76, 140800
  v_add_u32 v9, 7168, v12
  v_fmac_f32 v130, v50, v160
  v_fmac_f32 v131, v51, v160
  v_mfma_f32_16x16x32_bf16 v[84:87], a[20:23], v[172:175], v[84:87]
  buffer_load_dwordx4 v12, s[68:71], 0 offen lds
  s_add_u32 m0, s76, 141824
  v_fmac_f32 v132, v52, v160
  v_fmac_f32 v133, v53, v160
  v_fmac_f32 v134, v54, v160
  v_mfma_f32_16x16x32_bf16 v[88:91], a[24:27], v[172:175], v[88:91]
  ds_read_b128 v[148:151], v14 offset:7680
  v_fmac_f32 v135, v55, v160
  v_fmac_f32 v136, v56, v160
  v_fmac_f32 v137, v57, v160
  v_fmac_f32 v138, v58, v160
  v_mfma_f32_16x16x32_bf16 v[92:95], a[28:31], v[172:175], v[92:95]
  buffer_load_dwordx4 v9, s[68:71], 0 offen lds
  v_fmac_f32 v139, v59, v160
  v_fmac_f32 v140, v60, v160
  v_fmac_f32 v141, v61, v160
  v_fmac_f32 v142, v62, v160
  v_mfma_f32_16x16x32_bf16 v[96:99], a[0:3], v[144:147], v[96:99]
  ds_read_b128 v[152:155], v13 offset:9728
  v_fmac_f32 v143, v63, v160
  v_mul_f32 v128, v128, v136
  v_mul_f32 v129, v129, v137
  v_mul_f32 v130, v130, v138
  v_mfma_f32_16x16x32_bf16 v[100:103], a[4:7], v[144:147], v[100:103]
  ds_read_b128 v[156:159], v14 offset:9728
  v_mul_f32 v131, v131, v139
  v_mul_f32 v132, v132, v140
  v_mul_f32 v133, v133, v141
  v_mul_f32 v134, v134, v142
  v_mfma_f32_16x16x32_bf16 v[104:107], a[8:11], v[144:147], v[104:107]
  v_mul_f32 v135, v135, v143
  v_mul_f32 v128, v128, v161
  v_mul_f32 v129, v129, v161
  v_mul_f32 v130, v130, v161
  v_mul_f32 v131, v131, v161
  v_mfma_f32_16x16x32_bf16 v[108:111], a[12:15], v[144:147], v[108:111]
  v_mul_f32 v132, v132, v161
  v_mul_f32 v133, v133, v161
  v_mul_f32 v134, v134, v161
  v_mul_f32 v135, v135, v161
  v_cvt_pk_bf16_f32 v136, v128, v129
  s_waitcnt lgkmcnt(2)
  v_mfma_f32_16x16x32_bf16 v[96:99], a[16:19], v[148:151], v[96:99]
  v_cvt_pk_bf16_f32 v137, v130, v131
  v_cvt_pk_bf16_f32 v138, v132, v133
  v_cvt_pk_bf16_f32 v139, v134, v135
  v_fmac_f32 v64, v48, v162
  v_fmac_f32 v65, v49, v162
  v_mfma_f32_16x16x32_bf16 v[100:103], a[20:23], v[148:151], v[100:103]
  buffer_store_dwordx4 v[136:139], v23, s[24:27], s46 offen offset:2560 sc1
  v_fmac_f32 v66, v50, v162
  v_fmac_f32 v67, v51, v162
  v_fmac_f32 v68, v52, v162
  v_fmac_f32 v69, v53, v162
  v_mfma_f32_16x16x32_bf16 v[104:107], a[24:27], v[148:151], v[104:107]
  v_fmac_f32 v70, v54, v162
  v_fmac_f32 v71, v55, v162
  v_fmac_f32 v72, v56, v162
  v_fmac_f32 v73, v57, v162
  v_fmac_f32 v74, v58, v162
  v_mfma_f32_16x16x32_bf16 v[108:111], a[28:31], v[148:151], v[108:111]
  v_fmac_f32 v75, v59, v162
  v_fmac_f32 v76, v60, v162
  v_fmac_f32 v77, v61, v162
  v_fmac_f32 v78, v62, v162
  v_fmac_f32 v79, v63, v162
  s_waitcnt lgkmcnt(1)
  v_mfma_f32_16x16x32_bf16 v[112:115], a[0:3], v[152:155], v[112:115]
  v_mul_f32 v64, v64, v72
  v_mul_f32 v65, v65, v73
  v_mul_f32 v66, v66, v74
  v_mul_f32 v67, v67, v75
  v_mul_f32 v68, v68, v76
  v_mfma_f32_16x16x32_bf16 v[116:119], a[4:7], v[152:155], v[116:119]
  v_mul_f32 v69, v69, v77
  v_mul_f32 v70, v70, v78
  v_mul_f32 v71, v71, v79
  v_mul_f32 v64, v64, v163
  v_mul_f32 v65, v65, v163
  v_mfma_f32_16x16x32_bf16 v[120:123], a[8:11], v[152:155], v[120:123]
  v_mul_f32 v66, v66, v163
  v_mul_f32 v67, v67, v163
  v_mul_f32 v68, v68, v163
  v_mul_f32 v69, v69, v163
  v_mul_f32 v70, v70, v163
  v_mfma_f32_16x16x32_bf16 v[124:127], a[12:15], v[152:155], v[124:127]
  v_mul_f32 v71, v71, v163
  v_cvt_pk_bf16_f32 v72, v64, v65
  v_cvt_pk_bf16_f32 v73, v66, v67
  v_cvt_pk_bf16_f32 v74, v68, v69
  v_cvt_pk_bf16_f32 v75, v70, v71
  s_waitcnt lgkmcnt(0)
  v_mfma_f32_16x16x32_bf16 v[112:115], a[16:19], v[156:159], v[112:115]
  buffer_store_dwordx4 v[72:75], v23, s[24:27], s46 offen offset:1536 sc1
  v_fmac_f32 v80, v48, v24
  v_fmac_f32 v81, v49, v24
  v_fmac_f32 v82, v50, v24
  v_fmac_f32 v83, v51, v24
  v_mfma_f32_16x16x32_bf16 v[116:119], a[20:23], v[156:159], v[116:119]
  v_fmac_f32 v84, v52, v24
  v_fmac_f32 v85, v53, v24
  v_fmac_f32 v86, v54, v24
  v_fmac_f32 v87, v55, v24
  v_fmac_f32 v88, v56, v24
  v_mfma_f32_16x16x32_bf16 v[120:123], a[24:27], v[156:159], v[120:123]
  v_fmac_f32 v89, v57, v24
  v_fmac_f32 v90, v58, v24
  v_fmac_f32 v91, v59, v24
  v_fmac_f32 v92, v60, v24
  v_fmac_f32 v93, v61, v24
  v_mfma_f32_16x16x32_bf16 v[124:127], a[28:31], v[156:159], v[124:127]
  v_fmac_f32 v94, v62, v24
  v_fmac_f32 v95, v63, v24
  v_mul_f32 v80, v80, v88
  v_mul_f32 v81, v81, v89
  v_mul_f32 v82, v82, v90
  v_mul_f32 v83, v83, v91
  v_mul_f32 v84, v84, v92
  v_mul_f32 v85, v85, v93
  v_mul_f32 v86, v86, v94
  v_mul_f32 v87, v87, v95
  v_mul_f32 v80, v80, v25
  v_mul_f32 v81, v81, v25
  v_mul_f32 v82, v82, v25
  v_mul_f32 v83, v83, v25
  v_mul_f32 v84, v84, v25
  v_mul_f32 v85, v85, v25
  v_mul_f32 v86, v86, v25
  v_mul_f32 v87, v87, v25
  v_cvt_pk_bf16_f32 v88, v80, v81
  v_cvt_pk_bf16_f32 v89, v82, v83
  v_cvt_pk_bf16_f32 v90, v84, v85
  v_cvt_pk_bf16_f32 v91, v86, v87
  buffer_store_dwordx4 v[88:91], v23, s[24:27], s46 offen offset:1792 sc1
  v_fmac_f32 v96, v48, v28
  v_fmac_f32 v97, v49, v28
  v_fmac_f32 v98, v50, v28
  v_fmac_f32 v99, v51, v28
  v_fmac_f32 v100, v52, v28
  v_fmac_f32 v101, v53, v28
  v_fmac_f32 v102, v54, v28
  v_fmac_f32 v103, v55, v28
  v_fmac_f32 v104, v56, v28
  v_fmac_f32 v105, v57, v28
  v_fmac_f32 v106, v58, v28
  v_fmac_f32 v107, v59, v28
  v_fmac_f32 v108, v60, v28
  v_fmac_f32 v109, v61, v28
  v_fmac_f32 v110, v62, v28
  v_fmac_f32 v111, v63, v28
  v_mul_f32 v96, v96, v104
  v_mul_f32 v97, v97, v105
  v_mul_f32 v98, v98, v106
  v_mul_f32 v99, v99, v107
  v_mul_f32 v100, v100, v108
  v_mul_f32 v101, v101, v109
  v_mul_f32 v102, v102, v110
  v_mul_f32 v103, v103, v111
  v_mul_f32 v96, v96, v29
  v_mul_f32 v97, v97, v29
  v_mul_f32 v98, v98, v29
  v_mul_f32 v99, v99, v29
  v_mul_f32 v100, v100, v29
  v_mul_f32 v101, v101, v29
  v_mul_f32 v102, v102, v29
  v_mul_f32 v103, v103, v29
  v_cvt_pk_bf16_f32 v104, v96, v97
  v_cvt_pk_bf16_f32 v105, v98, v99
  v_cvt_pk_bf16_f32 v106, v100, v101
  v_cvt_pk_bf16_f32 v107, v102, v103
  buffer_store_dwordx4 v[104:107], v23, s[24:27], s46 offen offset:2048 sc1
  v_fmac_f32 v112, v48, v30
  v_fmac_f32 v113, v49, v30
  v_fmac_f32 v114, v50, v30
  v_fmac_f32 v115, v51, v30
  v_fmac_f32 v116, v52, v30
  v_fmac_f32 v117, v53, v30
  v_fmac_f32 v118, v54, v30
  v_fmac_f32 v119, v55, v30
  v_fmac_f32 v120, v56, v30
  v_fmac_f32 v121, v57, v30
  v_fmac_f32 v122, v58, v30
  v_fmac_f32 v123, v59, v30
  v_fmac_f32 v124, v60, v30
  v_fmac_f32 v125, v61, v30
  v_fmac_f32 v126, v62, v30
  v_fmac_f32 v127, v63, v30
  v_mul_f32 v112, v112, v120
  v_mul_f32 v113, v113, v121
  v_mul_f32 v114, v114, v122
  v_mul_f32 v115, v115, v123
  v_mul_f32 v116, v116, v124
  v_mul_f32 v117, v117, v125
  v_mul_f32 v118, v118, v126
  v_mul_f32 v119, v119, v127
  v_mul_f32 v112, v112, v31
  v_mul_f32 v113, v113, v31
  v_mul_f32 v114, v114, v31
  v_mul_f32 v115, v115, v31
  v_mul_f32 v116, v116, v31
  v_mul_f32 v117, v117, v31
  v_mul_f32 v118, v118, v31
  v_mul_f32 v119, v119, v31
  v_cvt_pk_bf16_f32 v120, v112, v113
  v_cvt_pk_bf16_f32 v121, v114, v115
  v_cvt_pk_bf16_f32 v122, v116, v117
  v_cvt_pk_bf16_f32 v123, v118, v119
  buffer_store_dwordx4 v[120:123], v23, s[24:27], s46 offen offset:2304 sc1
  s_waitcnt vmcnt(13)
  s_add_u32 s72, s72, s75
  s_cmp_eq_u32 s72, s73
  s_cselect_b32 s72, s74, s72
  v_mov_b32 v28, v164
  v_mov_b32 v29, v165
  s_branch L_s2
L_att0:
  s_add_u32 m0, s41, 112128
  s_nop 0
  buffer_load_dwordx4 v33, s[16:19], s64 offen offset:0 lds
  s_add_u32 m0, s41, 119424
  s_nop 0
  buffer_load_dwordx4 v33, s[16:19], s64 offen offset:896 lds
  s_add_u32 m0, s41, 126720
  s_nop 0
  buffer_load_dwordx4 v33, s[16:19], s64 offen offset:1792 lds
  v_lshlrev_b32 v5, 7, v2
  v_add_u32 v5, 0, v5
  v_lshrrev_b32 v4, 1, v2
  v_xor_b32 v4, v4, v3
  v_lshl_add_u32 v13, v4, 4, v5
  v_bfe_u32 v4, v1, 2, 2
  v_lshl_add_u32 v5, v3, 3, v4
  v_lshlrev_b32 v5, 8, v5
  v_add_u32 v5, 56832, v5
  v_and_b32 v6, 1, v3
  v_lshl_add_u32 v4, v6, 2, v4
  v_lshlrev_b32 v4, 5, v4
  v_and_b32 v6, 3, v1
  s_mul_i32 s52, s29, 56
  v_lshl_add_u32 v7, v6, 3, s52
  v_xor_b32 v8, v7, v4
  v_add_u32 v17, v8, v5
  s_waitcnt vmcnt(3)
  s_barrier
  ds_read_b64_tr_b16 a[8:9], v17 offset:24576
  ds_read_b64_tr_b16 a[10:11], v17 offset:25600
  ds_read_b128 v[36:39], v13 offset:48640
  ds_read_b64_tr_b16 a[0:1], v17 offset:16384
  ds_read_b64_tr_b16 a[2:3], v17 offset:17408
  ds_read_b64_tr_b16 a[16:17], v17 offset:32768
  ds_read_b64_tr_b16 a[18:19], v17 offset:33792
  ds_read_b128 v[40:43], v13 offset:42496
  ds_read_b128 v[80:83], v13 offset:44544
  ds_read_b128 v[84:87], v13 offset:46592
  s_waitcnt lgkmcnt(7)
  v_mfma_f32_16x16x32_bf16 v[136:139], a[8:11], v[36:39], 0
  s_mov_b32 s64, 172032
  v_add_u32 v7, 32, v7
  v_cmp_eq_u32 vcc, 3, v6
  s_add_u32 m0, s41, 136704
  s_mul_i32 s52, s29, 135168
  s_mov_b32 s66, 1463426304
  v_mov_b32 v8, 224
  v_cndmask_b32 v7, v7, v8, vcc
  v_xor_b32 v8, v7, v4
  v_add_u32 v18, v8, v5
  ds_read_b64_tr_b16 a[12:13], v18 offset:24576
  ds_read_b64_tr_b16 a[14:15], v18 offset:25600
  ds_read_b64_tr_b16 a[4:5], v18 offset:16384
  ds_read_b64_tr_b16 a[6:7], v18 offset:17408
  ds_read_b64_tr_b16 a[20:21], v18 offset:32768
  ds_read_b64_tr_b16 a[22:23], v18 offset:33792
  v_add_u32 v19, 49152, v17
  v_xor_b32 v14, 64, v13
  ds_read_b128 v[60:63], v14 offset:48640
  v_add_u32 v20, 49152, v18
  ds_read_b128 v[56:59], v14 offset:42496
  ds_read_b128 v[52:55], v14 offset:44544
  v_add_u32 v21, 65536, v13
  v_add_u32 v22, 65536, v14
  v_mul_u32_u24 v4, 33792, v3
  v_lshl_add_u32 v44, v2, 4, v4
  v_lshlrev_b32 v4, 2, v3
  v_sub_u32 v4, v2, v4
  v_subrev_u32 v6, 0, v4
  v_and_b32 v7, 0x80000001, v6
  v_mov_b32 v5, 0xff800000
  v_cmp_eq_u32 vcc, 0, v7
  s_nop 1
  v_cndmask_b32 v160, v5, 0, vcc
  v_cmp_eq_u32 vcc, 0x80000000, v7
  v_subrev_u32 v6, 1, v4
  s_nop 0
  v_cndmask_b32 v164, v5, 0, vcc
  v_and_b32 v7, 0x80000001, v6
  v_cmp_eq_u32 vcc, 0, v7
  s_nop 1
  v_cndmask_b32 v161, v5, 0, vcc
  s_waitcnt lgkmcnt(7)
  v_mfma_f32_16x16x32_bf16 v[140:143], a[12:15], v[36:39], 0
  s_mov_b32 s67, 488447261
  buffer_load_dwordx4 v32, s[16:19], s64 offen offset:0 lds
  s_add_u32 m0, s41, 144000
  s_add_u32 s46, s46, s52
  s_cmp_ge_u32 s56, 4
  s_cselect_b32 s66, 3417215348, s66
  s_cselect_b32 s67, 471670045, s67
  v_mfma_f32_16x16x32_bf16 v[152:155], a[0:3], v[36:39], 0
  v_cmp_eq_u32 vcc, 0x80000000, v7
  v_subrev_u32 v6, 2, v4
  s_lshl_b32 s47, s56, 3
  s_lshl_b32 s52, s29, 8
  s_lshr_b32 s66, s66, s47
  s_waitcnt lgkmcnt(5)
  v_mfma_f32_16x16x32_bf16 v[156:159], a[4:7], v[36:39], 0
  s_lshr_b32 s67, s67, s47
  v_cndmask_b32 v165, v5, 0, vcc
  v_and_b32 v7, 0x80000001, v6
  s_add_u32 s52, s52, 1536
  s_and_b32 s47, s66, 255
  s_add_u32 s47, s47, s57
  v_mfma_f32_16x16x32_bf16 v[144:147], v[36:39], a[16:19], 0
  buffer_load_dwordx4 v32, s[16:19], s64 offen offset:896 lds
  s_add_u32 m0, s41, 151296
  s_mul_i32 s66, s47, 9363
  s_and_b32 s77, s67, 255
  s_lshr_b32 s66, s66, 16
  s_waitcnt lgkmcnt(3)
  v_mfma_f32_16x16x32_bf16 v[148:151], v[36:39], a[20:23], 0
  s_mul_i32 s67, s66, 7
  v_cmp_eq_u32 vcc, 0, v7
  s_nop 1
  v_cndmask_b32 v162, v5, 0, vcc
  s_sub_u32 s67, s47, s67
  s_cmp_ge_u32 s30, 6
  s_mov_b32 s42, 9474192
  s_cselect_b32 s42, 8421504, s42
  v_mfma_f32_16x16x32_bf16 v[64:67], a[8:11], v[40:43], 0
  s_lshl_b32 s72, s67, 2
  ds_read_b128 v[36:39], v14 offset:46592
  v_cmp_eq_u32 vcc, 0x80000000, v7
  s_cmp_ge_u32 s30, 6
  s_cselect_b32 s75, 28, 32
  s_cselect_b32 s73, 16, 19
  s_cselect_b32 s74, 0, s32
  v_mfma_f32_16x16x32_bf16 v[68:71], a[12:15], v[40:43], 0
  s_lshr_b32 s42, s42, s72
  buffer_load_dwordx4 v32, s[16:19], s64 offen offset:1792 lds
  s_add_u32 m0, s41, 97664
  s_mul_i32 s75, s75, 896
  s_and_b32 s42, s42, 15
  s_mul_i32 s47, s31, 14336
  v_mfma_f32_16x16x32_bf16 v[72:75], v[40:43], a[16:19], 0
  s_mov_b32 s10, 1605632
  v_subrev_u32 v6, 3, v4
  v_cndmask_b32 v166, v5, 0, vcc
  s_mov_b32 s6, 401408
  s_mul_i32 s74, s74, 544768
  s_mul_i32 s72, s42, s75
  v_mfma_f32_16x16x32_bf16 v[76:79], v[40:43], a[20:23], 0
  s_add_u32 s72, s72, s74
  v_and_b32 v7, 0x80000001, v6
  v_cmp_eq_u32 vcc, 0, v7
  s_cmp_ge_u32 s30, 6
  s_cselect_b32 s68, s4, s8
  s_cselect_b32 s69, s5, s9
  s_cselect_b32 s70, s6, s10
  v_mfma_f32_16x16x32_bf16 v[88:91], a[8:11], v[80:83], 0
  s_lshl_b32 s76, s30, 11
  buffer_load_dwordx4 v10, s[12:15], s34 offen offset:128 lds
  s_add_u32 m0, s41, 105856
  s_cmp_ge_u32 s57, s77
  s_cselect_b32 s70, 0, s70
  s_mov_b32 s71, 0x20000
  v_mfma_f32_16x16x32_bf16 v[92:95], a[12:15], v[80:83], 0
  s_mul_i32 s73, s73, s75
  v_cndmask_b32 v163, v5, 0, vcc
  v_cmp_eq_u32 vcc, 0x80000000, v7
  s_add_u32 s73, s73, s74
  s_mov_b32 s27, 0x20000
  s_mov_b32 s26, 9797632
  v_mfma_f32_16x16x32_bf16 v[104:107], a[0:3], v[80:83], 0
  s_mov_b32 s11, 0x20000
  v_cndmask_b32 v167, v5, 0, vcc
  v_and_b32 v6, 1, v2
  s_mov_b32 s7, 0x20000
  s_mov_b32 s3, 896
  s_mov_b32 s62, 0x80008000
  v_mfma_f32_16x16x32_bf16 v[108:111], a[4:7], v[80:83], 0
  s_mov_b32 s63, 0x80008000
  buffer_load_dwordx4 v10, s[12:15], s35 offen offset:128 lds
  s_add_u32 m0, s41, 56832
  s_mov_b32 s38, 0
  s_mov_b32 s39, 0xffff0000
  v_mfma_f32_16x16x32_bf16 v[96:99], v[80:83], a[16:19], 0
  v_cmp_eq_u32 vcc, 1, v6
  v_mov_b32 v7, 0xffff
  v_mfma_f32_16x16x32_bf16 v[100:103], v[80:83], a[20:23], 0
  v_mov_b32 v8, 0xffff0000
  v_lshl_add_u32 v34, v3, 6, s52
  s_lshl_b32 s52, s29, 7
  s_add_u32 s52, s52, 2560
  v_mfma_f32_16x16x32_bf16 v[112:115], a[8:11], v[84:87], 0
  s_waitcnt vmcnt(5)
  s_barrier
  ds_read_b64_tr_b16 a[32:33], v19 offset:14336
  v_mfma_f32_16x16x32_bf16 v[116:119], a[12:15], v[84:87], 0
  ds_read_b64_tr_b16 a[34:35], v19 offset:15360
  v_cndmask_b32 v7, v7, v8, vcc
  v_mfma_f32_16x16x32_bf16 v[128:131], a[0:3], v[84:87], 0
  buffer_load_dwordx4 v33, s[16:19], s64 offen offset:0 lds
  s_add_u32 m0, s41, 64128
  v_mfma_f32_16x16x32_bf16 v[132:135], a[4:7], v[84:87], 0
  ds_read_b64_tr_b16 a[36:37], v20 offset:14336
  v_lshl_add_u32 v6, v3, 2, v6
  v_mfma_f32_16x16x32_bf16 v[120:123], v[84:87], a[16:19], 0
  ds_read_b64_tr_b16 a[38:39], v20 offset:15360
  v_add_u32 v8, 0, v6
  ds_read_b64_tr_b16 a[24:25], v19 offset:6144
  v_mfma_f32_16x16x32_bf16 v[124:127], v[84:87], a[20:23], 0
  s_waitcnt lgkmcnt(3)
  ds_read_b64_tr_b16 a[26:27], v19 offset:7168
  v_cmp_gt_u32 vcc, v8, v2
  ds_read_b64_tr_b16 a[28:29], v20 offset:6144
  v_mfma_f32_16x16x32_bf16 v[136:139], a[32:35], v[60:63], v[136:139]
  ds_read_b64_tr_b16 a[30:31], v20 offset:7168
  v_subrev_u32 v9, 16, v8
  ds_read_b64_tr_b16 a[40:41], v19 offset:22528
  ds_read_b64_tr_b16 a[42:43], v19 offset:23552
  buffer_load_dwordx4 v33, s[16:19], s64 offen offset:896 lds
  ds_read_b64_tr_b16 a[44:45], v20 offset:22528
  ds_read_b64_tr_b16 a[46:47], v20 offset:23552
  s_add_u32 m0, s41, 71424
  v_cndmask_b32 v168, v164, v5, s[54:55]
  s_waitcnt lgkmcnt(8)
  v_mfma_f32_16x16x32_bf16 v[140:143], a[36:39], v[60:63], v[140:143]
  s_waitcnt lgkmcnt(6)
  v_cndmask_b32 v169, v165, v5, s[54:55]
  v_cndmask_b32 v170, v166, v5, s[54:55]
  v_mfma_f32_16x16x32_bf16 v[152:155], a[24:27], v[60:63], v[152:155]
  s_waitcnt lgkmcnt(4)
  v_cndmask_b32 v171, v167, v5, s[54:55]
  v_cndmask_b32 v8, v8, v9, vcc
  v_mfma_f32_16x16x32_bf16 v[156:159], a[28:31], v[60:63], v[156:159]
  v_lshl_add_u32 v24, v2, 3, s52
  v_lshlrev_b32 v8, 2, v8
  s_lshl_b32 s52, s29, 11
  s_add_u32 s52, s52, 17920
  s_waitcnt lgkmcnt(2)
  v_mfma_f32_16x16x32_bf16 v[144:147], v[60:63], a[40:43], v[144:147]
  s_waitcnt lgkmcnt(0)
  v_lshlrev_b32 v4, 1, v3
  v_and_b32 v5, 7, v1
  v_mfma_f32_16x16x32_bf16 v[148:151], v[60:63], a[44:47], v[148:151]
  buffer_load_dwordx4 v33, s[16:19], s64 offen offset:1792 lds
  s_mov_b32 s64, 344064
  s_add_u32 m0, s41, 81408
  v_mfma_f32_16x16x32_bf16 v[64:67], a[32:35], v[56:59], v[64:67]
  v_add_u32 v25, 1024, v8
  v_xor_b32 v4, v4, v5
  v_mfma_f32_16x16x32_bf16 v[68:71], a[36:39], v[56:59], v[68:71]
  v_add_u32 v8, 2, v6
  v_lshl_add_u32 v45, v1, 4, s52
  s_lshl_b32 s52, s67, 7
  s_add_u32 s47, s47, s52
  v_mfma_f32_16x16x32_bf16 v[72:75], v[56:59], a[40:43], v[72:75]
  v_lshrrev_b32 v5, 3, v1
  v_mul_u32_u24 v6, 896, v5
  v_mfma_f32_16x16x32_bf16 v[76:79], v[56:59], a[44:47], v[76:79]
  v_lshl_add_u32 v6, v4, 4, v6
  v_add_u32 v11, s47, v6
  s_lshl_b32 s47, s32, 12
  s_add_u32 s47, s47, 26112
  v_mfma_f32_16x16x32_bf16 v[88:91], a[32:35], v[52:55], v[88:91]
  buffer_load_dwordx4 v32, s[16:19], s64 offen offset:0 lds
  s_add_u32 m0, s41, 88704
  v_mfma_f32_16x16x32_bf16 v[92:95], a[36:39], v[52:55], v[92:95]
  v_add_u32 v12, s72, v11
  v_cndmask_b32 v172, 0, v7, vcc
  s_add_u32 s72, s72, s75
  s_cmp_eq_u32 s72, s73
  s_cselect_b32 s72, s74, s72
  v_mfma_f32_16x16x32_bf16 v[104:107], a[24:27], v[52:55], v[104:107]
  v_cndmask_b32 v174, v7, 0, vcc
  v_cmp_gt_u32 vcc, v8, v2
  v_mfma_f32_16x16x32_bf16 v[108:111], a[28:31], v[52:55], v[108:111]
  v_subrev_u32 v9, 16, v8
  v_cndmask_b32 v8, v8, v9, vcc
  v_mfma_f32_16x16x32_bf16 v[96:99], v[52:55], a[40:43], v[96:99]
  v_add_u32 v9, 7168, v12
  v_cndmask_b32 v173, 0, v7, vcc
  v_mfma_f32_16x16x32_bf16 v[100:103], v[52:55], a[44:47], v[100:103]
  v_cndmask_b32 v175, v7, 0, vcc
  v_lshrrev_b32 v6, 2, v1
  v_mfma_f32_16x16x32_bf16 v[112:115], a[32:35], v[36:39], v[112:115]
  v_lshlrev_b32 v6, 7, v6
  v_and_b32 v7, 3, v1
  v_mfma_f32_16x16x32_bf16 v[116:119], a[36:39], v[36:39], v[116:119]
  v_lshl_add_u32 v6, v7, 3, v6
  v_bfe_u32 v7, v1, 3, 2
  v_mfma_f32_16x16x32_bf16 v[128:131], a[24:27], v[36:39], v[128:131]
  v_xor_b32 v7, s32, v7
  v_lshl_add_u32 v6, v7, 5, v6
  v_mfma_f32_16x16x32_bf16 v[132:135], a[28:31], v[36:39], v[132:135]
  s_waitcnt vmcnt(4)
  s_barrier
  buffer_load_dwordx4 v32, s[16:19], s64 offen offset:896 lds
  s_add_u32 m0, s41, 110336
  ds_read_b64_tr_b16 a[8:9], v19 offset:38912
  ds_read_b64_tr_b16 a[10:11], v19 offset:39936
  ds_read_b128 v[40:43], v21 offset:38400
  ds_read_b64_tr_b16 a[12:13], v20 offset:38912
  v_mfma_f32_16x16x32_bf16 v[120:123], v[36:39], a[40:43], v[120:123]
  ds_read_b64_tr_b16 a[14:15], v20 offset:39936
  v_add_u32 v4, s47, v6
  buffer_load_dwordx4 v32, s[16:19], s64 offen offset:1792 lds
  ds_read_b64_tr_b16 a[0:1], v19 offset:30720
  v_mfma_f32_16x16x32_bf16 v[124:127], v[36:39], a[44:47], v[124:127]
  ds_read_b64_tr_b16 a[2:3], v19 offset:31744
  s_add_u32 m0, s41, 25856
  ds_read_b64_tr_b16 a[4:5], v20 offset:30720
  ds_read_b64_tr_b16 a[6:7], v20 offset:31744
  ds_read_b64_tr_b16 a[16:17], v19 offset:47104
  ds_read_b64_tr_b16 a[18:19], v19 offset:48128
  ds_read_b64_tr_b16 a[20:21], v20 offset:47104
  ds_read_b64_tr_b16 a[22:23], v20 offset:48128
  ds_read_b128 v[80:83], v21 offset:32256
  ds_read_b128 v[84:87], v21 offset:34304
  ds_read_b128 v[60:63], v21 offset:36352
  ds_read_b128 v[56:59], v22 offset:38400
  ds_read_b128 v[52:55], v22 offset:32256
  s_waitcnt lgkmcnt(15)
  v_mfma_f32_16x16x32_bf16 v[136:139], a[8:11], v[40:43], v[136:139]
  s_waitcnt lgkmcnt(13)
  ds_read_b128 v[36:39], v22 offset:34304
  v_xor_b32 v5, 32, v4
  v_mfma_f32_16x16x32_bf16 v[140:143], a[12:15], v[40:43], v[140:143]
  s_waitcnt lgkmcnt(12)
  buffer_load_dwordx4 v10, s[12:15], s34 offen offset:256 lds
  s_add_u32 m0, s41, 34048
  v_mfma_f32_16x16x32_bf16 v[152:155], a[0:3], v[40:43], v[152:155]
  s_waitcnt lgkmcnt(10)
  v_xor_b32 v6, 64, v4
  v_xor_b32 v7, 96, v4
  v_mfma_f32_16x16x32_bf16 v[156:159], a[4:7], v[40:43], v[156:159]
  s_waitcnt lgkmcnt(8)
  v_lshlrev_b32 v27, 2, v2
  v_lshlrev_b32 v8, 2, v8
  v_mfma_f32_16x16x32_bf16 v[144:147], v[40:43], a[16:19], v[144:147]
  s_waitcnt lgkmcnt(6)
  v_add_u32 v26, 1024, v8
  v_lshlrev_b32 v8, 4, v3
  v_mfma_f32_16x16x32_bf16 v[148:151], v[40:43], a[20:23], v[148:151]
  s_waitcnt lgkmcnt(5)
  buffer_load_dwordx4 v10, s[12:15], s35 offen offset:256 lds
  s_add_u32 m0, s41, 120320
  v_mfma_f32_16x16x32_bf16 v[64:67], a[8:11], v[80:83], v[64:67]
  ds_read_b128 v[40:43], v22 offset:36352
  v_mfma_f32_16x16x32_bf16 v[68:71], a[12:15], v[80:83], v[68:71]
  v_mfma_f32_16x16x32_bf16 v[72:75], v[80:83], a[16:19], v[72:75]
  v_mfma_f32_16x16x32_bf16 v[76:79], v[80:83], a[20:23], v[76:79]
  s_waitcnt lgkmcnt(5)
  buffer_load_dwordx4 v33, s[16:19], s64 offen offset:0 lds
  s_add_u32 m0, s41, 127616
  v_mfma_f32_16x16x32_bf16 v[88:91], a[8:11], v[84:87], v[88:91]
  v_mfma_f32_16x16x32_bf16 v[92:95], a[12:15], v[84:87], v[92:95]
  v_mfma_f32_16x16x32_bf16 v[104:107], a[0:3], v[84:87], v[104:107]
  s_waitcnt vmcnt(6)
  s_barrier
  ds_read_b64_tr_b16 a[32:33], v17 offset:8192
  v_mfma_f32_16x16x32_bf16 v[108:111], a[4:7], v[84:87], v[108:111]
  buffer_load_dwordx4 v33, s[16:19], s64 offen offset:896 lds
  s_add_u32 m0, s41, 134912
  v_mfma_f32_16x16x32_bf16 v[96:99], v[84:87], a[16:19], v[96:99]
  ds_read_b64_tr_b16 a[34:35], v17 offset:9216
  v_mfma_f32_16x16x32_bf16 v[100:103], v[84:87], a[20:23], v[100:103]
  s_waitcnt lgkmcnt(6)
  ds_read_b64_tr_b16 a[36:37], v18 offset:8192
  v_mfma_f32_16x16x32_bf16 v[112:115], a[8:11], v[60:63], v[112:115]
  ds_read_b64_tr_b16 a[38:39], v18 offset:9216
  v_mfma_f32_16x16x32_bf16 v[116:119], a[12:15], v[60:63], v[116:119]
  buffer_load_dwordx4 v33, s[16:19], s64 offen offset:1792 lds
  s_mov_b32 s64, 516096
  s_add_u32 m0, s41, 144896
  v_mfma_f32_16x16x32_bf16 v[128:131], a[0:3], v[60:63], v[128:131]
  ds_read_b64_tr_b16 a[24:25], v17 offset:0
  v_mfma_f32_16x16x32_bf16 v[132:135], a[4:7], v[60:63], v[132:135]
  ds_read_b64_tr_b16 a[26:27], v17 offset:1024
  v_mfma_f32_16x16x32_bf16 v[120:123], v[60:63], a[16:19], v[120:123]
  ds_read_b64_tr_b16 a[28:29], v18 offset:0
  v_mfma_f32_16x16x32_bf16 v[124:127], v[60:63], a[20:23], v[124:127]
  s_waitcnt lgkmcnt(5)
  buffer_load_dwordx4 v32, s[16:19], s64 offen offset:0 lds
  s_add_u32 m0, s41, 152192
  v_mfma_f32_16x16x32_bf16 v[136:139], a[32:35], v[56:59], v[136:139]
  s_waitcnt lgkmcnt(3)
  ds_read_b64_tr_b16 a[30:31], v18 offset:1024
  ds_read_b64_tr_b16 a[40:41], v17 offset:16384
  v_mfma_f32_16x16x32_bf16 v[140:143], a[36:39], v[56:59], v[140:143]
  s_waitcnt lgkmcnt(3)
  ds_read_b64_tr_b16 a[42:43], v17 offset:17408
  ds_read_b64_tr_b16 a[44:45], v18 offset:16384
  v_mfma_f32_16x16x32_bf16 v[152:155], a[24:27], v[56:59], v[152:155]
  s_waitcnt lgkmcnt(3)
  ds_read_b64_tr_b16 a[46:47], v18 offset:17408
  v_mfma_f32_16x16x32_bf16 v[156:159], a[28:31], v[56:59], v[156:159]
  s_waitcnt lgkmcnt(2)
  buffer_load_dwordx4 v32, s[16:19], s64 offen offset:896 lds
  s_add_u32 m0, s41, 3200
  v_mfma_f32_16x16x32_bf16 v[144:147], v[56:59], a[40:43], v[144:147]
  s_waitcnt lgkmcnt(0)
  v_mfma_f32_16x16x32_bf16 v[148:151], v[56:59], a[44:47], v[148:151]
  v_mfma_f32_16x16x32_bf16 v[64:67], a[32:35], v[52:55], v[64:67]
  v_mfma_f32_16x16x32_bf16 v[68:71], a[36:39], v[52:55], v[68:71]
  buffer_load_dwordx4 v10, s[12:15], s34 offen offset:384 lds
  s_add_u32 m0, s41, 55040
  v_mfma_f32_16x16x32_bf16 v[72:75], v[52:55], a[40:43], v[72:75]
  v_mfma_f32_16x16x32_bf16 v[76:79], v[52:55], a[44:47], v[76:79]
  v_mfma_f32_16x16x32_bf16 v[88:91], a[32:35], v[36:39], v[88:91]
  v_mfma_f32_16x16x32_bf16 v[92:95], a[36:39], v[36:39], v[92:95]
  s_waitcnt vmcnt(6)
  s_barrier
  buffer_load_dwordx4 v32, s[16:19], s64 offen offset:1792 lds
  s_add_u32 m0, s41, 11392
  v_mfma_f32_16x16x32_bf16 v[104:107], a[24:27], v[36:39], v[104:107]
  ds_read_b64_tr_b16 a[8:9], v17 offset:32768
  v_mfma_f32_16x16x32_bf16 v[108:111], a[28:31], v[36:39], v[108:111]
  ds_read_b64_tr_b16 a[10:11], v17 offset:33792
  v_mfma_f32_16x16x32_bf16 v[96:99], v[36:39], a[40:43], v[96:99]
  ds_read_b128 v[80:83], v13 offset:32256
  v_mfma_f32_16x16x32_bf16 v[100:103], v[36:39], a[44:47], v[100:103]
  buffer_load_dwordx4 v10, s[12:15], s35 offen offset:384 lds
  s_add_u32 m0, s41, 65024
  v_mfma_f32_16x16x32_bf16 v[112:115], a[32:35], v[40:43], v[112:115]
  ds_read_b64_tr_b16 a[12:13], v18 offset:32768
  v_mfma_f32_16x16x32_bf16 v[116:119], a[36:39], v[40:43], v[116:119]
  ds_read_b64_tr_b16 a[14:15], v18 offset:33792
  v_mfma_f32_16x16x32_bf16 v[128:131], a[24:27], v[40:43], v[128:131]
  ds_read_b64_tr_b16 a[0:1], v17 offset:24576
  v_mfma_f32_16x16x32_bf16 v[132:135], a[28:31], v[40:43], v[132:135]
  buffer_load_dwordx4 v33, s[16:19], s64 offen offset:0 lds
  s_add_u32 m0, s41, 72320
  v_mfma_f32_16x16x32_bf16 v[120:123], v[40:43], a[40:43], v[120:123]
  ds_read_b64_tr_b16 a[2:3], v17 offset:25600
  v_mfma_f32_16x16x32_bf16 v[124:127], v[40:43], a[44:47], v[124:127]
  s_waitcnt lgkmcnt(4)
  ds_read_b64_tr_b16 a[4:5], v18 offset:24576
  v_mfma_f32_16x16x32_bf16 v[136:139], a[8:11], v[80:83], v[136:139]
  s_waitcnt lgkmcnt(3)
  ds_read_b64_tr_b16 a[6:7], v18 offset:25600
  ds_read_b64_tr_b16 a[16:17], v19 offset:6144
  v_mfma_f32_16x16x32_bf16 v[140:143], a[12:15], v[80:83], v[140:143]
  s_waitcnt lgkmcnt(3)
  ds_read_b64_tr_b16 a[18:19], v19 offset:7168
  buffer_load_dwordx4 v33, s[16:19], s64 offen offset:896 lds
  ds_read_b64_tr_b16 a[20:21], v20 offset:6144
  v_mfma_f32_16x16x32_bf16 v[152:155], a[0:3], v[80:83], v[152:155]
  ds_read_b64_tr_b16 a[22:23], v20 offset:7168
  s_add_u32 m0, s41, 41984
  ds_read_b128 v[84:87], v13 offset:26112
  ds_read_b128 v[60:63], v13 offset:28160
  ds_read_b128 v[56:59], v13 offset:30208
  ds_read_b128 v[52:55], v14 offset:32256
  ds_read_b128 v[36:39], v14 offset:26112
  ds_read_b128 v[40:43], v14 offset:28160
  s_waitcnt lgkmcnt(10)
  v_mfma_f32_16x16x32_bf16 v[156:159], a[4:7], v[80:83], v[156:159]
  s_waitcnt lgkmcnt(8)
  v_mfma_f32_16x16x32_bf16 v[144:147], v[80:83], a[16:19], v[144:147]
  s_waitcnt lgkmcnt(6)
  v_mfma_f32_16x16x32_bf16 v[148:151], v[80:83], a[20:23], v[148:151]
  s_waitcnt lgkmcnt(5)
  buffer_load_dwordx4 v10, s[12:15], s34 offen offset:512 lds
  s_add_u32 m0, s41, 79616
  v_mfma_f32_16x16x32_bf16 v[64:67], a[8:11], v[84:87], v[64:67]
  ds_read_b128 v[80:83], v14 offset:30208
  v_mfma_f32_16x16x32_bf16 v[68:71], a[12:15], v[84:87], v[68:71]
  v_mfma_f32_16x16x32_bf16 v[72:75], v[84:87], a[16:19], v[72:75]
  s_waitcnt vmcnt(8)
  s_barrier
  ds_read_b64_tr_b16 a[32:33], v19 offset:22528
  v_mfma_f32_16x16x32_bf16 v[76:79], v[84:87], a[20:23], v[76:79]
  s_waitcnt lgkmcnt(6)
  ds_read_b64_tr_b16 a[34:35], v19 offset:23552
  v_mfma_f32_16x16x32_bf16 v[88:91], a[8:11], v[60:63], v[88:91]
  buffer_load_dwordx4 v33, s[16:19], s64 offen offset:1792 lds
  s_mov_b32 s64, 688128
  s_add_u32 m0, s41, 89600
  v_mfma_f32_16x16x32_bf16 v[92:95], a[12:15], v[60:63], v[92:95]
  ds_read_b64_tr_b16 a[36:37], v20 offset:22528
  v_mfma_f32_16x16x32_bf16 v[104:107], a[0:3], v[60:63], v[104:107]
  ds_read_b64_tr_b16 a[38:39], v20 offset:23552
  v_mfma_f32_16x16x32_bf16 v[108:111], a[4:7], v[60:63], v[108:111]
  ds_read_b64_tr_b16 a[24:25], v19 offset:14336
  v_mfma_f32_16x16x32_bf16 v[96:99], v[60:63], a[16:19], v[96:99]
  buffer_load_dwordx4 v32, s[16:19], s64 offen offset:0 lds
  s_add_u32 m0, s41, 111232
  v_mfma_f32_16x16x32_bf16 v[100:103], v[60:63], a[20:23], v[100:103]
  s_waitcnt lgkmcnt(9)
  ds_read_b64_tr_b16 a[26:27], v19 offset:15360
  v_mfma_f32_16x16x32_bf16 v[112:115], a[8:11], v[56:59], v[112:115]
  ds_read_b64_tr_b16 a[28:29], v20 offset:14336
  v_mfma_f32_16x16x32_bf16 v[116:119], a[12:15], v[56:59], v[116:119]
  ds_read_b64_tr_b16 a[30:31], v20 offset:15360
  v_mfma_f32_16x16x32_bf16 v[128:131], a[0:3], v[56:59], v[128:131]
  ds_read_b64_tr_b16 a[40:41], v19 offset:30720
  v_mfma_f32_16x16x32_bf16 v[132:135], a[4:7], v[56:59], v[132:135]
  buffer_load_dwordx4 v32, s[16:19], s64 offen offset:896 lds
  s_add_u32 m0, s41, 50176
  v_mfma_f32_16x16x32_bf16 v[120:123], v[56:59], a[16:19], v[120:123]
  ds_read_b64_tr_b16 a[42:43], v19 offset:31744
  v_mfma_f32_16x16x32_bf16 v[124:127], v[56:59], a[20:23], v[124:127]
  s_waitcnt lgkmcnt(8)
  ds_read_b64_tr_b16 a[44:45], v20 offset:30720
  v_mfma_f32_16x16x32_bf16 v[136:139], a[32:35], v[52:55], v[136:139]
  s_waitcnt lgkmcnt(7)
  ds_read_b64_tr_b16 a[46:47], v20 offset:31744
  v_mfma_f32_16x16x32_bf16 v[140:143], a[36:39], v[52:55], v[140:143]
  s_waitcnt lgkmcnt(6)
  v_mfma_f32_16x16x32_bf16 v[152:155], a[24:27], v[52:55], v[152:155]
  s_waitcnt lgkmcnt(4)
  buffer_load_dwordx4 v10, s[12:15], s35 offen offset:512 lds
  s_add_u32 m0, s41, 118528
  v_mfma_f32_16x16x32_bf16 v[156:159], a[28:31], v[52:55], v[156:159]
  s_waitcnt lgkmcnt(2)
  v_mfma_f32_16x16x32_bf16 v[144:147], v[52:55], a[40:43], v[144:147]
  s_waitcnt lgkmcnt(0)
  v_mfma_f32_16x16x32_bf16 v[148:151], v[52:55], a[44:47], v[148:151]
  v_mfma_f32_16x16x32_bf16 v[64:67], a[32:35], v[36:39], v[64:67]
  s_waitcnt vmcnt(7)
  s_barrier
  ds_read_b64_tr_b16 a[8:9], v19 offset:47104
  v_mfma_f32_16x16x32_bf16 v[68:71], a[36:39], v[36:39], v[68:71]
  ds_read_b64_tr_b16 a[10:11], v19 offset:48128
  v_mfma_f32_16x16x32_bf16 v[72:75], v[36:39], a[40:43], v[72:75]
  buffer_load_dwordx4 v32, s[16:19], s64 offen offset:1792 lds
  s_add_u32 m0, s41, 128512
  v_mfma_f32_16x16x32_bf16 v[76:79], v[36:39], a[44:47], v[76:79]
  ds_read_b128 v[84:87], v13 offset:9728
  v_mfma_f32_16x16x32_bf16 v[88:91], a[32:35], v[40:43], v[88:91]
  ds_read_b64_tr_b16 a[12:13], v20 offset:47104
  v_mfma_f32_16x16x32_bf16 v[92:95], a[36:39], v[40:43], v[92:95]
  ds_read_b64_tr_b16 a[14:15], v20 offset:48128
  v_mfma_f32_16x16x32_bf16 v[104:107], a[24:27], v[40:43], v[104:107]
  ds_read_b64_tr_b16 a[0:1], v19 offset:38912
  v_mfma_f32_16x16x32_bf16 v[108:111], a[28:31], v[40:43], v[108:111]
  buffer_load_dwordx4 v33, s[16:19], s64 offen offset:0 lds
  s_add_u32 m0, s41, 135808
  v_mfma_f32_16x16x32_bf16 v[96:99], v[40:43], a[40:43], v[96:99]
  ds_read_b64_tr_b16 a[2:3], v19 offset:39936
  v_mfma_f32_16x16x32_bf16 v[100:103], v[40:43], a[44:47], v[100:103]
  ds_read_b64_tr_b16 a[4:5], v20 offset:38912
  v_mfma_f32_16x16x32_bf16 v[112:115], a[32:35], v[80:83], v[112:115]
  ds_read_b64_tr_b16 a[6:7], v20 offset:39936
  v_mfma_f32_16x16x32_bf16 v[116:119], a[36:39], v[80:83], v[116:119]
  ds_read_b64_tr_b16 a[16:17], v17 offset:0
  v_mfma_f32_16x16x32_bf16 v[128:131], a[24:27], v[80:83], v[128:131]
  buffer_load_dwordx4 v33, s[16:19], s64 offen offset:896 lds
  s_add_u32 m0, s41, 97152
  v_mfma_f32_16x16x32_bf16 v[132:135], a[28:31], v[80:83], v[132:135]
  ds_read_b64_tr_b16 a[18:19], v17 offset:1024
  v_mfma_f32_16x16x32_bf16 v[120:123], v[80:83], a[40:43], v[120:123]
  ds_read_b64_tr_b16 a[20:21], v18 offset:0
  v_mfma_f32_16x16x32_bf16 v[124:127], v[80:83], a[44:47], v[124:127]
  s_waitcnt lgkmcnt(9)
  ds_read_b64_tr_b16 a[22:23], v18 offset:1024
  v_mfma_f32_16x16x32_bf16 v[136:139], a[8:11], v[84:87], v[136:139]
  s_waitcnt lgkmcnt(8)
  ds_read_b128 v[60:63], v13 offset:3584
  v_mfma_f32_16x16x32_bf16 v[140:143], a[12:15], v[84:87], v[140:143]
  s_waitcnt lgkmcnt(7)
  ds_read_b128 v[56:59], v13 offset:5632
  v_mfma_f32_16x16x32_bf16 v[152:155], a[0:3], v[84:87], v[152:155]
  s_waitcnt lgkmcnt(6)
  buffer_load_dwordx4 v10, s[12:15], s34 offen offset:640 lds
  s_add_u32 m0, s76, 26112
  v_mfma_f32_16x16x32_bf16 v[156:159], a[4:7], v[84:87], v[156:159]
  s_waitcnt lgkmcnt(4)
  ds_read_b128 v[52:55], v13 offset:7680
  v_mfma_f32_16x16x32_bf16 v[144:147], v[84:87], a[16:19], v[144:147]
  s_waitcnt lgkmcnt(3)
  ds_read_b128 v[36:39], v14 offset:9728
  v_mfma_f32_16x16x32_bf16 v[148:151], v[84:87], a[20:23], v[148:151]
  s_waitcnt lgkmcnt(3)
  ds_read_b128 v[40:43], v14 offset:3584
  v_mfma_f32_16x16x32_bf16 v[64:67], a[8:11], v[60:63], v[64:67]
  s_waitcnt vmcnt(7)
  s_barrier
  ds_read_b64_tr_b16 a[32:33], v17 offset:16384
  v_mfma_f32_16x16x32_bf16 v[68:71], a[12:15], v[60:63], v[68:71]
  buffer_load_dwordx4 v12, s[68:71], 0 offen lds
  s_add_u32 m0, s76, 27136
  v_mfma_f32_16x16x32_bf16 v[72:75], v[60:63], a[16:19], v[72:75]
  ds_read_b64_tr_b16 a[34:35], v17 offset:17408
  v_add_u32 v12, s72, v11
  s_add_u32 s72, s72, s75
  s_cmp_eq_u32 s72, s73
  s_cselect_b32 s72, s74, s72
  v_mfma_f32_16x16x32_bf16 v[76:79], v[60:63], a[20:23], v[76:79]
  s_waitcnt lgkmcnt(5)
  ds_read_b64_tr_b16 a[36:37], v18 offset:16384
  v_mfma_f32_16x16x32_bf16 v[88:91], a[8:11], v[56:59], v[88:91]
  ds_read_b64_tr_b16 a[38:39], v18 offset:17408
  v_mfma_f32_16x16x32_bf16 v[92:95], a[12:15], v[56:59], v[92:95]
  buffer_load_dwordx4 v9, s[68:71], 0 offen lds
  s_add_u32 m0, s41, 143104
  v_mfma_f32_16x16x32_bf16 v[104:107], a[0:3], v[56:59], v[104:107]
  ds_read_b64_tr_b16 a[24:25], v17 offset:8192
  v_add_u32 v9, 7168, v12
  v_mfma_f32_16x16x32_bf16 v[108:111], a[4:7], v[56:59], v[108:111]
  ds_read_b64_tr_b16 a[26:27], v17 offset:9216
  v_mfma_f32_16x16x32_bf16 v[96:99], v[56:59], a[16:19], v[96:99]
  buffer_load_dwordx4 v33, s[16:19], s64 offen offset:1792 lds
  s_mov_b32 s64, 860160
  s_add_u32 m0, s41, 153088
  v_mfma_f32_16x16x32_bf16 v[100:103], v[56:59], a[20:23], v[100:103]
  s_waitcnt lgkmcnt(8)
  ds_read_b64_tr_b16 a[28:29], v18 offset:8192
  v_mfma_f32_16x16x32_bf16 v[112:115], a[8:11], v[52:55], v[112:115]
  ds_read_b64_tr_b16 a[30:31], v18 offset:9216
  v_mfma_f32_16x16x32_bf16 v[116:119], a[12:15], v[52:55], v[116:119]
  ds_read_b64_tr_b16 a[40:41], v17 offset:24576
  v_mfma_f32_16x16x32_bf16 v[128:131], a[0:3], v[52:55], v[128:131]
  buffer_load_dwordx4 v32, s[16:19], s64 offen offset:0 lds
  s_add_u32 m0, s41, 55936
  v_mfma_f32_16x16x32_bf16 v[132:135], a[4:7], v[52:55], v[132:135]
  ds_read_b64_tr_b16 a[42:43], v17 offset:25600
  v_mfma_f32_16x16x32_bf16 v[120:123], v[52:55], a[16:19], v[120:123]
  ds_read_b64_tr_b16 a[44:45], v18 offset:24576
  v_mfma_f32_16x16x32_bf16 v[124:127], v[52:55], a[20:23], v[124:127]
  s_waitcnt lgkmcnt(9)
  buffer_load_dwordx4 v32, s[16:19], s64 offen offset:896 lds
  s_add_u32 m0, s41, 105344
  v_mfma_f32_16x16x32_bf16 v[136:139], a[32:35], v[36:39], v[136:139]
  s_waitcnt lgkmcnt(7)
  ds_read_b64_tr_b16 a[46:47], v18 offset:25600
  v_mfma_f32_16x16x32_bf16 v[140:143], a[36:39], v[36:39], v[140:143]
  s_waitcnt lgkmcnt(6)
  ds_read_b128 v[80:83], v14 offset:5632
  v_mfma_f32_16x16x32_bf16 v[152:155], a[24:27], v[36:39], v[152:155]
  s_waitcnt lgkmcnt(5)
  ds_read_b128 v[84:87], v14 offset:7680
  v_mfma_f32_16x16x32_bf16 v[156:159], a[28:31], v[36:39], v[156:159]
  s_waitcnt lgkmcnt(4)
  buffer_load_dwordx4 v10, s[12:15], s35 offen offset:640 lds
  s_add_u32 m0, s41, 63232
  v_mfma_f32_16x16x32_bf16 v[144:147], v[36:39], a[40:43], v[144:147]
  s_waitcnt lgkmcnt(2)
  v_mfma_f32_16x16x32_bf16 v[148:151], v[36:39], a[44:47], v[148:151]
  v_mfma_f32_16x16x32_bf16 v[64:67], a[32:35], v[40:43], v[64:67]
  s_waitcnt vmcnt(9)
  s_barrier
  ds_read_b64_tr_b16 a[8:9], v19 offset:6144
  v_mfma_f32_16x16x32_bf16 v[68:71], a[36:39], v[40:43], v[68:71]
  ds_read_b64_tr_b16 a[10:11], v19 offset:7168
  v_mfma_f32_16x16x32_bf16 v[72:75], v[40:43], a[40:43], v[72:75]
  buffer_load_dwordx4 v32, s[16:19], s64 offen offset:1792 lds
  s_add_u32 m0, s41, 73216
  v_mfma_f32_16x16x32_bf16 v[76:79], v[40:43], a[44:47], v[76:79]
  s_waitcnt lgkmcnt(3)
  ds_read_b128 v[60:63], v13 offset:48640
  v_mfma_f32_16x16x32_bf16 v[88:91], a[32:35], v[80:83], v[88:91]
  ds_read_b64_tr_b16 a[12:13], v20 offset:6144
  v_mfma_f32_16x16x32_bf16 v[92:95], a[36:39], v[80:83], v[92:95]
  ds_read_b64_tr_b16 a[14:15], v20 offset:7168
  v_mfma_f32_16x16x32_bf16 v[104:107], a[24:27], v[80:83], v[104:107]
  ds_read_b64_tr_b16 a[0:1], v17 offset:32768
  v_mfma_f32_16x16x32_bf16 v[108:111], a[28:31], v[80:83], v[108:111]
  ds_read_b64_tr_b16 a[2:3], v17 offset:33792
  v_mfma_f32_16x16x32_bf16 v[96:99], v[80:83], a[40:43], v[96:99]
  ds_read_b64_tr_b16 a[4:5], v18 offset:32768
  v_mfma_f32_16x16x32_bf16 v[100:103], v[80:83], a[44:47], v[100:103]
  s_waitcnt lgkmcnt(8)
  buffer_load_dwordx4 v33, s[16:19], s64 offen offset:0 lds
  s_add_u32 m0, s41, 80512
  v_mfma_f32_16x16x32_bf16 v[112:115], a[32:35], v[84:87], v[112:115]
  ds_read_b64_tr_b16 a[6:7], v18 offset:33792
  v_mfma_f32_16x16x32_bf16 v[116:119], a[36:39], v[84:87], v[116:119]
  ds_read_b64_tr_b16 a[16:17], v19 offset:14336
  v_mfma_f32_16x16x32_bf16 v[128:131], a[24:27], v[84:87], v[128:131]
  ds_read_b64_tr_b16 a[18:19], v19 offset:15360
  v_mfma_f32_16x16x32_bf16 v[132:135], a[28:31], v[84:87], v[132:135]
  ds_read_b64_tr_b16 a[20:21], v20 offset:14336
  v_mfma_f32_16x16x32_bf16 v[120:123], v[84:87], a[40:43], v[120:123]
  ds_read_b64_tr_b16 a[22:23], v20 offset:15360
  v_mfma_f32_16x16x32_bf16 v[124:127], v[84:87], a[44:47], v[124:127]
  s_waitcnt lgkmcnt(10)
  ds_read_b128 v[56:59], v13 offset:42496
  v_mfma_f32_16x16x32_bf16 v[136:139], a[8:11], v[60:63], v[136:139]
  s_waitcnt lgkmcnt(9)
  buffer_load_dwordx4 v33, s[16:19], s64 offen offset:896 lds
  s_add_u32 m0, s41, 87808
  v_mfma_f32_16x16x32_bf16 v[140:143], a[12:15], v[60:63], v[140:143]
  s_waitcnt lgkmcnt(7)
  ds_read_b128 v[52:55], v13 offset:44544
  v_mfma_f32_16x16x32_bf16 v[152:155], a[0:3], v[60:63], v[152:155]
  s_waitcnt lgkmcnt(6)
  ds_read_b128 v[36:39], v13 offset:46592
  v_mfma_f32_16x16x32_bf16 v[156:159], a[4:7], v[60:63], v[156:159]
  s_waitcnt lgkmcnt(5)
  ds_read_b128 v[40:43], v14 offset:48640
  v_mfma_f32_16x16x32_bf16 v[144:147], v[60:63], a[16:19], v[144:147]
  s_waitcnt lgkmcnt(4)
  ds_read_b128 v[80:83], v14 offset:42496
  v_mfma_f32_16x16x32_bf16 v[148:151], v[60:63], a[20:23], v[148:151]
  s_waitcnt lgkmcnt(4)
  ds_read_b128 v[84:87], v14 offset:44544
  v_mfma_f32_16x16x32_bf16 v[64:67], a[8:11], v[56:59], v[64:67]
  s_waitcnt vmcnt(6)
  s_barrier
  ds_read_b64_tr_b16 a[32:33], v19 offset:30720
  v_mfma_f32_16x16x32_bf16 v[68:71], a[12:15], v[56:59], v[68:71]
  ds_read_b64_tr_b16 a[34:35], v19 offset:31744
  v_mfma_f32_16x16x32_bf16 v[72:75], v[56:59], a[16:19], v[72:75]
  buffer_load_dwordx4 v33, s[16:19], s64 offen offset:1792 lds
  s_mov_b32 s64, 1032192
  s_add_u32 m0, s41, 112128
  v_mfma_f32_16x16x32_bf16 v[76:79], v[56:59], a[20:23], v[76:79]
  s_waitcnt lgkmcnt(6)
  ds_read_b64_tr_b16 a[36:37], v20 offset:30720
  v_mfma_f32_16x16x32_bf16 v[88:91], a[8:11], v[52:55], v[88:91]
  ds_read_b64_tr_b16 a[38:39], v20 offset:31744
  v_mfma_f32_16x16x32_bf16 v[92:95], a[12:15], v[52:55], v[92:95]
  ds_read_b64_tr_b16 a[24:25], v19 offset:22528
  v_mfma_f32_16x16x32_bf16 v[104:107], a[0:3], v[52:55], v[104:107]
  ds_read_b64_tr_b16 a[26:27], v19 offset:23552
  v_mfma_f32_16x16x32_bf16 v[108:111], a[4:7], v[52:55], v[108:111]
  buffer_load_dwordx4 v32, s[16:19], s64 offen offset:0 lds
  s_add_u32 m0, s41, 119424
  v_mfma_f32_16x16x32_bf16 v[96:99], v[52:55], a[16:19], v[96:99]
  ds_read_b64_tr_b16 a[28:29], v20 offset:22528
  v_mfma_f32_16x16x32_bf16 v[100:103], v[52:55], a[20:23], v[100:103]
  s_waitcnt lgkmcnt(10)
  ds_read_b64_tr_b16 a[30:31], v20 offset:23552
  v_mfma_f32_16x16x32_bf16 v[112:115], a[8:11], v[36:39], v[112:115]
  ds_read_b64_tr_b16 a[40:41], v19 offset:38912
  v_mfma_f32_16x16x32_bf16 v[116:119], a[12:15], v[36:39], v[116:119]
  ds_read_b64_tr_b16 a[42:43], v19 offset:39936
  v_mfma_f32_16x16x32_bf16 v[128:131], a[0:3], v[36:39], v[128:131]
  buffer_load_dwordx4 v32, s[16:19], s64 offen offset:896 lds
  s_add_u32 m0, s41, 2816
  v_mfma_f32_16x16x32_bf16 v[132:135], a[4:7], v[36:39], v[132:135]
  ds_read_b64_tr_b16 a[44:45], v20 offset:38912
  v_mfma_f32_16x16x32_bf16 v[120:123], v[36:39], a[16:19], v[120:123]
  ds_read_b64_tr_b16 a[46:47], v20 offset:39936
  v_mfma_f32_16x16x32_bf16 v[124:127], v[36:39], a[20:23], v[124:127]
  s_waitcnt lgkmcnt(10)
  ds_read_b64_tr_b16 a[48:49], v4 offset:0
  v_mfma_f32_16x16x32_bf16 v[136:139], a[32:35], v[40:43], v[136:139]
  s_waitcnt lgkmcnt(9)
  ds_read_b64_tr_b16 a[50:51], v4 offset:2048
  v_mfma_f32_16x16x32_bf16 v[140:143], a[36:39], v[40:43], v[140:143]
  s_waitcnt lgkmcnt(8)
  ds_read_b64_tr_b16 a[52:53], v5 offset:0
  v_mfma_f32_16x16x32_bf16 v[152:155], a[24:27], v[40:43], v[152:155]
  s_waitcnt lgkmcnt(7)
  buffer_load_dwordx4 v10, s[12:15], s34 offen offset:768 lds
  s_add_u32 m0, s76, 26112
  v_mfma_f32_16x16x32_bf16 v[156:159], a[28:31], v[40:43], v[156:159]
  s_waitcnt lgkmcnt(5)
  ds_read_b64_tr_b16 a[54:55], v5 offset:2048
  v_mfma_f32_16x16x32_bf16 v[144:147], v[40:43], a[40:43], v[144:147]
  ds_read_b64_tr_b16 a[56:57], v6 offset:0
  ds_read_b64_tr_b16 a[58:59], v6 offset:2048
  ds_read_b64_tr_b16 a[60:61], v7 offset:0
  ds_read_b64_tr_b16 a[62:63], v7 offset:2048
  s_waitcnt lgkmcnt(8)
  v_mfma_f32_16x16x32_bf16 v[148:151], v[40:43], a[44:47], v[148:151]
  ds_read_b128 v[60:63], v14 offset:46592
  v_mfma_f32_16x16x32_bf16 v[64:67], a[32:35], v[80:83], v[64:67]
  v_mfma_f32_16x16x32_bf16 v[68:71], a[36:39], v[80:83], v[68:71]
  v_mfma_f32_16x16x32_bf16 v[72:75], v[80:83], a[40:43], v[72:75]
  s_waitcnt vmcnt(6) lgkmcnt(1)
  s_barrier
  buffer_load_dwordx4 v12, s[68:71], 0 offen lds
  s_add_u32 m0, s76, 27136
  v_mfma_f32_16x16x32_bf16 v[76:79], v[80:83], a[44:47], v[76:79]
  ds_read_b64_tr_b16 a[8:9], v17 offset:0
  v_add_u32 v12, s72, v11
  s_add_u32 s72, s72, s75
  s_cmp_eq_u32 s72, s73
  s_cselect_b32 s72, s74, s72
  v_mfma_f32_16x16x32_bf16 v[88:91], a[32:35], v[84:87], v[88:91]
  ds_read_b64_tr_b16 a[10:11], v17 offset:1024
  v_mfma_f32_16x16x32_bf16 v[92:95], a[36:39], v[84:87], v[92:95]
  buffer_load_dwordx4 v9, s[68:71], 0 offen lds
  s_add_u32 m0, s41, 126720
  v_mfma_f32_16x16x32_bf16 v[104:107], a[24:27], v[84:87], v[104:107]
  ds_read_b128 v[56:59], v21 offset:38400
  v_add_u32 v9, 7168, v12
  v_mfma_f32_16x16x32_bf16 v[108:111], a[28:31], v[84:87], v[108:111]
  ds_read_b64_tr_b16 a[12:13], v18 offset:0
  v_mfma_f32_16x16x32_bf16 v[96:99], v[84:87], a[40:43], v[96:99]
  buffer_load_dwordx4 v32, s[16:19], s64 offen offset:1792 lds
  s_add_u32 m0, s41, 11008
  v_mfma_f32_16x16x32_bf16 v[100:103], v[84:87], a[44:47], v[100:103]
  s_waitcnt lgkmcnt(4)
  ds_read_b64_tr_b16 a[14:15], v18 offset:1024
  v_mfma_f32_16x16x32_bf16 v[112:115], a[32:35], v[60:63], v[112:115]
  ds_read_b64_tr_b16 a[0:1], v19 offset:47104
  v_mfma_f32_16x16x32_bf16 v[116:119], a[36:39], v[60:63], v[116:119]
  ds_read_b64_tr_b16 a[2:3], v19 offset:48128
  v_mfma_f32_16x16x32_bf16 v[128:131], a[24:27], v[60:63], v[128:131]
  buffer_load_dwordx4 v10, s[12:15], s35 offen offset:768 lds
  s_add_u32 m0, s41, 136704
  v_mfma_f32_16x16x32_bf16 v[132:135], a[28:31], v[60:63], v[132:135]
  ds_read_b64_tr_b16 a[4:5], v20 offset:47104
  v_mfma_f32_16x16x32_bf16 v[120:123], v[60:63], a[40:43], v[120:123]
  ds_read_b64_tr_b16 a[6:7], v20 offset:48128
  v_mfma_f32_16x16x32_bf16 v[124:127], v[60:63], a[44:47], v[124:127]
  s_waitcnt lgkmcnt(6)
  buffer_load_dwordx4 v33, s[16:19], s64 offen offset:0 lds
  s_add_u32 m0, s41, 144000
  v_mfma_f32_16x16x32_bf16 v[136:139], a[8:11], v[56:59], v[136:139]
  s_waitcnt lgkmcnt(4)
  ds_read_b64_tr_b16 a[16:17], v17 offset:8192
  v_mfma_f32_16x16x32_bf16 v[140:143], a[12:15], v[56:59], v[140:143]
  s_waitcnt lgkmcnt(3)
  ds_read_b64_tr_b16 a[18:19], v17 offset:9216
  ds_read_b64_tr_b16 a[20:21], v18 offset:8192
  v_mfma_f32_16x16x32_bf16 v[152:155], a[0:3], v[56:59], v[152:155]
  s_waitcnt lgkmcnt(3)
  ds_read_b64_tr_b16 a[22:23], v18 offset:9216
  v_mfma_f32_16x16x32_bf16 v[156:159], a[4:7], v[56:59], v[156:159]
  ds_read_b128 v[52:55], v21 offset:32256
  buffer_load_dwordx4 v33, s[16:19], s64 offen offset:896 lds
  ds_read_b128 v[36:39], v21 offset:34304
  s_add_u32 m0, s76, 42496
  ds_read_b128 v[40:43], v21 offset:36352
  ds_read_b128 v[80:83], v22 offset:38400
  ds_read_b128 v[84:87], v22 offset:32256
  ds_read_b128 v[60:63], v22 offset:34304
  s_waitcnt lgkmcnt(8)
  v_mfma_f32_16x16x32_bf16 v[144:147], v[56:59], a[16:19], v[144:147]
  s_waitcnt lgkmcnt(6)
  v_mfma_f32_16x16x32_bf16 v[148:151], v[56:59], a[20:23], v[148:151]
  s_waitcnt lgkmcnt(5)
  v_mfma_f32_16x16x32_bf16 v[64:67], a[8:11], v[52:55], v[64:67]
  s_waitcnt vmcnt(9)
  s_barrier
  ds_read_b64_tr_b16 a[32:33], v17 offset:24576
  v_mfma_f32_16x16x32_bf16 v[68:71], a[12:15], v[52:55], v[68:71]
  ds_read_b64_tr_b16 a[34:35], v17 offset:25600
  v_mfma_f32_16x16x32_bf16 v[72:75], v[52:55], a[16:19], v[72:75]
  buffer_load_dwordx4 v12, s[68:71], 0 offen lds
  s_add_u32 m0, s76, 43520
  v_mfma_f32_16x16x32_bf16 v[76:79], v[52:55], a[20:23], v[76:79]
  s_waitcnt lgkmcnt(6)
  ds_read_b64_tr_b16 a[36:37], v18 offset:24576
  v_add_u32 v12, s72, v11
  s_add_u32 s72, s72, s75
  s_cmp_eq_u32 s72, s73
  s_cselect_b32 s72, s74, s72
  v_mfma_f32_16x16x32_bf16 v[88:91], a[8:11], v[36:39], v[88:91]
  ds_read_b64_tr_b16 a[38:39], v18 offset:25600
  v_mfma_f32_16x16x32_bf16 v[92:95], a[12:15], v[36:39], v[92:95]
  ds_read_b64_tr_b16 a[24:25], v17 offset:16384
  v_mfma_f32_16x16x32_bf16 v[104:107], a[0:3], v[36:39], v[104:107]
  ds_read_b64_tr_b16 a[26:27], v17 offset:17408
  v_mfma_f32_16x16x32_bf16 v[108:111], a[4:7], v[36:39], v[108:111]
  ds_read_b64_tr_b16 a[28:29], v18 offset:16384
  v_mfma_f32_16x16x32_bf16 v[96:99], v[36:39], a[16:19], v[96:99]
  ds_read_b64_tr_b16 a[30:31], v18 offset:17408
  v_mfma_f32_16x16x32_bf16 v[100:103], v[36:39], a[20:23], v[100:103]
  s_waitcnt lgkmcnt(11)
  buffer_load_dwordx4 v9, s[68:71], 0 offen lds
  s_add_u32 m0, s41, 151296
  v_mfma_f32_16x16x32_bf16 v[112:115], a[8:11], v[40:43], v[112:115]
  ds_read_b64_tr_b16 a[40:41], v17 offset:32768
  v_add_u32 v9, 7168, v12
  v_mfma_f32_16x16x32_bf16 v[116:119], a[12:15], v[40:43], v[116:119]
  ds_read_b64_tr_b16 a[42:43], v17 offset:33792
  v_mfma_f32_16x16x32_bf16 v[128:131], a[0:3], v[40:43], v[128:131]
  ds_read_b64_tr_b16 a[44:45], v18 offset:32768
  v_mfma_f32_16x16x32_bf16 v[132:135], a[4:7], v[40:43], v[132:135]
  ds_read_b64_tr_b16 a[46:47], v18 offset:33792
  v_mfma_f32_16x16x32_bf16 v[120:123], v[40:43], a[16:19], v[120:123]
  ds_read_b128 v[56:59], v22 offset:36352
  v_mfma_f32_16x16x32_bf16 v[124:127], v[40:43], a[20:23], v[124:127]
  s_waitcnt lgkmcnt(11)
  v_mfma_f32_16x16x32_bf16 v[136:139], a[32:35], v[80:83], v[136:139]
  s_waitcnt lgkmcnt(9)
  buffer_load_dwordx4 v33, s[16:19], s64 offen offset:1792 lds
  s_add_u32 m0, s76, 58880
  v_mfma_f32_16x16x32_bf16 v[140:143], a[36:39], v[80:83], v[140:143]
  s_waitcnt lgkmcnt(7)
  v_mfma_f32_16x16x32_bf16 v[152:155], a[24:27], v[80:83], v[152:155]
  s_waitcnt lgkmcnt(5)
  v_mfma_f32_16x16x32_bf16 v[156:159], a[28:31], v[80:83], v[156:159]
  s_waitcnt lgkmcnt(3)
  v_mfma_f32_16x16x32_bf16 v[144:147], v[80:83], a[40:43], v[144:147]
  s_waitcnt lgkmcnt(1)
  v_mfma_f32_16x16x32_bf16 v[148:151], v[80:83], a[44:47], v[148:151]
  v_mfma_f32_16x16x32_bf16 v[64:67], a[32:35], v[84:87], v[64:67]
  s_waitcnt vmcnt(5)
  s_barrier
  ds_read_b64_tr_b16 a[8:9], v19 offset:14336
  v_mfma_f32_16x16x32_bf16 v[68:71], a[36:39], v[84:87], v[68:71]
  ds_read_b64_tr_b16 a[10:11], v19 offset:15360
  v_mfma_f32_16x16x32_bf16 v[72:75], v[84:87], a[40:43], v[72:75]
  buffer_load_dwordx4 v12, s[68:71], 0 offen lds
  s_add_u32 m0, s76, 59904
  v_mfma_f32_16x16x32_bf16 v[76:79], v[84:87], a[44:47], v[76:79]
  ds_read_b128 v[52:55], v13 offset:9728
  v_add_u32 v12, s72, v11
  s_add_u32 s72, s72, s75
  s_cmp_eq_u32 s72, s73
  s_cselect_b32 s72, s74, s72
  v_mfma_f32_16x16x32_bf16 v[88:91], a[32:35], v[60:63], v[88:91]
  ds_read_b64_tr_b16 a[12:13], v20 offset:14336
  v_mfma_f32_16x16x32_bf16 v[92:95], a[36:39], v[60:63], v[92:95]
  ds_read_b64_tr_b16 a[14:15], v20 offset:15360
  v_mfma_f32_16x16x32_bf16 v[104:107], a[24:27], v[60:63], v[104:107]
  ds_read_b64_tr_b16 a[0:1], v19 offset:6144
  v_mfma_f32_16x16x32_bf16 v[108:111], a[28:31], v[60:63], v[108:111]
  buffer_load_dwordx4 v9, s[68:71], 0 offen lds
  s_add_u32 m0, s76, 75264
  v_mfma_f32_16x16x32_bf16 v[96:99], v[60:63], a[40:43], v[96:99]
  ds_read_b64_tr_b16 a[2:3], v19 offset:7168
  v_add_u32 v9, 7168, v12
  v_mfma_f32_16x16x32_bf16 v[100:103], v[60:63], a[44:47], v[100:103]
  s_waitcnt lgkmcnt(7)
  ds_read_b64_tr_b16 a[4:5], v20 offset:6144
  v_mfma_f32_16x16x32_bf16 v[112:115], a[32:35], v[56:59], v[112:115]
  ds_read_b64_tr_b16 a[6:7], v20 offset:7168
  v_mfma_f32_16x16x32_bf16 v[116:119], a[36:39], v[56:59], v[116:119]
  ds_read_b64_tr_b16 a[16:17], v19 offset:22528
  v_mfma_f32_16x16x32_bf16 v[128:131], a[24:27], v[56:59], v[128:131]
  buffer_load_dwordx4 v12, s[68:71], 0 offen lds
  s_add_u32 m0, s76, 76288
  v_mfma_f32_16x16x32_bf16 v[132:135], a[28:31], v[56:59], v[132:135]
  ds_read_b64_tr_b16 a[18:19], v19 offset:23552
  v_add_u32 v12, s72, v11
  s_add_u32 s72, s72, s75
  s_cmp_eq_u32 s72, s73
  s_cselect_b32 s72, s74, s72
  v_mfma_f32_16x16x32_bf16 v[120:123], v[56:59], a[40:43], v[120:123]
  ds_read_b64_tr_b16 a[20:21], v20 offset:22528
  v_mfma_f32_16x16x32_bf16 v[124:127], v[56:59], a[44:47], v[124:127]
  s_waitcnt lgkmcnt(9)
  ds_read_b64_tr_b16 a[22:23], v20 offset:23552
  v_mfma_f32_16x16x32_bf16 v[136:139], a[8:11], v[52:55], v[136:139]
  s_waitcnt lgkmcnt(8)
  ds_read_b128 v[36:39], v13 offset:3584
  v_mfma_f32_16x16x32_bf16 v[140:143], a[12:15], v[52:55], v[140:143]
  s_waitcnt lgkmcnt(7)
  ds_read_b64_tr_b16 a[64:65], v4 offset:0
  v_mfma_f32_16x16x32_bf16 v[152:155], a[0:3], v[52:55], v[152:155]
  s_waitcnt lgkmcnt(6)
  buffer_load_dwordx4 v9, s[68:71], 0 offen lds
  s_add_u32 m0, s76, 91648
  v_mfma_f32_16x16x32_bf16 v[156:159], a[4:7], v[52:55], v[156:159]
  s_waitcnt lgkmcnt(4)
  ds_read_b64_tr_b16 a[66:67], v4 offset:2048
  v_add_u32 v9, 7168, v12
  v_mfma_f32_16x16x32_bf16 v[144:147], v[52:55], a[16:19], v[144:147]
  ds_read_b64_tr_b16 a[68:69], v5 offset:0
  ds_read_b64_tr_b16 a[70:71], v5 offset:2048
  ds_read_b64_tr_b16 a[72:73], v6 offset:0
  ds_read_b64_tr_b16 a[74:75], v6 offset:2048
  ds_read_b64_tr_b16 a[76:77], v7 offset:0
  s_waitcnt lgkmcnt(8)
  v_mfma_f32_16x16x32_bf16 v[148:151], v[52:55], a[20:23], v[148:151]
  s_waitcnt lgkmcnt(7)
  ds_read_b64_tr_b16 a[78:79], v7 offset:2048
  v_mfma_f32_16x16x32_bf16 v[64:67], a[8:11], v[36:39], v[64:67]
  ds_read_b128 v[40:43], v13 offset:5632
  v_mfma_f32_16x16x32_bf16 v[68:71], a[12:15], v[36:39], v[68:71]
  ds_read_b128 v[80:83], v13 offset:7680
  v_mfma_f32_16x16x32_bf16 v[72:75], v[36:39], a[16:19], v[72:75]
  ds_read_b128 v[84:87], v14 offset:9728
  v_mfma_f32_16x16x32_bf16 v[76:79], v[36:39], a[20:23], v[76:79]
  s_waitcnt vmcnt(4) lgkmcnt(3)
  s_barrier
  s_waitcnt lgkmcnt(2)
  v_mfma_f32_16x16x32_bf16 v[88:91], a[8:11], v[40:43], v[88:91]
  buffer_load_dwordx4 v12, s[68:71], 0 offen lds
  s_add_u32 m0, s76, 92672
  v_mfma_f32_16x16x32_bf16 v[92:95], a[12:15], v[40:43], v[92:95]
  ds_read_b64_tr_b16 a[32:33], v19 offset:38912
  v_mfma_f32_16x16x32_bf16 v[104:107], a[0:3], v[40:43], v[104:107]
  ds_read_b64_tr_b16 a[34:35], v19 offset:39936
  v_mfma_f32_16x16x32_bf16 v[108:111], a[4:7], v[40:43], v[108:111]
  ds_read_b64_tr_b16 a[36:37], v20 offset:38912
  v_mfma_f32_16x16x32_bf16 v[96:99], v[40:43], a[16:19], v[96:99]
  ds_read_b64_tr_b16 a[38:39], v20 offset:39936
  v_mfma_f32_16x16x32_bf16 v[100:103], v[40:43], a[20:23], v[100:103]
  s_waitcnt lgkmcnt(5)
  ds_read_b64_tr_b16 a[24:25], v19 offset:30720
  v_mfma_f32_16x16x32_bf16 v[112:115], a[8:11], v[80:83], v[112:115]
  ds_read_b64_tr_b16 a[26:27], v19 offset:31744
  v_mfma_f32_16x16x32_bf16 v[116:119], a[12:15], v[80:83], v[116:119]
  ds_read_b64_tr_b16 a[28:29], v20 offset:30720
  v_mfma_f32_16x16x32_bf16 v[128:131], a[0:3], v[80:83], v[128:131]
  ds_read_b64_tr_b16 a[30:31], v20 offset:31744
  v_mfma_f32_16x16x32_bf16 v[132:135], a[4:7], v[80:83], v[132:135]
  ds_read_b64_tr_b16 a[40:41], v19 offset:47104
  v_mfma_f32_16x16x32_bf16 v[120:123], v[80:83], a[16:19], v[120:123]
  ds_read_b64_tr_b16 a[42:43], v19 offset:48128
  v_mfma_f32_16x16x32_bf16 v[124:127], v[80:83], a[20:23], v[124:127]
  s_waitcnt lgkmcnt(8)
  ds_read_b64_tr_b16 a[44:45], v20 offset:47104
  v_mfma_f32_16x16x32_bf16 v[136:139], a[32:35], v[84:87], v[136:139]
  s_waitcnt lgkmcnt(7)
  ds_read_b64_tr_b16 a[46:47], v20 offset:48128
  v_mfma_f32_16x16x32_bf16 v[140:143], a[36:39], v[84:87], v[140:143]
  s_waitcnt lgkmcnt(6)
  buffer_load_dwordx4 v9, s[68:71], 0 offen lds
  v_mfma_f32_16x16x32_bf16 v[152:155], a[24:27], v[84:87], v[152:155]
  s_waitcnt lgkmcnt(4)
  ds_read_b128 v[60:63], v14 offset:3584
  v_mfma_f32_16x16x32_bf16 v[156:159], a[28:31], v[84:87], v[156:159]
  s_waitcnt lgkmcnt(3)
  ds_read_b128 v[56:59], v14 offset:5632
  v_mfma_f32_16x16x32_bf16 v[144:147], v[84:87], a[40:43], v[144:147]
  s_waitcnt lgkmcnt(2)
  ds_read_b128 v[52:55], v14 offset:7680
  v_mfma_f32_16x16x32_bf16 v[148:151], v[84:87], a[44:47], v[148:151]
  s_waitcnt lgkmcnt(2)
  v_mfma_f32_16x16x32_bf16 v[64:67], a[32:35], v[60:63], v[64:67]
  v_mfma_f32_16x16x32_bf16 v[68:71], a[36:39], v[60:63], v[68:71]
  s_waitcnt lgkmcnt(1)
  v_mfma_f32_16x16x32_bf16 v[88:91], a[32:35], v[56:59], v[88:91]
  v_mfma_f32_16x16x32_bf16 v[92:95], a[36:39], v[56:59], v[92:95]
  v_mfma_f32_16x16x32_bf16 v[104:107], a[24:27], v[56:59], v[104:107]
  v_mfma_f32_16x16x32_bf16 v[108:111], a[28:31], v[56:59], v[108:111]
  s_waitcnt lgkmcnt(0)
  v_mfma_f32_16x16x32_bf16 v[112:115], a[32:35], v[52:55], v[112:115]
  s_barrier
  ds_read_b128 v[48:51], v34 offset:0
  v_mfma_f32_16x16x32_bf16 v[116:119], a[36:39], v[52:55], v[116:119]
  v_mfma_f32_16x16x32_bf16 v[128:131], a[24:27], v[52:55], v[128:131]
  v_mfma_f32_16x16x32_bf16 v[132:135], a[28:31], v[52:55], v[132:135]
  v_mfma_f32_16x16x32_bf16 v[72:75], v[60:63], a[40:43], v[72:75]
  v_mfma_f32_16x16x32_bf16 v[76:79], v[60:63], a[44:47], v[76:79]
  v_mfma_f32_16x16x32_bf16 v[96:99], v[56:59], a[40:43], v[96:99]
  v_mfma_f32_16x16x32_bf16 v[100:103], v[56:59], a[44:47], v[100:103]
  v_mfma_f32_16x16x32_bf16 v[120:123], v[52:55], a[40:43], v[120:123]
  v_mfma_f32_16x16x32_bf16 v[124:127], v[52:55], a[44:47], v[124:127]
  ds_read_b128 v[52:55], v34 offset:16
  ds_read_b128 v[56:59], v34 offset:32
  ds_read_b128 v[60:63], v34 offset:48
  ds_read2_b32 v[46:47], v24 offset0:0 offset1:0
  ds_read2_b32 v[22:23], v24 offset0:1 offset1:1
  ds_read2_b32 v[4:5], v27 offset0:48 offset1:48
  ds_read2_b32 v[6:7], v27 offset0:0 offset1:0
  ds_read2_b32 v[14:15], v27 offset0:16 offset1:16
  ds_read2_b32 v[20:21], v27 offset0:32 offset1:32
  ds_read_b128 v[16:19], v8 offset:192
  ds_read_b128 v[28:31], v8 offset:0
  v_add_u32 v12, s72, v11
  s_add_u32 m0, s76, 26112
  s_nop 0
  buffer_load_dwordx4 v12, s[68:71], 0 offen lds
  s_waitcnt lgkmcnt(5)
  v_pk_fma_f32 v[136:137], v[56:57], v[4:5], v[136:137]
  v_pk_fma_f32 v[138:139], v[58:59], v[4:5], v[138:139]
  v_pk_fma_f32 v[140:141], v[60:61], v[4:5], v[140:141]
  v_pk_fma_f32 v[142:143], v[62:63], v[4:5], v[142:143]
  v_cvt_pk_bf16_f32 v136, v136, v137
  v_cvt_pk_bf16_f32 v137, v138, v139
  v_cvt_pk_bf16_f32 v138, v140, v141
  v_cvt_pk_bf16_f32 v139, v142, v143
  s_waitcnt lgkmcnt(1)
  v_pk_fma_f32 v[144:145], v[16:17], v[46:47], v[144:145]
  v_pk_fma_f32 v[146:147], v[18:19], v[46:47], v[146:147]
  v_cvt_pk_bf16_f32 v86, v144, v145
  v_cvt_pk_bf16_f32 v87, v146, v147
  v_pk_fma_f32 v[148:149], v[16:17], v[22:23], v[148:149]
  v_pk_fma_f32 v[150:151], v[18:19], v[22:23], v[150:151]
  v_cvt_pk_bf16_f32 v42, v148, v149
  v_cvt_pk_bf16_f32 v43, v150, v151
  ds_write_b128 v45, v[136:139]
  ds_write_b64 v45, v[86:87] offset:1024
  ds_write_b64 v45, v[42:43] offset:1032
  v_pk_fma_f32 v[152:153], v[48:49], v[4:5], v[152:153]
  v_add_u32 v9, 7168, v12
  s_add_u32 m0, s76, 27136
  s_nop 0
  buffer_load_dwordx4 v9, s[68:71], 0 offen lds
  v_pk_fma_f32 v[154:155], v[50:51], v[4:5], v[154:155]
  v_pk_fma_f32 v[156:157], v[52:53], v[4:5], v[156:157]
  v_pk_fma_f32 v[158:159], v[54:55], v[4:5], v[158:159]
  v_cvt_pk_bf16_f32 v152, v152, v153
  v_cvt_pk_bf16_f32 v153, v154, v155
  v_cvt_pk_bf16_f32 v154, v156, v157
  v_cvt_pk_bf16_f32 v155, v158, v159
  v_pk_fma_f32 v[64:65], v[56:57], v[6:7], v[64:65]
  v_pk_fma_f32 v[66:67], v[58:59], v[6:7], v[66:67]
  v_pk_fma_f32 v[68:69], v[60:61], v[6:7], v[68:69]
  v_pk_fma_f32 v[70:71], v[62:63], v[6:7], v[70:71]
  v_cvt_pk_bf16_f32 v64, v64, v65
  v_cvt_pk_bf16_f32 v65, v66, v67
  v_cvt_pk_bf16_f32 v66, v68, v69
  v_cvt_pk_bf16_f32 v67, v70, v71
  v_pk_fma_f32 v[88:89], v[56:57], v[14:15], v[88:89]
  v_pk_fma_f32 v[90:91], v[58:59], v[14:15], v[90:91]
  v_pk_fma_f32 v[92:93], v[60:61], v[14:15], v[92:93]
  v_pk_fma_f32 v[94:95], v[62:63], v[14:15], v[94:95]
  v_cvt_pk_bf16_f32 v88, v88, v89
  s_add_u32 s72, s72, s75
  s_cmp_eq_u32 s72, s73
  s_cselect_b32 s72, s74, s72
  v_add_u32 v12, s72, v11
  s_add_u32 m0, s76, 108032
  s_nop 0
  buffer_load_dwordx4 v12, s[68:71], 0 offen lds
  v_cvt_pk_bf16_f32 v89, v90, v91
  v_cvt_pk_bf16_f32 v90, v92, v93
  v_cvt_pk_bf16_f32 v91, v94, v95
  v_pk_fma_f32 v[104:105], v[48:49], v[14:15], v[104:105]
  v_pk_fma_f32 v[106:107], v[50:51], v[14:15], v[106:107]
  v_pk_fma_f32 v[108:109], v[52:53], v[14:15], v[108:109]
  v_pk_fma_f32 v[110:111], v[54:55], v[14:15], v[110:111]
  v_cvt_pk_bf16_f32 v104, v104, v105
  v_cvt_pk_bf16_f32 v105, v106, v107
  v_cvt_pk_bf16_f32 v106, v108, v109
  v_cvt_pk_bf16_f32 v107, v110, v111
  v_pk_fma_f32 v[112:113], v[56:57], v[20:21], v[112:113]
  v_pk_fma_f32 v[114:115], v[58:59], v[20:21], v[114:115]
  v_pk_fma_f32 v[116:117], v[60:61], v[20:21], v[116:117]
  v_pk_fma_f32 v[118:119], v[62:63], v[20:21], v[118:119]
  v_cvt_pk_bf16_f32 v112, v112, v113
  v_cvt_pk_bf16_f32 v113, v114, v115
  v_cvt_pk_bf16_f32 v114, v116, v117
  v_cvt_pk_bf16_f32 v115, v118, v119
  v_add_u32 v9, 7168, v12
  s_add_u32 m0, s76, 109056
  s_nop 0
  buffer_load_dwordx4 v9, s[68:71], 0 offen lds
  v_pk_fma_f32 v[128:129], v[48:49], v[20:21], v[128:129]
  v_pk_fma_f32 v[130:131], v[50:51], v[20:21], v[130:131]
  v_pk_fma_f32 v[132:133], v[52:53], v[20:21], v[132:133]
  v_pk_fma_f32 v[134:135], v[54:55], v[20:21], v[134:135]
  v_cvt_pk_bf16_f32 v128, v128, v129
  v_cvt_pk_bf16_f32 v129, v130, v131
  v_cvt_pk_bf16_f32 v130, v132, v133
  v_cvt_pk_bf16_f32 v131, v134, v135
  s_waitcnt lgkmcnt(0)
  s_barrier
  ds_read_b32 v48, v27 offset:1088
  ds_read_b32 v49, v25 offset:64
  ds_read_b32 v50, v26 offset:64
  ds_read_b32 v53, v27 offset:1152
  ds_read_b32 v54, v25 offset:128
  ds_read_b32 v55, v26 offset:128
  ds_read_b32 v58, v27 offset:1216
  ds_read_b32 v59, v25 offset:192
  ds_read_b32 v60, v26 offset:192
  ds_read_b128 v[32:35], v8 offset:64
  ds_read_b128 v[16:19], v8 offset:128
  s_add_u32 s72, s72, s75
  s_cmp_eq_u32 s72, s73
  s_cselect_b32 s72, s74, s72
  v_add_u32 v12, s72, v11
  s_add_u32 m0, s76, 124416
  s_nop 0
  buffer_load_dwordx4 v12, s[68:71], 0 offen lds
  v_mfma_f32_16x16x32_bf16 v[108:111], v[88:91], v[104:107], v[160:163]
  v_mfma_f32_16x16x32_bf16 v[92:95], v[64:67], v[104:107], v[168:171]
  v_mfma_f32_16x16x32_bf16 v[132:135], v[112:115], v[128:131], v[160:163]
  v_mfma_f32_16x16x32_bf16 v[116:119], v[88:91], v[128:131], v[164:167]
  v_mfma_f32_16x16x32_bf16 v[156:159], v[136:139], v[152:155], v[160:163]
  v_mfma_f32_16x16x32_bf16 v[140:143], v[112:115], v[152:155], v[164:167]
  v_pk_fma_f32 v[72:73], v[28:29], v[46:47], v[72:73]
  v_pk_fma_f32 v[74:75], v[30:31], v[46:47], v[74:75]
  v_cvt_pk_bf16_f32 v80, v72, v73
  v_cvt_pk_bf16_f32 v81, v74, v75
  v_pk_fma_f32 v[76:77], v[28:29], v[22:23], v[76:77]
  v_pk_fma_f32 v[78:79], v[30:31], v[22:23], v[78:79]
  v_cvt_pk_bf16_f32 v36, v76, v77
  v_cvt_pk_bf16_f32 v37, v78, v79
  s_waitcnt lgkmcnt(1)
  v_pk_fma_f32 v[96:97], v[32:33], v[46:47], v[96:97]
  v_pk_fma_f32 v[98:99], v[34:35], v[46:47], v[98:99]
  v_cvt_pk_bf16_f32 v82, v96, v97
  v_cvt_pk_bf16_f32 v83, v98, v99
  v_pk_fma_f32 v[100:101], v[32:33], v[22:23], v[100:101]
  v_add_u32 v9, 7168, v12
  s_add_u32 m0, s76, 125440
  s_nop 0
  buffer_load_dwordx4 v9, s[68:71], 0 offen lds
  v_pk_fma_f32 v[102:103], v[34:35], v[22:23], v[102:103]
  v_cvt_pk_bf16_f32 v38, v100, v101
  v_cvt_pk_bf16_f32 v39, v102, v103
  s_waitcnt lgkmcnt(0)
  v_pk_fma_f32 v[120:121], v[16:17], v[46:47], v[120:121]
  v_pk_fma_f32 v[122:123], v[18:19], v[46:47], v[122:123]
  v_cvt_pk_bf16_f32 v84, v120, v121
  v_cvt_pk_bf16_f32 v85, v122, v123
  v_pk_fma_f32 v[124:125], v[16:17], v[22:23], v[124:125]
  v_pk_fma_f32 v[126:127], v[18:19], v[22:23], v[126:127]
  v_cvt_pk_bf16_f32 v40, v124, v125
  v_cvt_pk_bf16_f32 v41, v126, v127
  v_mul_f32 v48, 0x3e8b97f6, v48
  v_mul_f32 v53, 0x3e8b97f6, v53
  v_mul_f32 v58, 0x3e8b97f6, v58
  v_mul_f32 v51, v48, v49
  v_mul_f32 v56, v53, v54
  v_mul_f32 v61, v58, v59
  v_mul_f32 v52, v48, v50
  v_mul_f32 v57, v53, v55
  v_mul_f32 v62, v58, v60
  s_add_u32 s72, s72, s75
  s_cmp_eq_u32 s72, s73
  s_cselect_b32 s72, s74, s72
  v_add_u32 v12, s72, v11
  s_add_u32 m0, s76, 140800
  s_nop 0
  buffer_load_dwordx4 v12, s[68:71], 0 offen lds
  v_max3_f32 v108, v108, v109, v92
  v_max3_f32 v132, v132, v133, v116
  v_max3_f32 v156, v156, v157, v140
  v_max3_f32 v110, v110, v111, v94
  v_max3_f32 v134, v134, v135, v118
  v_max3_f32 v158, v158, v159, v142
  v_max_f32 v108, v108, v93
  v_max_f32 v132, v132, v117
  v_max_f32 v156, v156, v141
  v_max_f32 v110, v110, v95
  v_max_f32 v134, v134, v119
  v_max_f32 v158, v158, v143
  v_mul_f32 v108, v108, v51
  v_mul_f32 v132, v132, v56
  v_mul_f32 v156, v156, v61
  v_mul_f32 v110, v110, v52
  v_mul_f32 v134, v134, v57
  v_mul_f32 v158, v158, v62
  v_max_f32 v109, v108, v110
  v_add_u32 v9, 7168, v12
  s_add_u32 m0, s76, 141824
  s_nop 0
  buffer_load_dwordx4 v9, s[68:71], 0 offen lds
  s_add_u32 s72, s72, s75
  s_cmp_eq_u32 s72, s73
  s_cselect_b32 s72, s74, s72
  v_max_f32 v133, v132, v134
  v_max_f32 v157, v156, v158
  v_max_f32 v111, v108, v110
  v_max_f32 v135, v132, v134
  v_max_f32 v159, v156, v158
  v_permlane32_swap_b32 v109, v111
  v_permlane32_swap_b32 v133, v135
  v_permlane32_swap_b32 v157, v159
  v_max_f32 v92, v109, v111
  v_max_f32 v116, v133, v135
  v_max_f32 v140, v157, v159
  v_max_f32 v93, v109, v111
  v_max_f32 v117, v133, v135
  v_max_f32 v141, v157, v159
  v_permlane16_swap_b32 v92, v93
  v_permlane16_swap_b32 v116, v117
  v_permlane16_swap_b32 v140, v141
  v_max_f32 v92, v92, v93
  v_max_f32 v116, v116, v117
  v_max_f32 v140, v140, v141
  v_sub_f32 v108, v108, v92
  v_sub_f32 v132, v132, v116
  v_sub_f32 v156, v156, v140
  v_sub_f32 v110, v110, v92
  v_sub_f32 v134, v134, v116
  v_sub_f32 v158, v158, v140
  v_exp_f32 v108, v108
  v_exp_f32 v132, v132
  v_exp_f32 v156, v156
  v_exp_f32 v110, v110
  v_exp_f32 v134, v134
  v_exp_f32 v158, v158
  v_add_f32 v109, v108, v110
  v_add_f32 v133, v132, v134
  v_add_f32 v157, v156, v158
  v_add_f32 v111, v108, v110
  v_add_f32 v135, v132, v134
  v_add_f32 v159, v156, v158
  v_permlane32_swap_b32 v109, v111
  v_permlane32_swap_b32 v133, v135
  v_permlane32_swap_b32 v157, v159
  v_mul_f32 v108, v108, v49
  v_mul_f32 v132, v132, v54
  v_mul_f32 v156, v156, v59
  v_mul_f32 v110, v110, v50
  v_mul_f32 v134, v134, v55
  v_mul_f32 v158, v158, v60
  v_add_f32 v92, v109, v111
  v_add_f32 v116, v133, v135
  v_add_f32 v140, v157, v159
  v_add_f32 v93, v109, v111
  v_add_f32 v117, v133, v135
  v_add_f32 v141, v157, v159
  v_permlane16_swap_b32 v92, v93
  v_permlane16_swap_b32 v116, v117
  v_permlane16_swap_b32 v140, v141
  v_add_f32 v92, v92, v93
  v_add_f32 v116, v116, v117
  v_add_f32 v140, v140, v141
  v_rcp_f32 v92, v92
  v_rcp_f32 v116, v116
  v_rcp_f32 v140, v140
  v_mul_f32 v108, v108, v92
  v_mul_f32 v132, v132, v116
  v_mul_f32 v156, v156, v140
  v_mul_f32 v110, v110, v92
  v_mul_f32 v134, v134, v116
  v_mul_f32 v158, v158, v140
  v_cvt_pk_bf16_f32 v94, v108, v108
  v_cvt_pk_bf16_f32 v118, v132, v132
  v_cvt_pk_bf16_f32 v142, v156, v156
  v_cvt_pk_bf16_f32 v95, v110, v110
  v_cvt_pk_bf16_f32 v119, v134, v134
  v_cvt_pk_bf16_f32 v143, v158, v158
  v_and_b32 v108, v94, v172
  v_and_b32 v132, v118, v172
  v_and_b32 v156, v142, v172
  v_and_b32 v109, v95, v173
  v_and_b32 v133, v119, v173
  v_and_b32 v157, v143, v173
  v_and_b32 v110, v94, v174
  v_and_b32 v134, v118, v174
  v_and_b32 v158, v142, v174
  v_and_b32 v111, v95, v175
  v_and_b32 v135, v119, v175
  v_and_b32 v159, v143, v175
  v_mfma_f32_16x16x32_bf16 v[96:99], v[80:83], v[108:111], 0
  v_mfma_f32_16x16x32_bf16 v[100:103], v[36:39], v[108:111], 0
  v_mfma_f32_16x16x32_bf16 v[120:123], v[82:85], v[132:135], 0
  v_mfma_f32_16x16x32_bf16 v[124:127], v[38:41], v[132:135], 0
  v_mfma_f32_16x16x32_bf16 v[144:147], v[84:87], v[156:159], 0
  v_mfma_f32_16x16x32_bf16 v[148:151], v[40:43], v[156:159], 0
  s_nop 2
  v_cvt_pk_bf16_f32 v104, v96, v97
  v_cvt_pk_bf16_f32 v105, v98, v99
  v_cvt_pk_bf16_f32 v106, v100, v101
  v_cvt_pk_bf16_f32 v107, v102, v103
  buffer_store_dwordx4 v[104:107], v44, s[24:27], s46 offen offset:0 sc1
  v_cvt_pk_bf16_f32 v128, v120, v121
  v_cvt_pk_bf16_f32 v129, v122, v123
  v_cvt_pk_bf16_f32 v130, v124, v125
  v_cvt_pk_bf16_f32 v131, v126, v127
  buffer_store_dwordx4 v[128:131], v44, s[24:27], s46 offen offset:256 sc1
  v_cvt_pk_bf16_f32 v152, v144, v145
  v_cvt_pk_bf16_f32 v153, v146, v147
  v_cvt_pk_bf16_f32 v154, v148, v149
  v_cvt_pk_bf16_f32 v155, v150, v151
  buffer_store_dwordx4 v[152:155], v44, s[24:27], s46 offen offset:512 sc1
  s_waitcnt vmcnt(11)
  s_branch L_s2
L_att1:
  s_add_u32 m0, s41, 112128
  s_nop 0
  buffer_load_dwordx4 v33, s[16:19], s64 offen offset:0 lds
  s_add_u32 m0, s41, 119424
  s_nop 0
  buffer_load_dwordx4 v33, s[16:19], s64 offen offset:896 lds
  s_add_u32 m0, s41, 126720
  s_nop 0
  buffer_load_dwordx4 v33, s[16:19], s64 offen offset:1792 lds
  v_lshlrev_b32 v5, 7, v2
  v_add_u32 v5, 0, v5
  v_lshrrev_b32 v4, 1, v2
  v_xor_b32 v4, v4, v3
  v_lshl_add_u32 v13, v4, 4, v5
  v_bfe_u32 v4, v1, 2, 2
  v_lshl_add_u32 v5, v3, 3, v4
  v_lshlrev_b32 v5, 8, v5
  v_add_u32 v5, 56832, v5
  v_and_b32 v6, 1, v3
  v_lshl_add_u32 v4, v6, 2, v4
  v_lshlrev_b32 v4, 5, v4
  v_and_b32 v6, 3, v1
  s_mul_i32 s52, s29, 56
  v_lshl_add_u32 v7, v6, 3, s52
  v_xor_b32 v8, v7, v4
  v_add_u32 v17, v8, v5
  v_mov_b32 v8, 224
  v_add_u32 v7, 32, v7
  v_cmp_eq_u32 vcc, 3, v6
  s_nop 1
  v_cndmask_b32 v7, v7, v8, vcc
  v_xor_b32 v8, v7, v4
  v_and_b32 v4, 7, v1
  v_lshlrev_b32 v4, 4, v4
  v_add_u32 v4, 14208, v4
  v_mov_b32 v6, 0x3f803f80
  v_mov_b32 v7, 0x3f803f80
  v_add_u32 v18, v8, v5
  v_mov_b32 v8, 0x3f803f80
  v_mov_b32 v9, 0x3f803f80
  v_add_u32 v5, 65536, v4
  ds_write_b128 v4, v[6:9] offset:42496
  ds_write_b128 v5, v[6:9] offset:32256
  ds_write_b128 v4, v[6:9] offset:26112
  ds_write_b128 v4, v[6:9] offset:3584
  s_waitcnt vmcnt(3) lgkmcnt(0)
  s_barrier
  ds_read_b64_tr_b16 a[8:9], v17 offset:24576
  ds_read_b64_tr_b16 a[10:11], v17 offset:25600
  ds_read_b128 v[36:39], v13 offset:54784
  ds_read_b64_tr_b16 a[12:13], v18 offset:24576
  ds_read_b64_tr_b16 a[14:15], v18 offset:25600
  ds_read_b64_tr_b16 a[0:1], v17 offset:16384
  ds_read_b64_tr_b16 a[2:3], v17 offset:17408
  ds_read_b64_tr_b16 a[4:5], v18 offset:16384
  ds_read_b64_tr_b16 a[6:7], v18 offset:17408
  ds_read_b64_tr_b16 a[16:17], v17 offset:32768
  ds_read_b64_tr_b16 a[18:19], v17 offset:33792
  ds_read_b64_tr_b16 a[20:21], v18 offset:32768
  ds_read_b64_tr_b16 a[22:23], v18 offset:33792
  ds_read_b128 v[40:43], v13 offset:52736
  ds_read_b128 v[136:139], v13 offset:50688
  s_waitcnt lgkmcnt(12)
  v_mfma_f32_16x16x32_bf16 v[112:115], a[8:11], v[36:39], 0
  s_mov_b32 s64, 172032
  s_add_u32 m0, s41, 136704
  s_mul_i32 s52, s29, 135168
  s_mov_b32 s66, 1463426304
  s_mov_b32 s67, 488447261
  s_waitcnt lgkmcnt(10)
  v_mfma_f32_16x16x32_bf16 v[116:119], a[12:15], v[36:39], 0
  v_add_u32 v19, 49152, v17
  v_xor_b32 v14, 64, v13
  s_add_u32 s46, s46, s52
  s_cmp_ge_u32 s56, 4
  s_cselect_b32 s66, 3417215348, s66
  s_cselect_b32 s67, 471670045, s67
  s_waitcnt lgkmcnt(8)
  v_mfma_f32_16x16x32_bf16 v[128:131], a[0:3], v[36:39], 0
  buffer_load_dwordx4 v32, s[16:19], s64 offen offset:0 lds
  s_add_u32 m0, s41, 144000
  s_lshl_b32 s47, s56, 3
  s_lshl_b32 s52, s29, 8
  s_lshr_b32 s66, s66, s47
  s_waitcnt lgkmcnt(6)
  v_mfma_f32_16x16x32_bf16 v[132:135], a[4:7], v[36:39], 0
  ds_read_b128 v[140:143], v14 offset:54784
  v_add_u32 v20, 49152, v18
  s_lshr_b32 s67, s67, s47
  s_add_u32 s52, s52, 1536
  s_and_b32 s47, s66, 255
  s_waitcnt lgkmcnt(5)
  v_mfma_f32_16x16x32_bf16 v[120:123], v[36:39], a[16:19], 0
  buffer_load_dwordx4 v32, s[16:19], s64 offen offset:896 lds
  s_add_u32 m0, s41, 151296
  s_add_u32 s47, s47, s57
  s_mul_i32 s66, s47, 9363
  s_and_b32 s77, s67, 255
  s_waitcnt lgkmcnt(3)
  v_mfma_f32_16x16x32_bf16 v[124:127], v[36:39], a[20:23], 0
  ds_read_b128 v[144:147], v14 offset:52736
  v_add_u32 v21, 65536, v13
  s_lshr_b32 s66, s66, 16
  s_mul_i32 s67, s66, 7
  s_sub_u32 s67, s47, s67
  s_waitcnt lgkmcnt(3)
  v_mfma_f32_16x16x32_bf16 v[88:91], a[8:11], v[40:43], 0
  s_lshl_b32 s72, s67, 2
  ds_read_b128 v[148:151], v14 offset:50688
  v_add_u32 v22, 65536, v14
  s_cmp_ge_u32 s30, 6
  s_mov_b32 s42, 9474192
  s_cselect_b32 s42, 8421504, s42
  v_mfma_f32_16x16x32_bf16 v[92:95], a[12:15], v[40:43], 0
  s_lshr_b32 s42, s42, s72
  buffer_load_dwordx4 v32, s[16:19], s64 offen offset:1792 lds
  s_add_u32 m0, s41, 97664
  s_cmp_ge_u32 s30, 6
  s_cselect_b32 s75, 28, 32
  s_cselect_b32 s73, 16, 19
  s_cselect_b32 s74, 0, s32
  v_mfma_f32_16x16x32_bf16 v[104:107], a[0:3], v[40:43], 0
  s_mul_i32 s75, s75, 896
  v_mul_u32_u24 v4, 33792, v3
  v_lshl_add_u32 v44, v2, 4, v4
  s_and_b32 s42, s42, 15
  s_mul_i32 s47, s31, 14336
  s_mov_b32 s10, 1605632
  v_mfma_f32_16x16x32_bf16 v[108:111], a[4:7], v[40:43], 0
  s_mov_b32 s6, 401408
  buffer_load_dwordx4 v10, s[12:15], s34 offen offset:128 lds
  s_add_u32 m0, s41, 105856
  s_mul_i32 s74, s74, 544768
  s_mul_i32 s72, s42, s75
  s_add_u32 s72, s72, s74
  v_mfma_f32_16x16x32_bf16 v[96:99], v[40:43], a[16:19], 0
  s_lshl_b32 s76, s30, 11
  v_lshlrev_b32 v4, 2, v3
  v_sub_u32 v4, v2, v4
  s_cmp_ge_u32 s30, 6
  s_cselect_b32 s68, s4, s8
  s_cselect_b32 s69, s5, s9
  s_cselect_b32 s70, s6, s10
  v_mfma_f32_16x16x32_bf16 v[100:103], v[40:43], a[20:23], 0
  s_mov_b64 exec, s[44:45]
  buffer_load_dwordx4 v10, s[12:15], s35 offen offset:128 lds
  s_mov_b64 exec, -1
  s_add_u32 m0, s41, 56832
  s_cmp_ge_u32 s57, s77
  s_cselect_b32 s70, 0, s70
  s_waitcnt lgkmcnt(3)
  v_mfma_f32_16x16x32_bf16 v[64:67], a[8:11], v[136:139], 0
  s_waitcnt vmcnt(4)
  s_barrier
  ds_read_b64_tr_b16 a[32:33], v19 offset:14336
  s_mov_b32 s71, 0x20000
  s_lshl_b32 s58, s29, 6
  s_mov_b32 s27, 0x20000
  v_mfma_f32_16x16x32_bf16 v[68:71], a[12:15], v[136:139], 0
  s_mov_b32 s26, 9797632
  ds_read_b64_tr_b16 a[34:35], v19 offset:15360
  v_subrev_u32 v6, 0, v4
  s_mul_i32 s73, s73, s75
  s_add_u32 s73, s73, s74
  s_mov_b32 s62, 0x80008000
  v_mfma_f32_16x16x32_bf16 v[80:83], a[0:3], v[136:139], 0
  s_mov_b32 s63, 0x80008000
  ds_read_b64_tr_b16 a[36:37], v20 offset:14336
  v_and_b32 v7, 0x80000001, v6
  s_mov_b32 s38, 0
  s_mov_b32 s39, 0xffff0000
  s_mov_b32 s11, 0x20000
  v_mfma_f32_16x16x32_bf16 v[84:87], a[4:7], v[136:139], 0
  s_mov_b32 s7, 0x20000
  ds_read_b64_tr_b16 a[38:39], v20 offset:15360
  v_mov_b32 v5, 0xff800000
  s_mov_b32 s3, 896
  v_mfma_f32_16x16x32_bf16 v[72:75], v[136:139], a[16:19], 0
  buffer_load_dwordx4 v33, s[16:19], s64 offen offset:0 lds
  s_add_u32 m0, s41, 64128
  ds_read_b64_tr_b16 a[24:25], v19 offset:6144
  v_mfma_f32_16x16x32_bf16 v[76:79], v[136:139], a[20:23], 0
  s_waitcnt lgkmcnt(3)
  ds_read_b64_tr_b16 a[26:27], v19 offset:7168
  v_cmp_eq_u32 vcc, 0, v7
  ds_read_b64_tr_b16 a[28:29], v20 offset:6144
  v_mfma_f32_16x16x32_bf16 v[112:115], a[32:35], v[140:143], v[112:115]
  s_waitcnt lgkmcnt(3)
  ds_read_b64_tr_b16 a[30:31], v20 offset:7168
  v_cndmask_b32 v160, v5, 0, vcc
  ds_read_b64_tr_b16 a[40:41], v19 offset:22528
  v_mfma_f32_16x16x32_bf16 v[116:119], a[36:39], v[140:143], v[116:119]
  buffer_load_dwordx4 v33, s[16:19], s64 offen offset:896 lds
  s_add_u32 m0, s41, 71424
  ds_read_b64_tr_b16 a[42:43], v19 offset:23552
  ds_read_b64_tr_b16 a[44:45], v20 offset:22528
  ds_read_b64_tr_b16 a[46:47], v20 offset:23552
  v_cmp_eq_u32 vcc, 0x80000000, v7
  v_subrev_u32 v6, 1, v4
  s_nop 0
  v_cndmask_b32 v164, v5, 0, vcc
  v_and_b32 v7, 0x80000001, v6
  v_cmp_eq_u32 vcc, 0, v7
  s_waitcnt lgkmcnt(6)
  v_mfma_f32_16x16x32_bf16 v[128:131], a[24:27], v[140:143], v[128:131]
  s_waitcnt lgkmcnt(4)
  v_cndmask_b32 v161, v5, 0, vcc
  v_cmp_eq_u32 vcc, 0x80000000, v7
  v_mfma_f32_16x16x32_bf16 v[132:135], a[28:31], v[140:143], v[132:135]
  v_subrev_u32 v6, 2, v4
  v_cndmask_b32 v165, v5, 0, vcc
  v_and_b32 v7, 0x80000001, v6
  v_cmp_eq_u32 vcc, 0, v7
  s_waitcnt lgkmcnt(2)
  v_mfma_f32_16x16x32_bf16 v[120:123], v[140:143], a[40:43], v[120:123]
  s_waitcnt lgkmcnt(0)
  v_cndmask_b32 v162, v5, 0, vcc
  v_cmp_eq_u32 vcc, 0x80000000, v7
  v_mfma_f32_16x16x32_bf16 v[124:127], v[140:143], a[44:47], v[124:127]
  buffer_load_dwordx4 v33, s[16:19], s64 offen offset:1792 lds
  s_mov_b32 s64, 344064
  s_add_u32 m0, s41, 81408
  v_mfma_f32_16x16x32_bf16 v[88:91], a[32:35], v[144:147], v[88:91]
  v_subrev_u32 v6, 3, v4
  v_cndmask_b32 v166, v5, 0, vcc
  v_mfma_f32_16x16x32_bf16 v[92:95], a[36:39], v[144:147], v[92:95]
  v_and_b32 v7, 0x80000001, v6
  v_cmp_eq_u32 vcc, 0, v7
  v_mfma_f32_16x16x32_bf16 v[104:107], a[24:27], v[144:147], v[104:107]
  s_nop 0
  v_cndmask_b32 v163, v5, 0, vcc
  v_cmp_eq_u32 vcc, 0x80000000, v7
  v_mfma_f32_16x16x32_bf16 v[108:111], a[28:31], v[144:147], v[108:111]
  buffer_load_dwordx4 v32, s[16:19], s64 offen offset:0 lds
  s_add_u32 m0, s41, 88704
  v_mfma_f32_16x16x32_bf16 v[96:99], v[144:147], a[40:43], v[96:99]
  v_cndmask_b32 v167, v5, 0, vcc
  v_and_b32 v6, 1, v2
  v_mfma_f32_16x16x32_bf16 v[100:103], v[144:147], a[44:47], v[100:103]
  v_cmp_eq_u32 vcc, 1, v6
  v_mov_b32 v7, 0xffff
  v_mfma_f32_16x16x32_bf16 v[64:67], a[32:35], v[148:151], v[64:67]
  v_mov_b32 v8, 0xffff0000
  v_lshl_add_u32 v34, v3, 6, s52
  s_lshl_b32 s52, s29, 7
  s_add_u32 s52, s52, 2560
  v_mfma_f32_16x16x32_bf16 v[68:71], a[36:39], v[148:151], v[68:71]
  v_cndmask_b32 v7, v7, v8, vcc
  v_lshl_add_u32 v6, v3, 2, v6
  v_mfma_f32_16x16x32_bf16 v[80:83], a[24:27], v[148:151], v[80:83]
  v_add_u32 v8, 0, v6
  v_cmp_gt_u32 vcc, v8, v2
  v_mfma_f32_16x16x32_bf16 v[84:87], a[28:31], v[148:151], v[84:87]
  v_subrev_u32 v9, 16, v8
  v_cndmask_b32 v8, v8, v9, vcc
  v_mfma_f32_16x16x32_bf16 v[72:75], v[148:151], a[40:43], v[72:75]
  v_lshl_add_u32 v24, v2, 3, s52
  v_lshlrev_b32 v8, 2, v8
  s_lshl_b32 s52, s29, 11
  s_add_u32 s52, s52, 17920
  v_mfma_f32_16x16x32_bf16 v[76:79], v[148:151], a[44:47], v[76:79]
  v_lshlrev_b32 v4, 1, v3
  v_and_b32 v5, 7, v1
  v_add_u32 v25, 1024, v8
  v_xor_b32 v4, v4, v5
  v_add_u32 v8, 2, v6
  v_lshl_add_u32 v45, v1, 4, s52
  v_lshrrev_b32 v5, 3, v1
  v_mul_u32_u24 v6, 896, v5
  s_lshl_b32 s52, s67, 7
  v_lshl_add_u32 v6, v4, 4, v6
  s_add_u32 s47, s47, s52
  v_add_u32 v11, s47, v6
  v_add_u32 v12, s72, v11
  v_cndmask_b32 v172, 0, v7, vcc
  v_cndmask_b32 v174, v7, 0, vcc
  v_cmp_gt_u32 vcc, v8, v2
  v_subrev_u32 v9, 16, v8
  s_nop 0
  v_cndmask_b32 v8, v8, v9, vcc
  v_add_u32 v9, 7168, v12
  v_add_u32 v52, s58, v1
  v_min_u32 v52, 126, v52
  s_waitcnt vmcnt(4)
  s_barrier
  ds_read_b64_tr_b16 a[8:9], v19 offset:38912
  ds_read_b64_tr_b16 a[10:11], v19 offset:39936
  ds_read_b128 v[36:39], v21 offset:44544
  buffer_load_dwordx4 v32, s[16:19], s64 offen offset:896 lds
  s_add_u32 m0, s41, 110336
  s_nop 0
  buffer_load_dwordx4 v32, s[16:19], s64 offen offset:1792 lds
  ds_read_b64_tr_b16 a[12:13], v20 offset:38912
  s_add_u32 m0, s41, 25856
  ds_read_b64_tr_b16 a[14:15], v20 offset:39936
  ds_read_b64_tr_b16 a[0:1], v19 offset:30720
  ds_read_b64_tr_b16 a[2:3], v19 offset:31744
  ds_read_b64_tr_b16 a[4:5], v20 offset:30720
  ds_read_b64_tr_b16 a[6:7], v20 offset:31744
  ds_read_b64_tr_b16 a[16:17], v19 offset:47104
  ds_read_b64_tr_b16 a[18:19], v19 offset:48128
  ds_read_b64_tr_b16 a[20:21], v20 offset:47104
  ds_read_b64_tr_b16 a[22:23], v20 offset:48128
  ds_read_b128 v[40:43], v21 offset:42496
  ds_read_b128 v[136:139], v21 offset:40448
  ds_read_b128 v[140:143], v22 offset:44544
  ds_read_b128 v[144:147], v22 offset:42496
  ds_read_b128 v[148:151], v22 offset:40448
  v_lshlrev_b32 v30, 2, v52
  v_add_u32 v52, s33, v52
  v_max_i32 v52, 0, v52
  v_min_u32 v52, 2047, v52
  v_mov_b32 v58, 0
  v_lshlrev_b32 v52, 4, v52
  v_add_u32 v52, 9764864, v52
  v_cndmask_b32 v173, 0, v7, vcc
  s_waitcnt lgkmcnt(15)
  v_mfma_f32_16x16x32_bf16 v[112:115], a[8:11], v[36:39], v[112:115]
  v_cndmask_b32 v175, v7, 0, vcc
  v_lshrrev_b32 v6, 2, v1
  s_lshl_b32 s47, s32, 12
  s_add_u32 s47, s47, 26112
  s_waitcnt lgkmcnt(13)
  v_mfma_f32_16x16x32_bf16 v[116:119], a[12:15], v[36:39], v[116:119]
  s_waitcnt lgkmcnt(11)
  buffer_load_dwordx4 v10, s[12:15], s34 offen offset:256 lds
  s_add_u32 m0, s41, 34048
  s_add_u32 s72, s72, s75
  s_cmp_eq_u32 s72, s73
  s_cselect_b32 s72, s74, s72
  v_mfma_f32_16x16x32_bf16 v[128:131], a[0:3], v[36:39], v[128:131]
  s_waitcnt lgkmcnt(9)
  v_lshlrev_b32 v6, 7, v6
  v_and_b32 v7, 3, v1
  v_mfma_f32_16x16x32_bf16 v[132:135], a[4:7], v[36:39], v[132:135]
  s_waitcnt lgkmcnt(7)
  v_lshl_add_u32 v6, v7, 3, v6
  v_bfe_u32 v7, v1, 3, 2
  v_mfma_f32_16x16x32_bf16 v[120:123], v[36:39], a[16:19], v[120:123]
  s_mov_b64 exec, s[44:45]
  buffer_load_dwordx4 v10, s[12:15], s35 offen offset:256 lds
  s_mov_b64 exec, -1
  s_add_u32 m0, s41, 120320
  s_waitcnt lgkmcnt(5)
  v_mfma_f32_16x16x32_bf16 v[124:127], v[36:39], a[20:23], v[124:127]
  s_waitcnt lgkmcnt(4)
  v_xor_b32 v7, s32, v7
  v_lshl_add_u32 v6, v7, 5, v6
  v_mfma_f32_16x16x32_bf16 v[88:91], a[8:11], v[40:43], v[88:91]
  v_add_u32 v4, s47, v6
  v_xor_b32 v5, 32, v4
  v_mfma_f32_16x16x32_bf16 v[92:95], a[12:15], v[40:43], v[92:95]
  buffer_load_dwordx4 v33, s[16:19], s64 offen offset:0 lds
  s_add_u32 m0, s41, 127616
  v_mfma_f32_16x16x32_bf16 v[104:107], a[0:3], v[40:43], v[104:107]
  v_xor_b32 v6, 64, v4
  v_xor_b32 v7, 96, v4
  v_mfma_f32_16x16x32_bf16 v[108:111], a[4:7], v[40:43], v[108:111]
  s_waitcnt vmcnt(5)
  s_barrier
  ds_read_b64_tr_b16 a[32:33], v17 offset:8192
  v_mfma_f32_16x16x32_bf16 v[96:99], v[40:43], a[16:19], v[96:99]
  ds_read_b64_tr_b16 a[34:35], v17 offset:9216
  v_lshlrev_b32 v27, 2, v2
  v_mfma_f32_16x16x32_bf16 v[100:103], v[40:43], a[20:23], v[100:103]
  s_waitcnt lgkmcnt(5)
  buffer_load_dwordx4 v33, s[16:19], s64 offen offset:896 lds
  s_add_u32 m0, s41, 134912
  v_mfma_f32_16x16x32_bf16 v[64:67], a[8:11], v[136:139], v[64:67]
  ds_read_b64_tr_b16 a[36:37], v18 offset:8192
  v_lshlrev_b32 v8, 2, v8
  v_mfma_f32_16x16x32_bf16 v[68:71], a[12:15], v[136:139], v[68:71]
  ds_read_b64_tr_b16 a[38:39], v18 offset:9216
  v_add_u32 v26, 1024, v8
  v_mfma_f32_16x16x32_bf16 v[80:83], a[0:3], v[136:139], v[80:83]
  buffer_load_dwordx4 v33, s[16:19], s64 offen offset:1792 lds
  s_mov_b32 s64, 516096
  s_add_u32 m0, s41, 144896
  v_mfma_f32_16x16x32_bf16 v[84:87], a[4:7], v[136:139], v[84:87]
  ds_read_b64_tr_b16 a[24:25], v17 offset:0
  v_lshlrev_b32 v8, 4, v3
  v_mfma_f32_16x16x32_bf16 v[72:75], v[136:139], a[16:19], v[72:75]
  ds_read_b64_tr_b16 a[26:27], v17 offset:1024
  v_mfma_f32_16x16x32_bf16 v[76:79], v[136:139], a[20:23], v[76:79]
  s_waitcnt lgkmcnt(4)
  buffer_load_dwordx4 v32, s[16:19], s64 offen offset:0 lds
  s_add_u32 m0, s41, 152192
  ds_read_b64_tr_b16 a[28:29], v18 offset:0
  v_mfma_f32_16x16x32_bf16 v[112:115], a[32:35], v[140:143], v[112:115]
  s_waitcnt lgkmcnt(3)
  ds_read_b64_tr_b16 a[30:31], v18 offset:1024
  ds_read_b64_tr_b16 a[40:41], v17 offset:16384
  v_mfma_f32_16x16x32_bf16 v[116:119], a[36:39], v[140:143], v[116:119]
  s_waitcnt lgkmcnt(3)
  ds_read_b64_tr_b16 a[42:43], v17 offset:17408
  ds_read_b64_tr_b16 a[44:45], v18 offset:16384
  v_mfma_f32_16x16x32_bf16 v[128:131], a[24:27], v[140:143], v[128:131]
  s_waitcnt lgkmcnt(3)
  ds_read_b64_tr_b16 a[46:47], v18 offset:17408
  buffer_load_dwordx4 v32, s[16:19], s64 offen offset:896 lds
  s_add_u32 m0, s41, 3200
  v_mfma_f32_16x16x32_bf16 v[132:135], a[28:31], v[140:143], v[132:135]
  s_waitcnt lgkmcnt(2)
  v_mfma_f32_16x16x32_bf16 v[120:123], v[140:143], a[40:43], v[120:123]
  s_waitcnt lgkmcnt(0)
  v_mfma_f32_16x16x32_bf16 v[124:127], v[140:143], a[44:47], v[124:127]
  buffer_load_dwordx4 v10, s[12:15], s34 offen offset:384 lds
  s_add_u32 m0, s41, 55040
  v_mfma_f32_16x16x32_bf16 v[88:91], a[32:35], v[144:147], v[88:91]
  v_mfma_f32_16x16x32_bf16 v[92:95], a[36:39], v[144:147], v[92:95]
  v_mfma_f32_16x16x32_bf16 v[104:107], a[24:27], v[144:147], v[104:107]
  v_mfma_f32_16x16x32_bf16 v[108:111], a[28:31], v[144:147], v[108:111]
  v_mfma_f32_16x16x32_bf16 v[96:99], v[144:147], a[40:43], v[96:99]
  v_mfma_f32_16x16x32_bf16 v[100:103], v[144:147], a[44:47], v[100:103]
  v_mfma_f32_16x16x32_bf16 v[64:67], a[32:35], v[148:151], v[64:67]
  v_mfma_f32_16x16x32_bf16 v[68:71], a[36:39], v[148:151], v[68:71]
  v_mfma_f32_16x16x32_bf16 v[80:83], a[24:27], v[148:151], v[80:83]
  s_waitcnt vmcnt(6)
  s_barrier
  buffer_load_dwordx4 v32, s[16:19], s64 offen offset:1792 lds
  s_add_u32 m0, s41, 11392
  s_mov_b64 exec, s[44:45]
  buffer_load_dwordx4 v10, s[12:15], s35 offen offset:384 lds
  s_mov_b64 exec, -1
  ds_read_b64_tr_b16 a[8:9], v17 offset:32768
  v_mfma_f32_16x16x32_bf16 v[84:87], a[28:31], v[148:151], v[84:87]
  s_add_u32 m0, s41, 65024
  ds_read_b64_tr_b16 a[10:11], v17 offset:33792
  ds_read_b128 v[36:39], v13 offset:38400
  buffer_load_dwordx4 v33, s[16:19], s64 offen offset:0 lds
  ds_read_b64_tr_b16 a[12:13], v18 offset:32768
  v_mfma_f32_16x16x32_bf16 v[72:75], v[148:151], a[40:43], v[72:75]
  s_add_u32 m0, s41, 72320
  ds_read_b64_tr_b16 a[14:15], v18 offset:33792
  ds_read_b64_tr_b16 a[0:1], v17 offset:24576
  v_mfma_f32_16x16x32_bf16 v[76:79], v[148:151], a[44:47], v[76:79]
  ds_read_b64_tr_b16 a[2:3], v17 offset:25600
  ds_read_b64_tr_b16 a[4:5], v18 offset:24576
  ds_read_b64_tr_b16 a[6:7], v18 offset:25600
  ds_read_b64_tr_b16 a[16:17], v19 offset:6144
  ds_read_b64_tr_b16 a[18:19], v19 offset:7168
  ds_read_b64_tr_b16 a[20:21], v20 offset:6144
  ds_read_b64_tr_b16 a[22:23], v20 offset:7168
  ds_read_b128 v[40:43], v13 offset:36352
  ds_read_b128 v[136:139], v13 offset:34304
  s_waitcnt lgkmcnt(12)
  v_mfma_f32_16x16x32_bf16 v[112:115], a[8:11], v[36:39], v[112:115]
  s_waitcnt lgkmcnt(10)
  buffer_load_dwordx4 v33, s[16:19], s64 offen offset:896 lds
  s_add_u32 m0, s41, 41984
  v_mfma_f32_16x16x32_bf16 v[116:119], a[12:15], v[36:39], v[116:119]
  s_waitcnt lgkmcnt(8)
  ds_read_b128 v[140:143], v14 offset:38400
  v_mfma_f32_16x16x32_bf16 v[128:131], a[0:3], v[36:39], v[128:131]
  s_waitcnt lgkmcnt(7)
  ds_read_b128 v[144:147], v14 offset:36352
  v_mfma_f32_16x16x32_bf16 v[132:135], a[4:7], v[36:39], v[132:135]
  s_waitcnt lgkmcnt(6)
  buffer_load_dwordx4 v10, s[12:15], s34 offen offset:512 lds
  s_add_u32 m0, s41, 79616
  v_mfma_f32_16x16x32_bf16 v[120:123], v[36:39], a[16:19], v[120:123]
  s_waitcnt lgkmcnt(4)
  ds_read_b128 v[148:151], v14 offset:34304
  v_mfma_f32_16x16x32_bf16 v[124:127], v[36:39], a[20:23], v[124:127]
  s_waitcnt vmcnt(7)
  s_barrier
  s_waitcnt lgkmcnt(4)
  v_mfma_f32_16x16x32_bf16 v[88:91], a[8:11], v[40:43], v[88:91]
  ds_read_b64_tr_b16 a[32:33], v19 offset:22528
  v_mfma_f32_16x16x32_bf16 v[92:95], a[12:15], v[40:43], v[92:95]
  buffer_load_dwordx4 v33, s[16:19], s64 offen offset:1792 lds
  s_mov_b32 s64, 688128
  s_add_u32 m0, s41, 89600
  v_mfma_f32_16x16x32_bf16 v[104:107], a[0:3], v[40:43], v[104:107]
  ds_read_b64_tr_b16 a[34:35], v19 offset:23552
  v_mfma_f32_16x16x32_bf16 v[108:111], a[4:7], v[40:43], v[108:111]
  ds_read_b64_tr_b16 a[36:37], v20 offset:22528
  v_mfma_f32_16x16x32_bf16 v[96:99], v[40:43], a[16:19], v[96:99]
  ds_read_b64_tr_b16 a[38:39], v20 offset:23552
  v_mfma_f32_16x16x32_bf16 v[100:103], v[40:43], a[20:23], v[100:103]
  s_waitcnt lgkmcnt(7)
  buffer_load_dwordx4 v32, s[16:19], s64 offen offset:0 lds
  s_add_u32 m0, s41, 111232
  v_mfma_f32_16x16x32_bf16 v[64:67], a[8:11], v[136:139], v[64:67]
  ds_read_b64_tr_b16 a[24:25], v19 offset:14336
  v_mfma_f32_16x16x32_bf16 v[68:71], a[12:15], v[136:139], v[68:71]
  ds_read_b64_tr_b16 a[26:27], v19 offset:15360
  v_mfma_f32_16x16x32_bf16 v[80:83], a[0:3], v[136:139], v[80:83]
  ds_read_b64_tr_b16 a[28:29], v20 offset:14336
  v_mfma_f32_16x16x32_bf16 v[84:87], a[4:7], v[136:139], v[84:87]
  buffer_load_dwordx4 v32, s[16:19], s64 offen offset:896 lds
  s_add_u32 m0, s41, 50176
  v_mfma_f32_16x16x32_bf16 v[72:75], v[136:139], a[16:19], v[72:75]
  ds_read_b64_tr_b16 a[30:31], v20 offset:15360
  v_mfma_f32_16x16x32_bf16 v[76:79], v[136:139], a[20:23], v[76:79]
  s_waitcnt lgkmcnt(6)
  ds_read_b64_tr_b16 a[40:41], v19 offset:30720
  v_mfma_f32_16x16x32_bf16 v[112:115], a[32:35], v[140:143], v[112:115]
  s_waitcnt lgkmcnt(5)
  ds_read_b64_tr_b16 a[42:43], v19 offset:31744
  ds_read_b64_tr_b16 a[44:45], v20 offset:30720
  v_mfma_f32_16x16x32_bf16 v[116:119], a[36:39], v[140:143], v[116:119]
  ds_read_b64_tr_b16 a[46:47], v20 offset:31744
  s_mov_b64 exec, s[44:45]
  buffer_load_dwordx4 v10, s[12:15], s35 offen offset:512 lds
  s_mov_b64 exec, -1
  s_waitcnt lgkmcnt(6)
  v_mfma_f32_16x16x32_bf16 v[128:131], a[24:27], v[140:143], v[128:131]
  s_waitcnt lgkmcnt(4)
  s_add_u32 m0, s41, 118528
  v_mfma_f32_16x16x32_bf16 v[132:135], a[28:31], v[140:143], v[132:135]
  s_waitcnt lgkmcnt(2)
  v_mfma_f32_16x16x32_bf16 v[120:123], v[140:143], a[40:43], v[120:123]
  s_waitcnt lgkmcnt(0)
  v_mfma_f32_16x16x32_bf16 v[124:127], v[140:143], a[44:47], v[124:127]
  v_mfma_f32_16x16x32_bf16 v[88:91], a[32:35], v[144:147], v[88:91]
  s_waitcnt vmcnt(6)
  s_barrier
  buffer_load_dwordx4 v32, s[16:19], s64 offen offset:1792 lds
  s_add_u32 m0, s41, 128512
  v_mfma_f32_16x16x32_bf16 v[92:95], a[36:39], v[144:147], v[92:95]
  ds_read_b64_tr_b16 a[8:9], v19 offset:47104
  v_mfma_f32_16x16x32_bf16 v[104:107], a[24:27], v[144:147], v[104:107]
  ds_read_b64_tr_b16 a[10:11], v19 offset:48128
  v_mfma_f32_16x16x32_bf16 v[108:111], a[28:31], v[144:147], v[108:111]
  ds_read_b128 v[36:39], v13 offset:15872
  v_mfma_f32_16x16x32_bf16 v[96:99], v[144:147], a[40:43], v[96:99]
  buffer_load_dwordx4 v33, s[16:19], s64 offen offset:0 lds
  s_add_u32 m0, s41, 135808
  v_mfma_f32_16x16x32_bf16 v[100:103], v[144:147], a[44:47], v[100:103]
  ds_read_b64_tr_b16 a[12:13], v20 offset:47104
  v_mfma_f32_16x16x32_bf16 v[64:67], a[32:35], v[148:151], v[64:67]
  ds_read_b64_tr_b16 a[14:15], v20 offset:48128
  v_mfma_f32_16x16x32_bf16 v[68:71], a[36:39], v[148:151], v[68:71]
  ds_read_b64_tr_b16 a[0:1], v19 offset:38912
  v_mfma_f32_16x16x32_bf16 v[80:83], a[24:27], v[148:151], v[80:83]
  buffer_load_dwordx4 v33, s[16:19], s64 offen offset:896 lds
  s_add_u32 m0, s41, 97152
  v_mfma_f32_16x16x32_bf16 v[84:87], a[28:31], v[148:151], v[84:87]
  ds_read_b64_tr_b16 a[2:3], v19 offset:39936
  v_mfma_f32_16x16x32_bf16 v[72:75], v[148:151], a[40:43], v[72:75]
  ds_read_b64_tr_b16 a[4:5], v20 offset:38912
  v_mfma_f32_16x16x32_bf16 v[76:79], v[148:151], a[44:47], v[76:79]
  s_waitcnt lgkmcnt(5)
  ds_read_b64_tr_b16 a[6:7], v20 offset:39936
  v_mfma_f32_16x16x32_bf16 v[112:115], a[8:11], v[36:39], v[112:115]
  s_waitcnt lgkmcnt(4)
  ds_read_b64_tr_b16 a[16:17], v17 offset:0
  ds_read_b64_tr_b16 a[18:19], v17 offset:1024
  ds_read_b64_tr_b16 a[20:21], v18 offset:0
  v_mfma_f32_16x16x32_bf16 v[116:119], a[12:15], v[36:39], v[116:119]
  s_waitcnt lgkmcnt(5)
  ds_read_b64_tr_b16 a[22:23], v18 offset:1024
  buffer_load_dwordx4 v10, s[12:15], s34 offen offset:640 lds
  v_mfma_f32_16x16x32_bf16 v[128:131], a[0:3], v[36:39], v[128:131]
  s_waitcnt lgkmcnt(4)
  ds_read_b128 v[40:43], v13 offset:13824
  s_add_u32 m0, s76, 26112
  v_mfma_f32_16x16x32_bf16 v[132:135], a[4:7], v[36:39], v[132:135]
  s_waitcnt lgkmcnt(3)
  ds_read_b128 v[136:139], v13 offset:11776
  v_mfma_f32_16x16x32_bf16 v[120:123], v[36:39], a[16:19], v[120:123]
  s_waitcnt lgkmcnt(2)
  ds_read_b128 v[140:143], v14 offset:15872
  v_mfma_f32_16x16x32_bf16 v[124:127], v[36:39], a[20:23], v[124:127]
  s_waitcnt vmcnt(6)
  s_barrier
  buffer_load_dwordx4 v12, s[68:71], 0 offen lds
  s_waitcnt lgkmcnt(2)
  v_mfma_f32_16x16x32_bf16 v[88:91], a[8:11], v[40:43], v[88:91]
  s_add_u32 m0, s76, 27136
  ds_read_b64_tr_b16 a[32:33], v17 offset:16384
  v_add_u32 v12, s72, v11
  s_add_u32 s72, s72, s75
  s_cmp_eq_u32 s72, s73
  s_cselect_b32 s72, s74, s72
  v_mfma_f32_16x16x32_bf16 v[92:95], a[12:15], v[40:43], v[92:95]
  buffer_load_dwordx4 v9, s[68:71], 0 offen lds
  s_add_u32 m0, s41, 143104
  v_mfma_f32_16x16x32_bf16 v[104:107], a[0:3], v[40:43], v[104:107]
  ds_read_b64_tr_b16 a[34:35], v17 offset:17408
  v_add_u32 v9, 7168, v12
  v_mfma_f32_16x16x32_bf16 v[108:111], a[4:7], v[40:43], v[108:111]
  ds_read_b64_tr_b16 a[36:37], v18 offset:16384
  v_mfma_f32_16x16x32_bf16 v[96:99], v[40:43], a[16:19], v[96:99]
  buffer_load_dwordx4 v33, s[16:19], s64 offen offset:1792 lds
  s_mov_b32 s64, 860160
  s_add_u32 m0, s41, 153088
  v_mfma_f32_16x16x32_bf16 v[100:103], v[40:43], a[20:23], v[100:103]
  s_waitcnt lgkmcnt(4)
  ds_read_b64_tr_b16 a[38:39], v18 offset:17408
  v_mfma_f32_16x16x32_bf16 v[64:67], a[8:11], v[136:139], v[64:67]
  ds_read_b64_tr_b16 a[24:25], v17 offset:8192
  v_mfma_f32_16x16x32_bf16 v[68:71], a[12:15], v[136:139], v[68:71]
  buffer_load_dwordx4 v32, s[16:19], s64 offen offset:0 lds
  s_add_u32 m0, s41, 55936
  v_mfma_f32_16x16x32_bf16 v[80:83], a[0:3], v[136:139], v[80:83]
  ds_read_b64_tr_b16 a[26:27], v17 offset:9216
  v_mfma_f32_16x16x32_bf16 v[84:87], a[4:7], v[136:139], v[84:87]
  ds_read_b64_tr_b16 a[28:29], v18 offset:8192
  v_mfma_f32_16x16x32_bf16 v[72:75], v[136:139], a[16:19], v[72:75]
  buffer_load_dwordx4 v32, s[16:19], s64 offen offset:896 lds
  s_add_u32 m0, s41, 105344
  v_mfma_f32_16x16x32_bf16 v[76:79], v[136:139], a[20:23], v[76:79]
  s_waitcnt lgkmcnt(5)
  ds_read_b64_tr_b16 a[30:31], v18 offset:9216
  v_mfma_f32_16x16x32_bf16 v[112:115], a[32:35], v[140:143], v[112:115]
  s_waitcnt lgkmcnt(4)
  ds_read_b64_tr_b16 a[40:41], v17 offset:24576
  ds_read_b64_tr_b16 a[42:43], v17 offset:25600
  ds_read_b64_tr_b16 a[44:45], v18 offset:24576
  v_mfma_f32_16x16x32_bf16 v[116:119], a[36:39], v[140:143], v[116:119]
  ds_read_b64_tr_b16 a[46:47], v18 offset:25600
  s_mov_b64 exec, s[44:45]
  buffer_load_dwordx4 v10, s[12:15], s35 offen offset:640 lds
  s_mov_b64 exec, -1
  s_waitcnt lgkmcnt(6)
  v_mfma_f32_16x16x32_bf16 v[128:131], a[24:27], v[140:143], v[128:131]
  s_waitcnt lgkmcnt(4)
  ds_read_b128 v[144:147], v14 offset:13824
  s_add_u32 m0, s41, 63232
  v_mfma_f32_16x16x32_bf16 v[132:135], a[28:31], v[140:143], v[132:135]
  s_waitcnt lgkmcnt(3)
  ds_read_b128 v[148:151], v14 offset:11776
  v_mfma_f32_16x16x32_bf16 v[120:123], v[140:143], a[40:43], v[120:123]
  s_waitcnt lgkmcnt(2)
  v_mfma_f32_16x16x32_bf16 v[124:127], v[140:143], a[44:47], v[124:127]
  s_waitcnt vmcnt(8)
  s_barrier
  s_waitcnt lgkmcnt(1)
  v_mfma_f32_16x16x32_bf16 v[88:91], a[32:35], v[144:147], v[88:91]
  ds_read_b64_tr_b16 a[8:9], v19 offset:6144
  v_mfma_f32_16x16x32_bf16 v[92:95], a[36:39], v[144:147], v[92:95]
  buffer_load_dwordx4 v32, s[16:19], s64 offen offset:1792 lds
  s_add_u32 m0, s41, 73216
  v_mfma_f32_16x16x32_bf16 v[104:107], a[24:27], v[144:147], v[104:107]
  ds_read_b64_tr_b16 a[10:11], v19 offset:7168
  v_mfma_f32_16x16x32_bf16 v[108:111], a[28:31], v[144:147], v[108:111]
  ds_read_b128 v[36:39], v13 offset:54784
  v_mfma_f32_16x16x32_bf16 v[96:99], v[144:147], a[40:43], v[96:99]
  ds_read_b64_tr_b16 a[12:13], v20 offset:6144
  v_mfma_f32_16x16x32_bf16 v[100:103], v[144:147], a[44:47], v[100:103]
  s_waitcnt lgkmcnt(4)
  ds_read_b64_tr_b16 a[14:15], v20 offset:7168
  v_mfma_f32_16x16x32_bf16 v[64:67], a[32:35], v[148:151], v[64:67]
  buffer_load_dwordx4 v33, s[16:19], s64 offen offset:0 lds
  s_add_u32 m0, s41, 80512
  v_mfma_f32_16x16x32_bf16 v[68:71], a[36:39], v[148:151], v[68:71]
  ds_read_b64_tr_b16 a[0:1], v17 offset:32768
  v_mfma_f32_16x16x32_bf16 v[80:83], a[24:27], v[148:151], v[80:83]
  ds_read_b64_tr_b16 a[2:3], v17 offset:33792
  v_mfma_f32_16x16x32_bf16 v[84:87], a[28:31], v[148:151], v[84:87]
  ds_read_b64_tr_b16 a[4:5], v18 offset:32768
  v_mfma_f32_16x16x32_bf16 v[72:75], v[148:151], a[40:43], v[72:75]
  ds_read_b64_tr_b16 a[6:7], v18 offset:33792
  v_mfma_f32_16x16x32_bf16 v[76:79], v[148:151], a[44:47], v[76:79]
  s_waitcnt lgkmcnt(6)
  ds_read_b64_tr_b16 a[16:17], v19 offset:14336
  v_mfma_f32_16x16x32_bf16 v[112:115], a[8:11], v[36:39], v[112:115]
  s_waitcnt lgkmcnt(5)
  ds_read_b64_tr_b16 a[18:19], v19 offset:15360
  ds_read_b64_tr_b16 a[20:21], v20 offset:14336
  v_mfma_f32_16x16x32_bf16 v[116:119], a[12:15], v[36:39], v[116:119]
  s_waitcnt lgkmcnt(5)
  ds_read_b64_tr_b16 a[22:23], v20 offset:15360
  buffer_load_dwordx4 v33, s[16:19], s64 offen offset:896 lds
  v_mfma_f32_16x16x32_bf16 v[128:131], a[0:3], v[36:39], v[128:131]
  s_waitcnt lgkmcnt(4)
  ds_read_b128 v[40:43], v13 offset:52736
  s_add_u32 m0, s41, 87808
  v_mfma_f32_16x16x32_bf16 v[132:135], a[4:7], v[36:39], v[132:135]
  s_waitcnt lgkmcnt(3)
  ds_read_b128 v[136:139], v13 offset:50688
  v_mfma_f32_16x16x32_bf16 v[120:123], v[36:39], a[16:19], v[120:123]
  s_waitcnt lgkmcnt(2)
  ds_read_b128 v[140:143], v14 offset:54784
  v_mfma_f32_16x16x32_bf16 v[124:127], v[36:39], a[20:23], v[124:127]
  s_waitcnt vmcnt(5)
  s_barrier
  buffer_load_dwordx4 v33, s[16:19], s64 offen offset:1792 lds
  s_waitcnt lgkmcnt(2)
  v_mfma_f32_16x16x32_bf16 v[88:91], a[8:11], v[40:43], v[88:91]
  s_mov_b32 s64, 1032192
  s_add_u32 m0, s41, 112128
  v_mfma_f32_16x16x32_bf16 v[92:95], a[12:15], v[40:43], v[92:95]
  buffer_load_dwordx4 v32, s[16:19], s64 offen offset:0 lds
  s_add_u32 m0, s41, 119424
  v_mfma_f32_16x16x32_bf16 v[104:107], a[0:3], v[40:43], v[104:107]
  ds_read_b64_tr_b16 a[32:33], v19 offset:30720
  v_mfma_f32_16x16x32_bf16 v[108:111], a[4:7], v[40:43], v[108:111]
  ds_read_b64_tr_b16 a[34:35], v19 offset:31744
  v_mfma_f32_16x16x32_bf16 v[96:99], v[40:43], a[16:19], v[96:99]
  buffer_load_dwordx4 v32, s[16:19], s64 offen offset:896 lds
  s_add_u32 m0, s41, 2816
  v_mfma_f32_16x16x32_bf16 v[100:103], v[40:43], a[20:23], v[100:103]
  s_waitcnt lgkmcnt(3)
  ds_read_b64_tr_b16 a[36:37], v20 offset:30720
  v_mfma_f32_16x16x32_bf16 v[64:67], a[8:11], v[136:139], v[64:67]
  ds_read_b64_tr_b16 a[38:39], v20 offset:31744
  v_mfma_f32_16x16x32_bf16 v[68:71], a[12:15], v[136:139], v[68:71]
  buffer_load_dwordx4 v10, s[12:15], s34 offen offset:768 lds
  v_mfma_f32_16x16x32_bf16 v[80:83], a[0:3], v[136:139], v[80:83]
  ds_read_b64_tr_b16 a[24:25], v19 offset:22528
  v_mfma_f32_16x16x32_bf16 v[84:87], a[4:7], v[136:139], v[84:87]
  ds_read_b64_tr_b16 a[26:27], v19 offset:23552
  v_mfma_f32_16x16x32_bf16 v[72:75], v[136:139], a[16:19], v[72:75]
  global_load_dwordx2 v[58:59], v58, s[60:61] sc1
  v_mfma_f32_16x16x32_bf16 v[76:79], v[136:139], a[20:23], v[76:79]
  s_waitcnt lgkmcnt(4)
  ds_read_b64_tr_b16 a[28:29], v20 offset:22528
  v_mfma_f32_16x16x32_bf16 v[112:115], a[32:35], v[140:143], v[112:115]
  ds_read_b64_tr_b16 a[30:31], v20 offset:23552
  ds_read_b64_tr_b16 a[48:49], v4 offset:0
  ds_read_b64_tr_b16 a[50:51], v4 offset:2048
  ds_read_b64_tr_b16 a[52:53], v5 offset:0
  ds_read_b64_tr_b16 a[54:55], v5 offset:2048
  ds_read_b64_tr_b16 a[56:57], v6 offset:0
  ds_read_b64_tr_b16 a[40:41], v19 offset:38912
  ds_read_b64_tr_b16 a[58:59], v6 offset:2048
  ds_read_b64_tr_b16 a[42:43], v19 offset:39936
  ds_read_b64_tr_b16 a[60:61], v7 offset:0
  ds_read_b64_tr_b16 a[44:45], v20 offset:38912
  s_waitcnt lgkmcnt(14)
  v_mfma_f32_16x16x32_bf16 v[116:119], a[36:39], v[140:143], v[116:119]
  buffer_load_dwordx4 v[48:51], v52, s[24:27], 0 offen sc1
  s_add_u32 m0, s76, 26112
  ds_read_b64_tr_b16 a[62:63], v7 offset:2048
  ds_read_b64_tr_b16 a[46:47], v20 offset:39936
  s_waitcnt lgkmcnt(14)
  v_mfma_f32_16x16x32_bf16 v[128:131], a[24:27], v[140:143], v[128:131]
  s_waitcnt lgkmcnt(12)
  ds_read_b128 v[144:147], v14 offset:52736
  ds_read_b128 v[148:151], v14 offset:50688
  v_mfma_f32_16x16x32_bf16 v[132:135], a[28:31], v[140:143], v[132:135]
  s_waitcnt lgkmcnt(6)
  v_mfma_f32_16x16x32_bf16 v[120:123], v[140:143], a[40:43], v[120:123]
  s_waitcnt lgkmcnt(2)
  v_mfma_f32_16x16x32_bf16 v[124:127], v[140:143], a[44:47], v[124:127]
  s_waitcnt vmcnt(8)
  s_barrier
  buffer_load_dwordx4 v12, s[68:71], 0 offen lds
  s_waitcnt lgkmcnt(1)
  v_mfma_f32_16x16x32_bf16 v[88:91], a[32:35], v[144:147], v[88:91]
  s_add_u32 m0, s76, 27136
  ds_read_b64_tr_b16 a[8:9], v17 offset:0
  v_add_u32 v12, s72, v11
  s_add_u32 s72, s72, s75
  s_cmp_eq_u32 s72, s73
  s_cselect_b32 s72, s74, s72
  v_mfma_f32_16x16x32_bf16 v[92:95], a[36:39], v[144:147], v[92:95]
  buffer_load_dwordx4 v9, s[68:71], 0 offen lds
  s_add_u32 m0, s41, 126720
  v_mfma_f32_16x16x32_bf16 v[104:107], a[24:27], v[144:147], v[104:107]
  ds_read_b64_tr_b16 a[10:11], v17 offset:1024
  v_add_u32 v9, 7168, v12
  v_mfma_f32_16x16x32_bf16 v[108:111], a[28:31], v[144:147], v[108:111]
  ds_read_b128 v[36:39], v21 offset:44544
  v_mfma_f32_16x16x32_bf16 v[96:99], v[144:147], a[40:43], v[96:99]
  buffer_load_dwordx4 v32, s[16:19], s64 offen offset:1792 lds
  s_add_u32 m0, s41, 11008
  v_mfma_f32_16x16x32_bf16 v[100:103], v[144:147], a[44:47], v[100:103]
  s_waitcnt lgkmcnt(3)
  ds_read_b64_tr_b16 a[12:13], v18 offset:0
  v_mfma_f32_16x16x32_bf16 v[64:67], a[32:35], v[148:151], v[64:67]
  ds_read_b64_tr_b16 a[14:15], v18 offset:1024
  v_mfma_f32_16x16x32_bf16 v[68:71], a[36:39], v[148:151], v[68:71]
  s_mov_b64 exec, s[44:45]
  buffer_load_dwordx4 v10, s[12:15], s35 offen offset:768 lds
  s_mov_b64 exec, -1
  s_add_u32 m0, s41, 136704
  v_mfma_f32_16x16x32_bf16 v[80:83], a[24:27], v[148:151], v[80:83]
  ds_read_b64_tr_b16 a[0:1], v19 offset:47104
  v_mfma_f32_16x16x32_bf16 v[84:87], a[28:31], v[148:151], v[84:87]
  ds_read_b64_tr_b16 a[2:3], v19 offset:48128
  v_mfma_f32_16x16x32_bf16 v[72:75], v[148:151], a[40:43], v[72:75]
  buffer_load_dwordx4 v33, s[16:19], s64 offen offset:0 lds
  s_add_u32 m0, s41, 144000
  v_mfma_f32_16x16x32_bf16 v[76:79], v[148:151], a[44:47], v[76:79]
  s_waitcnt lgkmcnt(4)
  ds_read_b64_tr_b16 a[4:5], v20 offset:47104
  v_mfma_f32_16x16x32_bf16 v[112:115], a[8:11], v[36:39], v[112:115]
  ds_read_b64_tr_b16 a[6:7], v20 offset:48128
  ds_read_b64_tr_b16 a[16:17], v17 offset:8192
  ds_read_b64_tr_b16 a[18:19], v17 offset:9216
  ds_read_b64_tr_b16 a[20:21], v18 offset:8192
  s_waitcnt lgkmcnt(7)
  v_mfma_f32_16x16x32_bf16 v[116:119], a[12:15], v[36:39], v[116:119]
  s_waitcnt lgkmcnt(5)
  ds_read_b64_tr_b16 a[22:23], v18 offset:9216
  buffer_load_dwordx4 v33, s[16:19], s64 offen offset:896 lds
  v_mfma_f32_16x16x32_bf16 v[128:131], a[0:3], v[36:39], v[128:131]
  ds_read_b128 v[40:43], v21 offset:42496
  s_add_u32 m0, s76, 42496
  ds_read_b128 v[136:139], v21 offset:40448
  ds_read_b128 v[140:143], v22 offset:44544
  ds_read_b128 v[144:147], v22 offset:42496
  ds_read_b128 v[148:151], v22 offset:40448
  s_waitcnt lgkmcnt(9)
  v_mfma_f32_16x16x32_bf16 v[132:135], a[4:7], v[36:39], v[132:135]
  s_waitcnt lgkmcnt(7)
  v_mfma_f32_16x16x32_bf16 v[120:123], v[36:39], a[16:19], v[120:123]
  s_waitcnt vmcnt(10) lgkmcnt(5)
  s_barrier
  v_mfma_f32_16x16x32_bf16 v[124:127], v[36:39], a[20:23], v[124:127]
  s_waitcnt lgkmcnt(4)
  ds_read_b64_tr_b16 a[32:33], v17 offset:24576
  v_mfma_f32_16x16x32_bf16 v[88:91], a[8:11], v[40:43], v[88:91]
  ds_read_b64_tr_b16 a[34:35], v17 offset:25600
  v_mfma_f32_16x16x32_bf16 v[92:95], a[12:15], v[40:43], v[92:95]
  s_waitcnt vmcnt(6)
  v_cmp_ne_u32 vcc, 0, v58
  s_nop 4
  s_cbranch_vccz L_pns11
L_pss11:
  buffer_load_dwordx4 v12, s[68:71], 0 offen lds
  v_mfma_f32_16x16x32_bf16 v[104:107], a[0:3], v[40:43], v[104:107]
  s_add_u32 m0, s76, 43520
  ds_read_b64_tr_b16 a[36:37], v18 offset:24576
  v_add_u32 v12, s72, v11
  s_add_u32 s72, s72, s75
  s_cmp_eq_u32 s72, s73
  s_cselect_b32 s72, s74, s72
  v_mfma_f32_16x16x32_bf16 v[108:111], a[4:7], v[40:43], v[108:111]
  ds_read_b64_tr_b16 a[38:39], v18 offset:25600
  v_mov_b32 v168, v58
  v_mfma_f32_16x16x32_bf16 v[96:99], v[40:43], a[16:19], v[96:99]
  ds_read_b64_tr_b16 a[24:25], v17 offset:16384
  v_mov_b32 v169, v59
  v_mfma_f32_16x16x32_bf16 v[100:103], v[40:43], a[20:23], v[100:103]
  s_waitcnt vmcnt(6)
  v_cmp_ne_u32 vcc, v49, v58
  v_cmp_ne_u32 s[48:49], v51, v59
  s_nop 2
  s_or_b64 vcc, vcc, s[48:49]
  s_cbranch_scc1 L_qt1
L_rt1:
  ds_write_b32 v30, v48
  ds_write_b32 v30, v50 offset:1024
  s_waitcnt lgkmcnt(10)
  v_mfma_f32_16x16x32_bf16 v[64:67], a[8:11], v[136:139], v[64:67]
  buffer_load_dwordx4 v9, s[68:71], 0 offen lds
  s_add_u32 m0, s41, 151296
  v_mfma_f32_16x16x32_bf16 v[68:71], a[12:15], v[136:139], v[68:71]
  ds_read_b64_tr_b16 a[26:27], v17 offset:17408
  v_add_u32 v9, 7168, v12
  v_mfma_f32_16x16x32_bf16 v[80:83], a[0:3], v[136:139], v[80:83]
  ds_read_b64_tr_b16 a[28:29], v18 offset:16384
  v_mfma_f32_16x16x32_bf16 v[84:87], a[4:7], v[136:139], v[84:87]
  ds_read_b64_tr_b16 a[30:31], v18 offset:17408
  v_mfma_f32_16x16x32_bf16 v[72:75], v[136:139], a[16:19], v[72:75]
  ds_read_b64_tr_b16 a[40:41], v17 offset:32768
  v_mfma_f32_16x16x32_bf16 v[76:79], v[136:139], a[20:23], v[76:79]
  s_waitcnt lgkmcnt(9)
  ds_read_b64_tr_b16 a[42:43], v17 offset:33792
  v_mfma_f32_16x16x32_bf16 v[112:115], a[32:35], v[140:143], v[112:115]
  s_waitcnt lgkmcnt(8)
  buffer_load_dwordx4 v33, s[16:19], s64 offen offset:1792 lds
  s_add_u32 m0, s76, 58880
  ds_read_b64_tr_b16 a[44:45], v18 offset:32768
  v_mfma_f32_16x16x32_bf16 v[116:119], a[36:39], v[140:143], v[116:119]
  s_waitcnt lgkmcnt(5)
  ds_read_b64_tr_b16 a[46:47], v18 offset:33792
  v_mfma_f32_16x16x32_bf16 v[128:131], a[24:27], v[140:143], v[128:131]
  s_waitcnt lgkmcnt(4)
  v_mfma_f32_16x16x32_bf16 v[132:135], a[28:31], v[140:143], v[132:135]
  s_waitcnt lgkmcnt(2)
  v_mfma_f32_16x16x32_bf16 v[120:123], v[140:143], a[40:43], v[120:123]
  s_waitcnt lgkmcnt(0)
  v_mfma_f32_16x16x32_bf16 v[124:127], v[140:143], a[44:47], v[124:127]
  s_waitcnt vmcnt(5)
  s_barrier
  ds_read_b64_tr_b16 a[8:9], v19 offset:14336
  v_mfma_f32_16x16x32_bf16 v[88:91], a[32:35], v[144:147], v[88:91]
  buffer_load_dwordx4 v12, s[68:71], 0 offen lds
  s_add_u32 m0, s76, 59904
  v_mfma_f32_16x16x32_bf16 v[92:95], a[36:39], v[144:147], v[92:95]
  v_add_u32 v12, s72, v11
  s_add_u32 s72, s72, s75
  s_cmp_eq_u32 s72, s73
  s_cselect_b32 s72, s74, s72
  v_mfma_f32_16x16x32_bf16 v[104:107], a[24:27], v[144:147], v[104:107]
  ds_read_b64_tr_b16 a[10:11], v19 offset:15360
  v_mfma_f32_16x16x32_bf16 v[108:111], a[28:31], v[144:147], v[108:111]
  ds_read_b128 v[36:39], v13 offset:15872
  v_mfma_f32_16x16x32_bf16 v[96:99], v[144:147], a[40:43], v[96:99]
  buffer_load_dwordx4 v9, s[68:71], 0 offen lds
  s_add_u32 m0, s76, 75264
  v_mfma_f32_16x16x32_bf16 v[100:103], v[144:147], a[44:47], v[100:103]
  ds_read_b64_tr_b16 a[12:13], v20 offset:14336
  v_add_u32 v9, 7168, v12
  v_mfma_f32_16x16x32_bf16 v[64:67], a[32:35], v[148:151], v[64:67]
  ds_read_b64_tr_b16 a[14:15], v20 offset:15360
  v_mfma_f32_16x16x32_bf16 v[68:71], a[36:39], v[148:151], v[68:71]
  ds_read_b64_tr_b16 a[0:1], v19 offset:6144
  v_mfma_f32_16x16x32_bf16 v[80:83], a[24:27], v[148:151], v[80:83]
  buffer_load_dwordx4 v12, s[68:71], 0 offen lds
  s_add_u32 m0, s76, 76288
  v_mfma_f32_16x16x32_bf16 v[84:87], a[28:31], v[148:151], v[84:87]
  ds_read_b64_tr_b16 a[2:3], v19 offset:7168
  v_add_u32 v12, s72, v11
  s_add_u32 s72, s72, s75
  s_cmp_eq_u32 s72, s73
  s_cselect_b32 s72, s74, s72
  v_mfma_f32_16x16x32_bf16 v[72:75], v[148:151], a[40:43], v[72:75]
  ds_read_b64_tr_b16 a[4:5], v20 offset:6144
  v_mfma_f32_16x16x32_bf16 v[76:79], v[148:151], a[44:47], v[76:79]
  s_waitcnt lgkmcnt(5)
  ds_read_b64_tr_b16 a[6:7], v20 offset:7168
  v_mfma_f32_16x16x32_bf16 v[112:115], a[8:11], v[36:39], v[112:115]
  ds_read_b64_tr_b16 a[64:65], v4 offset:0
  ds_read_b64_tr_b16 a[66:67], v4 offset:2048
  ds_read_b64_tr_b16 a[68:69], v5 offset:0
  ds_read_b64_tr_b16 a[70:71], v5 offset:2048
  ds_read_b64_tr_b16 a[72:73], v6 offset:0
  ds_read_b64_tr_b16 a[16:17], v19 offset:22528
  ds_read_b64_tr_b16 a[74:75], v6 offset:2048
  ds_read_b64_tr_b16 a[18:19], v19 offset:23552
  ds_read_b64_tr_b16 a[76:77], v7 offset:0
  ds_read_b64_tr_b16 a[20:21], v20 offset:22528
  s_waitcnt lgkmcnt(14)
  v_mfma_f32_16x16x32_bf16 v[116:119], a[12:15], v[36:39], v[116:119]
  s_waitcnt lgkmcnt(12)
  ds_read_b64_tr_b16 a[78:79], v7 offset:2048
  ds_read_b64_tr_b16 a[22:23], v20 offset:23552
  buffer_load_dwordx4 v9, s[68:71], 0 offen lds
  v_mfma_f32_16x16x32_bf16 v[128:131], a[0:3], v[36:39], v[128:131]
  s_waitcnt lgkmcnt(12)
  ds_read_b128 v[40:43], v13 offset:13824
  s_add_u32 m0, s76, 91648
  v_mfma_f32_16x16x32_bf16 v[132:135], a[4:7], v[36:39], v[132:135]
  s_waitcnt lgkmcnt(5)
  ds_read_b128 v[136:139], v13 offset:11776
  v_add_u32 v9, 7168, v12
  ds_read_b128 v[140:143], v14 offset:15872
  v_mfma_f32_16x16x32_bf16 v[120:123], v[36:39], a[16:19], v[120:123]
  s_waitcnt lgkmcnt(3)
  ds_read_b128 v[144:147], v14 offset:13824
  v_mfma_f32_16x16x32_bf16 v[124:127], v[36:39], a[20:23], v[124:127]
  s_waitcnt lgkmcnt(3)
  ds_read_b128 v[148:151], v14 offset:11776
  v_mfma_f32_16x16x32_bf16 v[88:91], a[8:11], v[40:43], v[88:91]
  v_mfma_f32_16x16x32_bf16 v[92:95], a[12:15], v[40:43], v[92:95]
  v_mfma_f32_16x16x32_bf16 v[104:107], a[0:3], v[40:43], v[104:107]
  v_mfma_f32_16x16x32_bf16 v[108:111], a[4:7], v[40:43], v[108:111]
  v_mfma_f32_16x16x32_bf16 v[96:99], v[40:43], a[16:19], v[96:99]
  s_waitcnt vmcnt(4)
  s_barrier
  ds_read_b64_tr_b16 a[32:33], v19 offset:38912
  v_mfma_f32_16x16x32_bf16 v[100:103], v[40:43], a[20:23], v[100:103]
  s_waitcnt lgkmcnt(4)
  ds_read_b64_tr_b16 a[34:35], v19 offset:39936
  v_mfma_f32_16x16x32_bf16 v[64:67], a[8:11], v[136:139], v[64:67]
  ds_read_b64_tr_b16 a[36:37], v20 offset:38912
  v_mfma_f32_16x16x32_bf16 v[68:71], a[12:15], v[136:139], v[68:71]
  buffer_load_dwordx4 v12, s[68:71], 0 offen lds
  s_add_u32 m0, s76, 92672
  v_mfma_f32_16x16x32_bf16 v[80:83], a[0:3], v[136:139], v[80:83]
  ds_read_b64_tr_b16 a[38:39], v20 offset:39936
  v_mfma_f32_16x16x32_bf16 v[84:87], a[4:7], v[136:139], v[84:87]
  ds_read_b64_tr_b16 a[24:25], v19 offset:30720
  v_mfma_f32_16x16x32_bf16 v[72:75], v[136:139], a[16:19], v[72:75]
  ds_read_b64_tr_b16 a[26:27], v19 offset:31744
  v_mfma_f32_16x16x32_bf16 v[76:79], v[136:139], a[20:23], v[76:79]
  s_waitcnt lgkmcnt(4)
  ds_read_b64_tr_b16 a[28:29], v20 offset:30720
  v_mfma_f32_16x16x32_bf16 v[112:115], a[32:35], v[140:143], v[112:115]
  s_waitcnt lgkmcnt(3)
  ds_read_b64_tr_b16 a[30:31], v20 offset:31744
  ds_read_b64_tr_b16 a[40:41], v19 offset:47104
  v_mfma_f32_16x16x32_bf16 v[116:119], a[36:39], v[140:143], v[116:119]
  s_waitcnt lgkmcnt(3)
  ds_read_b64_tr_b16 a[42:43], v19 offset:48128
  ds_read_b64_tr_b16 a[44:45], v20 offset:47104
  v_mfma_f32_16x16x32_bf16 v[128:131], a[24:27], v[140:143], v[128:131]
  s_waitcnt lgkmcnt(3)
  ds_read_b64_tr_b16 a[46:47], v20 offset:48128
  v_mfma_f32_16x16x32_bf16 v[132:135], a[28:31], v[140:143], v[132:135]
  s_waitcnt lgkmcnt(2)
  s_mov_b64 exec, s[62:63]
  s_nop 2
  ds_write_b128 v34, v[128:131] offset:0
  s_mov_b64 exec, -1
  v_mfma_f32_16x16x32_bf16 v[120:123], v[140:143], a[40:43], v[120:123]
  s_waitcnt lgkmcnt(1)
  v_mfma_f32_16x16x32_bf16 v[124:127], v[140:143], a[44:47], v[124:127]
  s_mov_b64 exec, s[62:63]
  ds_write_b128 v34, v[132:135] offset:16
  s_mov_b64 exec, -1
  v_mfma_f32_16x16x32_bf16 v[88:91], a[32:35], v[144:147], v[88:91]
  s_mov_b64 exec, s[62:63]
  ds_write_b128 v34, v[112:115] offset:32
  s_mov_b64 exec, -1
  v_mfma_f32_16x16x32_bf16 v[92:95], a[36:39], v[144:147], v[92:95]
  s_mov_b64 exec, s[62:63]
  ds_write_b128 v34, v[116:119] offset:48
  s_mov_b64 exec, -1
  v_mfma_f32_16x16x32_bf16 v[104:107], a[24:27], v[144:147], v[104:107]
  s_mov_b64 exec, s[38:39]
  ds_write_b32 v24, v123 offset:0
  s_mov_b64 exec, -1
  s_mov_b64 exec, s[38:39]
  ds_write_b32 v24, v127 offset:4
  s_mov_b64 exec, -1
  v_mfma_f32_16x16x32_bf16 v[108:111], a[28:31], v[144:147], v[108:111]
  buffer_load_dwordx4 v9, s[68:71], 0 offen lds
  v_mfma_f32_16x16x32_bf16 v[64:67], a[32:35], v[148:151], v[64:67]
  v_mfma_f32_16x16x32_bf16 v[68:71], a[36:39], v[148:151], v[68:71]
  v_mfma_f32_16x16x32_bf16 v[80:83], a[24:27], v[148:151], v[80:83]
  s_waitcnt lgkmcnt(0)
  s_barrier
  ds_read_b128 v[48:51], v34 offset:0
  ds_read_b128 v[52:55], v34 offset:16
  ds_read_b128 v[56:59], v34 offset:32
  ds_read_b128 v[60:63], v34 offset:48
  ds_read2_b32 v[46:47], v24 offset0:0 offset1:0
  v_mfma_f32_16x16x32_bf16 v[84:87], a[28:31], v[148:151], v[84:87]
  ds_read2_b32 v[22:23], v24 offset0:1 offset1:1
  ds_read2_b32 v[4:5], v27 offset0:96 offset1:96
  ds_read2_b32 v[6:7], v27 offset0:80 offset1:80
  ds_read2_b32 v[14:15], v27 offset0:64 offset1:64
  v_mfma_f32_16x16x32_bf16 v[96:99], v[144:147], a[40:43], v[96:99]
  ds_read_b128 v[16:19], v8 offset:384
  ds_read_b128 v[28:31], v8 offset:320
  v_mfma_f32_16x16x32_bf16 v[100:103], v[144:147], a[44:47], v[100:103]
  v_mfma_f32_16x16x32_bf16 v[72:75], v[148:151], a[40:43], v[72:75]
  v_mfma_f32_16x16x32_bf16 v[76:79], v[148:151], a[44:47], v[76:79]
  s_waitcnt lgkmcnt(4)
  v_add_u32 v12, s72, v11
  s_add_u32 m0, s76, 26112
  s_nop 0
  buffer_load_dwordx4 v12, s[68:71], 0 offen lds
  v_pk_fma_f32 v[112:113], v[56:57], v[4:5], v[112:113]
  v_pk_fma_f32 v[114:115], v[58:59], v[4:5], v[114:115]
  v_pk_fma_f32 v[116:117], v[60:61], v[4:5], v[116:117]
  v_pk_fma_f32 v[118:119], v[62:63], v[4:5], v[118:119]
  v_cvt_pk_bf16_f32 v112, v112, v113
  v_cvt_pk_bf16_f32 v113, v114, v115
  v_cvt_pk_bf16_f32 v114, v116, v117
  v_cvt_pk_bf16_f32 v115, v118, v119
  s_waitcnt lgkmcnt(1)
  v_pk_fma_f32 v[120:121], v[16:17], v[46:47], v[120:121]
  v_pk_fma_f32 v[122:123], v[18:19], v[46:47], v[122:123]
  v_cvt_pk_bf16_f32 v142, v120, v121
  v_cvt_pk_bf16_f32 v143, v122, v123
  v_pk_fma_f32 v[124:125], v[16:17], v[22:23], v[124:125]
  v_pk_fma_f32 v[126:127], v[18:19], v[22:23], v[126:127]
  v_cvt_pk_bf16_f32 v150, v124, v125
  v_cvt_pk_bf16_f32 v151, v126, v127
  v_pk_fma_f32 v[128:129], v[48:49], v[4:5], v[128:129]
  v_pk_fma_f32 v[130:131], v[50:51], v[4:5], v[130:131]
  v_pk_fma_f32 v[132:133], v[52:53], v[4:5], v[132:133]
  v_add_u32 v9, 7168, v12
  s_add_u32 m0, s76, 27136
  s_nop 0
  buffer_load_dwordx4 v9, s[68:71], 0 offen lds
  v_pk_fma_f32 v[134:135], v[54:55], v[4:5], v[134:135]
  v_cvt_pk_bf16_f32 v128, v128, v129
  v_cvt_pk_bf16_f32 v129, v130, v131
  v_cvt_pk_bf16_f32 v130, v132, v133
  v_cvt_pk_bf16_f32 v131, v134, v135
  v_pk_fma_f32 v[88:89], v[56:57], v[6:7], v[88:89]
  v_pk_fma_f32 v[90:91], v[58:59], v[6:7], v[90:91]
  v_pk_fma_f32 v[92:93], v[60:61], v[6:7], v[92:93]
  v_pk_fma_f32 v[94:95], v[62:63], v[6:7], v[94:95]
  v_cvt_pk_bf16_f32 v88, v88, v89
  v_cvt_pk_bf16_f32 v89, v90, v91
  v_cvt_pk_bf16_f32 v90, v92, v93
  v_cvt_pk_bf16_f32 v91, v94, v95
  v_pk_fma_f32 v[104:105], v[48:49], v[6:7], v[104:105]
  v_pk_fma_f32 v[106:107], v[50:51], v[6:7], v[106:107]
  v_pk_fma_f32 v[108:109], v[52:53], v[6:7], v[108:109]
  v_pk_fma_f32 v[110:111], v[54:55], v[6:7], v[110:111]
  v_cvt_pk_bf16_f32 v104, v104, v105
  s_add_u32 s72, s72, s75
  s_cmp_eq_u32 s72, s73
  s_cselect_b32 s72, s74, s72
  v_add_u32 v12, s72, v11
  s_add_u32 m0, s76, 108032
  s_nop 0
  buffer_load_dwordx4 v12, s[68:71], 0 offen lds
  v_cvt_pk_bf16_f32 v105, v106, v107
  v_cvt_pk_bf16_f32 v106, v108, v109
  v_cvt_pk_bf16_f32 v107, v110, v111
  v_pk_fma_f32 v[64:65], v[56:57], v[14:15], v[64:65]
  v_pk_fma_f32 v[66:67], v[58:59], v[14:15], v[66:67]
  v_pk_fma_f32 v[68:69], v[60:61], v[14:15], v[68:69]
  v_pk_fma_f32 v[70:71], v[62:63], v[14:15], v[70:71]
  v_cvt_pk_bf16_f32 v64, v64, v65
  v_cvt_pk_bf16_f32 v65, v66, v67
  v_cvt_pk_bf16_f32 v66, v68, v69
  v_cvt_pk_bf16_f32 v67, v70, v71
  v_pk_fma_f32 v[80:81], v[48:49], v[14:15], v[80:81]
  v_pk_fma_f32 v[82:83], v[50:51], v[14:15], v[82:83]
  v_pk_fma_f32 v[84:85], v[52:53], v[14:15], v[84:85]
  v_pk_fma_f32 v[86:87], v[54:55], v[14:15], v[86:87]
  v_cvt_pk_bf16_f32 v80, v80, v81
  v_cvt_pk_bf16_f32 v81, v82, v83
  v_cvt_pk_bf16_f32 v82, v84, v85
  v_add_u32 v9, 7168, v12
  s_add_u32 m0, s76, 109056
  s_nop 0
  buffer_load_dwordx4 v9, s[68:71], 0 offen lds
  v_cvt_pk_bf16_f32 v83, v86, v87
  s_barrier
  ds_read_b128 v[152:155], v45
  ds_read_b64 v[136:137], v45 offset:1024
  ds_read_b64 v[144:145], v45 offset:1032
  ds_read_b32 v48, v27 offset:1408
  ds_read_b32 v49, v25 offset:384
  ds_read_b32 v50, v26 offset:384
  ds_read_b32 v53, v27 offset:1344
  ds_read_b32 v54, v25 offset:320
  ds_read_b32 v55, v26 offset:320
  ds_read_b32 v58, v27 offset:1280
  ds_read_b32 v59, v25 offset:256
  ds_read_b32 v60, v26 offset:256
  ds_read_b128 v[32:35], v8 offset:256
  v_mfma_f32_16x16x32_bf16 v[132:135], v[112:115], v[128:131], v[160:163]
  v_mfma_f32_16x16x32_bf16 v[116:119], v[88:91], v[128:131], v[164:167]
  v_mfma_f32_16x16x32_bf16 v[108:111], v[88:91], v[104:107], v[160:163]
  s_add_u32 s72, s72, s75
  s_cmp_eq_u32 s72, s73
  s_cselect_b32 s72, s74, s72
  v_add_u32 v12, s72, v11
  s_add_u32 m0, s76, 124416
  s_nop 0
  buffer_load_dwordx4 v12, s[68:71], 0 offen lds
  v_mfma_f32_16x16x32_bf16 v[92:95], v[64:67], v[104:107], v[164:167]
  v_mfma_f32_16x16x32_bf16 v[84:87], v[64:67], v[80:83], v[160:163]
  s_waitcnt lgkmcnt(12)
  v_mfma_f32_16x16x32_bf16 v[68:71], v[152:155], v[80:83], v[164:167]
  v_pk_fma_f32 v[96:97], v[28:29], v[46:47], v[96:97]
  v_pk_fma_f32 v[98:99], v[30:31], v[46:47], v[98:99]
  v_cvt_pk_bf16_f32 v140, v96, v97
  v_cvt_pk_bf16_f32 v141, v98, v99
  v_pk_fma_f32 v[100:101], v[28:29], v[22:23], v[100:101]
  v_pk_fma_f32 v[102:103], v[30:31], v[22:23], v[102:103]
  v_cvt_pk_bf16_f32 v148, v100, v101
  v_cvt_pk_bf16_f32 v149, v102, v103
  s_waitcnt lgkmcnt(0)
  v_pk_fma_f32 v[72:73], v[32:33], v[46:47], v[72:73]
  v_pk_fma_f32 v[74:75], v[34:35], v[46:47], v[74:75]
  v_cvt_pk_bf16_f32 v138, v72, v73
  v_cvt_pk_bf16_f32 v139, v74, v75
  v_pk_fma_f32 v[76:77], v[32:33], v[22:23], v[76:77]
  v_pk_fma_f32 v[78:79], v[34:35], v[22:23], v[78:79]
  v_cvt_pk_bf16_f32 v146, v76, v77
  v_add_u32 v9, 7168, v12
  s_add_u32 m0, s76, 125440
  s_nop 0
  buffer_load_dwordx4 v9, s[68:71], 0 offen lds
  v_cvt_pk_bf16_f32 v147, v78, v79
  v_mul_f32 v48, 0x3e8b97f6, v48
  v_mul_f32 v53, 0x3e8b97f6, v53
  v_mul_f32 v58, 0x3e8b97f6, v58
  v_mul_f32 v51, v48, v49
  v_mul_f32 v56, v53, v54
  v_mul_f32 v61, v58, v59
  v_mul_f32 v52, v48, v50
  v_mul_f32 v57, v53, v55
  v_mul_f32 v62, v58, v60
  v_max3_f32 v132, v132, v133, v116
  v_max3_f32 v108, v108, v109, v92
  v_max3_f32 v84, v84, v85, v68
  v_max3_f32 v134, v134, v135, v118
  v_max3_f32 v110, v110, v111, v94
  v_max3_f32 v86, v86, v87, v70
  v_max_f32 v132, v132, v117
  v_max_f32 v108, v108, v93
  s_add_u32 s72, s72, s75
  s_cmp_eq_u32 s72, s73
  s_cselect_b32 s72, s74, s72
  v_add_u32 v12, s72, v11
  s_add_u32 m0, s76, 140800
  s_nop 0
  buffer_load_dwordx4 v12, s[68:71], 0 offen lds
  v_max_f32 v84, v84, v69
  v_max_f32 v134, v134, v119
  v_max_f32 v110, v110, v95
  v_max_f32 v86, v86, v71
  v_mul_f32 v132, v132, v51
  v_mul_f32 v108, v108, v56
  v_mul_f32 v84, v84, v61
  v_mul_f32 v134, v134, v52
  v_mul_f32 v110, v110, v57
  v_mul_f32 v86, v86, v62
  v_max_f32 v133, v132, v134
  v_max_f32 v109, v108, v110
  v_max_f32 v85, v84, v86
  v_max_f32 v135, v132, v134
  v_max_f32 v111, v108, v110
  v_max_f32 v87, v84, v86
  v_permlane32_swap_b32 v133, v135
  v_permlane32_swap_b32 v109, v111
  v_add_u32 v9, 7168, v12
  s_add_u32 m0, s76, 141824
  s_nop 0
  buffer_load_dwordx4 v9, s[68:71], 0 offen lds
  s_add_u32 s72, s72, s75
  s_cmp_eq_u32 s72, s73
  s_cselect_b32 s72, s74, s72
  v_permlane32_swap_b32 v85, v87
  v_max_f32 v116, v133, v135
  v_max_f32 v92, v109, v111
  v_max_f32 v68, v85, v87
  v_max_f32 v117, v133, v135
  v_max_f32 v93, v109, v111
  v_max_f32 v69, v85, v87
  v_permlane16_swap_b32 v116, v117
  v_permlane16_swap_b32 v92, v93
  v_permlane16_swap_b32 v68, v69
  v_max_f32 v116, v116, v117
  v_max_f32 v92, v92, v93
  v_max_f32 v68, v68, v69
  v_sub_f32 v132, v132, v116
  v_sub_f32 v108, v108, v92
  v_sub_f32 v84, v84, v68
  v_sub_f32 v134, v134, v116
  v_sub_f32 v110, v110, v92
  v_sub_f32 v86, v86, v68
  v_exp_f32 v132, v132
  v_exp_f32 v108, v108
  v_exp_f32 v84, v84
  v_exp_f32 v134, v134
  v_exp_f32 v110, v110
  v_exp_f32 v86, v86
  v_add_f32 v133, v132, v134
  v_add_f32 v109, v108, v110
  v_add_f32 v85, v84, v86
  v_add_f32 v135, v132, v134
  v_add_f32 v111, v108, v110
  v_add_f32 v87, v84, v86
  v_permlane32_swap_b32 v133, v135
  v_permlane32_swap_b32 v109, v111
  v_permlane32_swap_b32 v85, v87
  v_mul_f32 v132, v132, v49
  v_mul_f32 v108, v108, v54
  v_mul_f32 v84, v84, v59
  v_mul_f32 v134, v134, v50
  v_mul_f32 v110, v110, v55
  v_mul_f32 v86, v86, v60
  v_add_f32 v116, v133, v135
  v_add_f32 v92, v109, v111
  v_add_f32 v68, v85, v87
  v_add_f32 v117, v133, v135
  v_add_f32 v93, v109, v111
  v_add_f32 v69, v85, v87
  v_permlane16_swap_b32 v116, v117
  v_permlane16_swap_b32 v92, v93
  v_permlane16_swap_b32 v68, v69
  v_add_f32 v116, v116, v117
  v_add_f32 v92, v92, v93
  v_add_f32 v68, v68, v69
  v_rcp_f32 v116, v116
  v_rcp_f32 v92, v92
  v_rcp_f32 v68, v68
  v_mul_f32 v132, v132, v116
  v_mul_f32 v108, v108, v92
  v_mul_f32 v84, v84, v68
  v_mul_f32 v134, v134, v116
  v_mul_f32 v110, v110, v92
  v_mul_f32 v86, v86, v68
  v_cvt_pk_bf16_f32 v118, v132, v132
  v_cvt_pk_bf16_f32 v94, v108, v108
  v_cvt_pk_bf16_f32 v70, v84, v84
  v_cvt_pk_bf16_f32 v119, v134, v134
  v_cvt_pk_bf16_f32 v95, v110, v110
  v_cvt_pk_bf16_f32 v71, v86, v86
  v_and_b32 v132, v118, v172
  v_and_b32 v108, v94, v172
  v_and_b32 v84, v70, v172
  v_and_b32 v133, v119, v173
  v_and_b32 v109, v95, v173
  v_and_b32 v85, v71, v173
  v_and_b32 v134, v118, v174
  v_and_b32 v110, v94, v174
  v_and_b32 v86, v70, v174
  v_and_b32 v135, v119, v175
  v_and_b32 v111, v95, v175
  v_and_b32 v87, v71, v175
  v_mfma_f32_16x16x32_bf16 v[120:123], v[140:143], v[132:135], 0
  v_mfma_f32_16x16x32_bf16 v[124:127], v[148:151], v[132:135], 0
  v_mfma_f32_16x16x32_bf16 v[96:99], v[138:141], v[108:111], 0
  v_mfma_f32_16x16x32_bf16 v[100:103], v[146:149], v[108:111], 0
  v_mfma_f32_16x16x32_bf16 v[72:75], v[136:139], v[84:87], 0
  v_mfma_f32_16x16x32_bf16 v[76:79], v[144:147], v[84:87], 0
  s_nop 2
  v_cvt_pk_bf16_f32 v128, v120, v121
  v_cvt_pk_bf16_f32 v129, v122, v123
  v_cvt_pk_bf16_f32 v130, v124, v125
  v_cvt_pk_bf16_f32 v131, v126, v127
  buffer_store_dwordx4 v[128:131], v44, s[24:27], s46 offen offset:1280 sc1
  v_cvt_pk_bf16_f32 v104, v96, v97
  v_cvt_pk_bf16_f32 v105, v98, v99
  v_cvt_pk_bf16_f32 v106, v100, v101
  v_cvt_pk_bf16_f32 v107, v102, v103
  buffer_store_dwordx4 v[104:107], v44, s[24:27], s46 offen offset:1024 sc1
  v_cvt_pk_bf16_f32 v80, v72, v73
  v_cvt_pk_bf16_f32 v81, v74, v75
  v_cvt_pk_bf16_f32 v82, v76, v77
  v_cvt_pk_bf16_f32 v83, v78, v79
  buffer_store_dwordx4 v[80:83], v44, s[24:27], s46 offen offset:768 sc1
  s_waitcnt vmcnt(11)
  v_mov_b32 v28, v168
  v_mov_b32 v29, v169
  s_branch L_s2
L_s2:
  s_load_dwordx2 s[16:17], s[0:1], 56
  s_cmp_eq_u32 s70, 0
  s_cbranch_scc1 L_pub
  s_cmp_ge_u32 s30, 6
  s_cbranch_scc1 L_s2s
  v_lshrrev_b32 v4, 2, v1
  v_lshlrev_b32 v4, 7, v4
  v_and_b32 v5, 3, v1
  v_lshl_add_u32 v4, v5, 3, v4
  v_bfe_u32 v5, v1, 3, 2
  v_xor_b32 v5, s32, v5
  v_lshl_add_u32 v4, v5, 5, v4
  s_lshl_b32 s47, s32, 12
  s_add_u32 s47, s47, 3584
  v_add_u32 v16, s47, v4
  v_xor_b32 v17, 32, v16
  v_xor_b32 v18, 64, v16
  v_xor_b32 v19, 96, v16
  v_add_u32 v20, 55296, v16
  v_add_u32 v21, 55296, v17
  v_add_u32 v22, 55296, v18
  v_add_u32 v23, 55296, v19
  v_add_u32 v24, 120832, v16
  v_add_u32 v25, 120832, v17
  v_add_u32 v26, 120832, v18
  v_add_u32 v27, 120832, v19
  s_lshl_b32 s47, s30, 2
  s_add_u32 s47, s47, 3072
  v_mov_b32 v30, s47
  v_mov_b32 v31, 0
  v_xor_b32 v0, 4, v30
  s_waitcnt vmcnt(0)
  s_barrier
  v_add_u32 v12, s72, v11
  s_add_u32 m0, s76, 3584
  s_nop 0
  buffer_load_dwordx4 v12, s[68:71], 0 offen lds
  v_add_u32 v9, 7168, v12
  s_add_u32 m0, s76, 4608
  s_nop 0
  buffer_load_dwordx4 v9, s[68:71], 0 offen lds
  s_add_u32 s72, s72, s75
  s_cmp_eq_u32 s72, s73
  s_cselect_b32 s72, s74, s72
  ds_read_b64_tr_b16 a[0:1], v16 offset:38912
  ds_read_b64_tr_b16 a[2:3], v16 offset:40960
  ds_read_b64_tr_b16 a[4:5], v17 offset:38912
  ds_read_b64_tr_b16 a[6:7], v17 offset:40960
  ds_read_b64_tr_b16 a[8:9], v18 offset:38912
  ds_read_b64_tr_b16 a[10:11], v18 offset:40960
  ds_read_b64_tr_b16 a[12:13], v19 offset:38912
  ds_read_b64_tr_b16 a[14:15], v19 offset:40960
  ds_read_b64_tr_b16 a[16:17], v20 offset:0
  ds_read_b64_tr_b16 a[18:19], v20 offset:2048
  ds_read_b64_tr_b16 a[20:21], v21 offset:0
  ds_read_b64_tr_b16 a[22:23], v21 offset:2048
  ds_read_b64_tr_b16 a[24:25], v22 offset:0
  ds_read_b64_tr_b16 a[26:27], v22 offset:2048
  ds_read_b64_tr_b16 a[28:29], v23 offset:0
  ds_read_b64_tr_b16 a[30:31], v23 offset:2048
  ds_read_b64_tr_b16 a[32:33], v20 offset:16384
  ds_read_b64_tr_b16 a[34:35], v20 offset:18432
  ds_read_b64_tr_b16 a[36:37], v21 offset:16384
  ds_read_b64_tr_b16 a[38:39], v21 offset:18432
  ds_read_b64_tr_b16 a[40:41], v22 offset:16384
  ds_read_b64_tr_b16 a[42:43], v22 offset:18432
  ds_read_b64_tr_b16 a[44:45], v23 offset:16384
  ds_read_b64_tr_b16 a[46:47], v23 offset:18432
  ds_read_b64_tr_b16 v[64:65], v20 offset:32768
  ds_read_b64_tr_b16 v[66:67], v20 offset:34816
  ds_read_b64_tr_b16 v[68:69], v21 offset:32768
  ds_read_b64_tr_b16 v[70:71], v21 offset:34816
  ds_read_b64_tr_b16 v[72:73], v22 offset:32768
  ds_read_b64_tr_b16 v[74:75], v22 offset:34816
  ds_read_b64_tr_b16 v[76:77], v23 offset:32768
  ds_read_b64_tr_b16 v[78:79], v23 offset:34816
  ds_write_b32 v30, v31 offset:64
  s_waitcnt lgkmcnt(0)
  s_barrier
  s_waitcnt lgkmcnt(0)
  v_add_u32 v12, s72, v11
  s_add_u32 m0, s76, 42496
  s_nop 0
  buffer_load_dwordx4 v12, s[68:71], 0 offen lds
  v_add_u32 v9, 7168, v12
  s_add_u32 m0, s76, 43520
  s_nop 0
  buffer_load_dwordx4 v9, s[68:71], 0 offen lds
  s_add_u32 s72, s72, s75
  s_cmp_eq_u32 s72, s73
  s_cselect_b32 s72, s74, s72
  ds_read_b64_tr_b16 v[80:81], v16 offset:22528
  ds_read_b64_tr_b16 v[82:83], v16 offset:24576
  ds_read_b64_tr_b16 v[84:85], v17 offset:22528
  ds_read_b64_tr_b16 v[86:87], v17 offset:24576
  ds_read_b64_tr_b16 v[88:89], v18 offset:22528
  ds_read_b64_tr_b16 v[90:91], v18 offset:24576
  ds_read_b64_tr_b16 v[92:93], v19 offset:22528
  ds_read_b64_tr_b16 v[94:95], v19 offset:24576
  v_add_u32 v12, s72, v11
  s_add_u32 m0, s76, 58880
  s_nop 0
  buffer_load_dwordx4 v12, s[68:71], 0 offen lds
  v_add_u32 v9, 7168, v12
  s_add_u32 m0, s76, 59904
  s_nop 0
  buffer_load_dwordx4 v9, s[68:71], 0 offen lds
  s_add_u32 s72, s72, s75
  s_cmp_eq_u32 s72, s73
  s_cselect_b32 s72, s74, s72
  ds_read_b64_tr_b16 v[96:97], v20 offset:49152
  ds_read_b64_tr_b16 v[98:99], v20 offset:51200
  ds_read_b64_tr_b16 v[100:101], v21 offset:49152
  ds_read_b64_tr_b16 v[102:103], v21 offset:51200
  ds_read_b64_tr_b16 v[104:105], v22 offset:49152
  ds_read_b64_tr_b16 v[106:107], v22 offset:51200
  ds_read_b64_tr_b16 v[108:109], v23 offset:49152
  ds_read_b64_tr_b16 v[110:111], v23 offset:51200
  v_add_u32 v12, s72, v11
  s_add_u32 m0, s76, 75264
  s_nop 0
  buffer_load_dwordx4 v12, s[68:71], 0 offen lds
  v_add_u32 v9, 7168, v12
  s_add_u32 m0, s76, 76288
  s_nop 0
  buffer_load_dwordx4 v9, s[68:71], 0 offen lds
  s_add_u32 s72, s72, s75
  s_cmp_eq_u32 s72, s73
  s_cselect_b32 s72, s74, s72
  ds_read_b64_tr_b16 v[112:113], v24 offset:0
  ds_read_b64_tr_b16 v[114:115], v24 offset:2048
  ds_read_b64_tr_b16 v[116:117], v25 offset:0
  ds_read_b64_tr_b16 v[118:119], v25 offset:2048
  ds_read_b64_tr_b16 v[120:121], v26 offset:0
  ds_read_b64_tr_b16 v[122:123], v26 offset:2048
  ds_read_b64_tr_b16 v[124:125], v27 offset:0
  ds_read_b64_tr_b16 v[126:127], v27 offset:2048
  v_add_u32 v12, s72, v11
  s_add_u32 m0, s76, 91648
  s_nop 0
  buffer_load_dwordx4 v12, s[68:71], 0 offen lds
  v_add_u32 v9, 7168, v12
  s_add_u32 m0, s76, 92672
  s_nop 0
  buffer_load_dwordx4 v9, s[68:71], 0 offen lds
  s_add_u32 s72, s72, s75
  s_cmp_eq_u32 s72, s73
  s_cselect_b32 s72, s74, s72
  ds_read_b64_tr_b16 v[128:129], v24 offset:16384
  ds_read_b64_tr_b16 v[130:131], v24 offset:18432
  ds_read_b64_tr_b16 v[132:133], v25 offset:16384
  ds_read_b64_tr_b16 v[134:135], v25 offset:18432
  ds_read_b64_tr_b16 v[136:137], v26 offset:16384
  ds_read_b64_tr_b16 v[138:139], v26 offset:18432
  ds_read_b64_tr_b16 v[140:141], v27 offset:16384
  ds_read_b64_tr_b16 v[142:143], v27 offset:18432
  s_waitcnt lgkmcnt(0)
  s_barrier
  v_add_u32 v12, s72, v11
  s_add_u32 m0, s76, 26112
  s_nop 0
  buffer_load_dwordx4 v12, s[68:71], 0 offen lds
  v_add_u32 v9, 7168, v12
  s_add_u32 m0, s76, 27136
  s_nop 0
  buffer_load_dwordx4 v9, s[68:71], 0 offen lds
  s_add_u32 s72, s72, s75
  s_cmp_eq_u32 s72, s73
  s_cselect_b32 s72, s74, s72
  s_lshl_b32 s45, s66, 1
  s_add_u32 s45, s45, s31
  s_lshl_b32 s45, s45, 5
  s_lshl_b32 s47, s32, 5
  s_lshl_b32 s46, s67, 7
  s_add_u32 s46, s46, s47
  v_mul_u32_u24 v40, 33792, v3
  s_mov_b32 s47, 47663
  s_mov_b32 s52, 44621
  v_add_u32 v44, s45, v2
  v_add_u32 v44, 0, v44
  v_mul_lo_u32 v45, v44, s47
  v_lshrrev_b32 v45, 23, v45
  v_add_u32 v12, s72, v11
  s_add_u32 m0, s76, 108032
  s_nop 0
  buffer_load_dwordx4 v12, s[68:71], 0 offen lds
  v_add_u32 v9, 7168, v12
  s_add_u32 m0, s76, 109056
  s_nop 0
  buffer_load_dwordx4 v9, s[68:71], 0 offen lds
  s_add_u32 s72, s72, s75
  s_cmp_eq_u32 s72, s73
  s_cselect_b32 s72, s74, s72
  v_mul_u32_u24 v46, 176, v45
  v_sub_u32 v46, v44, v46
  v_mul_u32_u24 v41, 171, v45
  v_min_u32 v42, 1873, v41
  v_add_u32 v42, v42, v46
  v_sub_u32 v41, v42, v41
  v_cmp_gt_u32 vcc, 171, v41
  v_mul_u32_u24 v41, 896, v42
  v_lshl_add_u32 v41, v3, 3, v41
  v_add_u32 v41, s46, v41
  v_cndmask_b32 v13, -16, v41, vcc
  v_lshl_add_u32 v144, v44, 4, v40
  v_add_u32 v44, s45, v2
  v_add_u32 v12, s72, v11
  s_add_u32 m0, s76, 124416
  s_nop 0
  buffer_load_dwordx4 v12, s[68:71], 0 offen lds
  v_add_u32 v9, 7168, v12
  s_add_u32 m0, s76, 125440
  s_nop 0
  buffer_load_dwordx4 v9, s[68:71], 0 offen lds
  s_add_u32 s72, s72, s75
  s_cmp_eq_u32 s72, s73
  s_cselect_b32 s72, s74, s72
  v_add_u32 v44, 16, v44
  v_mul_lo_u32 v45, v44, s47
  v_lshrrev_b32 v45, 23, v45
  v_mul_u32_u24 v46, 176, v45
  v_sub_u32 v46, v44, v46
  v_mul_u32_u24 v41, 171, v45
  v_min_u32 v42, 1873, v41
  v_add_u32 v42, v42, v46
  v_sub_u32 v41, v42, v41
  v_cmp_gt_u32 vcc, 171, v41
  v_mul_u32_u24 v41, 896, v42
  v_lshl_add_u32 v41, v3, 3, v41
  v_add_u32 v41, s46, v41
  v_add_u32 v12, s72, v11
  s_add_u32 m0, s76, 140800
  s_nop 0
  buffer_load_dwordx4 v12, s[68:71], 0 offen lds
  v_add_u32 v9, 7168, v12
  s_add_u32 m0, s76, 141824
  s_nop 0
  buffer_load_dwordx4 v9, s[68:71], 0 offen lds
  s_add_u32 s72, s72, s75
  s_cmp_eq_u32 s72, s73
  s_cselect_b32 s72, s74, s72
  v_cndmask_b32 v14, -16, v41, vcc
  v_lshl_add_u32 v145, v44, 4, v40
  s_mul_i32 s53, s32, 2568192
  s_add_u32 s53, s53, 2162688
  s_add_u32 s54, s53, 2568192
  s_mul_i32 s55, s42, 135168
  s_add_u32 s55, s55, s53
  s_mov_b32 s18, 1835008
  s_mov_b32 s19, 0x20000
  s_mov_b32 s20, s24
  s_mov_b32 s21, s25
  s_mov_b32 s22, 9732096
  s_mov_b32 s23, 0x20000
  s_barrier
  v_add_u32 v8, s55, v144
  buffer_load_dwordx4 v[152:155], v8, s[20:23], 0 offen sc1
  v_add_u32 v10, s55, v145
  buffer_load_dwordx4 v[156:159], v10, s[20:23], 0 offen sc1
  s_add_u32 s55, s55, 135168
  s_cmp_eq_u32 s55, s54
  s_cselect_b32 s55, s53, s55
  v_add_u32 v8, s55, v144
  buffer_load_dwordx4 v[160:163], v8, s[20:23], 0 offen sc1
  v_add_u32 v10, s55, v145
  buffer_load_dwordx4 v[164:167], v10, s[20:23], 0 offen sc1
  s_add_u32 s55, s55, 135168
  s_cmp_eq_u32 s55, s54
  s_cselect_b32 s55, s53, s55
  v_add_u32 v8, s55, v144
  buffer_load_dwordx4 v[168:171], v8, s[20:23], 0 offen sc1
  v_add_u32 v10, s55, v145
  buffer_load_dwordx4 v[172:175], v10, s[20:23], 0 offen sc1
  s_add_u32 s55, s55, 135168
  s_cmp_eq_u32 s55, s54
  s_cselect_b32 s55, s53, s55
  v_mov_b32 v146, 3
  v_add_u32 v8, s55, v144
  v_add_u32 v10, s55, v145
  s_add_u32 s55, s55, 135168
  s_cmp_eq_u32 s55, s54
  s_cselect_b32 s55, s53, s55
  s_lshl_b32 s47, s31, 11
  v_lshl_add_u32 v12, v1, 4, s47
  s_mov_b32 s48, 7680
  s_cmp_eq_u32 s32, 1
  s_cselect_b32 s48, 67072, s48
  s_cmp_eq_u32 s32, 2
  s_cselect_b32 s48, 42496, s48
  s_mov_b32 s49, 50688
  s_cmp_eq_u32 s32, 1
  s_cselect_b32 s49, 3584, s49
  s_cmp_eq_u32 s32, 2
  s_cselect_b32 s49, 62976, s49
  s_mov_b32 s50, 71168
  s_cmp_eq_u32 s32, 1
  s_cselect_b32 s50, 54784, s50
  s_cmp_eq_u32 s32, 2
  s_cselect_b32 s50, 15872, s50
  s_waitcnt vmcnt(5)
  v_mfma_f32_16x16x32_bf16 v[32:35], a[48:51], v[152:155], 0
  ds_write_b32 v0, v146 offset:64
  s_nop 1
  v_mov_b32 v146, 4
  v_mfma_f32_16x16x32_bf16 v[36:39], a[52:55], v[152:155], 0
  v_mfma_f32_16x16x32_bf16 v[40:43], a[56:59], v[152:155], 0
  v_mfma_f32_16x16x32_bf16 v[44:47], a[60:63], v[152:155], 0
  s_waitcnt vmcnt(4)
  v_mfma_f32_16x16x32_bf16 v[48:51], a[48:51], v[156:159], 0
  buffer_load_dwordx4 v[152:155], v8, s[20:23], 0 offen sc1
  v_add_u32 v8, s55, v144
  v_mfma_f32_16x16x32_bf16 v[52:55], a[52:55], v[156:159], 0
  v_mfma_f32_16x16x32_bf16 v[56:59], a[56:59], v[156:159], 0
  v_mfma_f32_16x16x32_bf16 v[60:63], a[60:63], v[156:159], 0
  s_waitcnt vmcnt(4)
  v_mfma_f32_16x16x32_bf16 v[32:35], a[64:67], v[160:163], v[32:35]
  buffer_load_dwordx4 v[156:159], v10, s[20:23], 0 offen sc1
  v_add_u32 v10, s55, v145
  ds_read_b32 v31, v30 offset:64
  s_add_u32 s55, s55, 135168
  s_cmp_eq_u32 s55, s54
  s_cselect_b32 s55, s53, s55
  v_mfma_f32_16x16x32_bf16 v[36:39], a[68:71], v[160:163], v[36:39]
  v_mfma_f32_16x16x32_bf16 v[40:43], a[72:75], v[160:163], v[40:43]
  v_mfma_f32_16x16x32_bf16 v[44:47], a[76:79], v[160:163], v[44:47]
  s_waitcnt vmcnt(4)
  v_mfma_f32_16x16x32_bf16 v[48:51], a[64:67], v[164:167], v[48:51]
  buffer_load_dwordx4 v[160:163], v8, s[20:23], 0 offen sc1
  v_add_u32 v8, s55, v144
  v_mfma_f32_16x16x32_bf16 v[52:55], a[68:71], v[164:167], v[52:55]
  v_mfma_f32_16x16x32_bf16 v[56:59], a[72:75], v[164:167], v[56:59]
  v_mfma_f32_16x16x32_bf16 v[60:63], a[76:79], v[164:167], v[60:63]
  s_waitcnt vmcnt(4)
  v_mfma_f32_16x16x32_bf16 v[32:35], a[0:3], v[168:171], v[32:35]
  s_waitcnt lgkmcnt(0)
  buffer_load_dwordx4 v[164:167], v10, s[20:23], 0 offen sc1
  v_add_u32 v10, s55, v145
  L_pfl0:
  v_readfirstlane_b32 s64, v31
  s_nop 1
  s_cmp_ge_u32 s64, 3
  s_cbranch_scc1 L_pfdl0
  ds_read_b32 v31, v30 offset:64
  s_waitcnt lgkmcnt(0)
  s_branch L_pfl0
L_pfdl0:
  s_add_u32 s55, s55, 135168
  s_cmp_eq_u32 s55, s54
  s_cselect_b32 s55, s53, s55
  v_mfma_f32_16x16x32_bf16 v[36:39], a[4:7], v[168:171], v[36:39]
  ds_read_b64_tr_b16 a[48:49], v16 offset:0
  v_mfma_f32_16x16x32_bf16 v[40:43], a[8:11], v[168:171], v[40:43]
  ds_read_b64_tr_b16 a[50:51], v16 offset:2048
  v_mfma_f32_16x16x32_bf16 v[44:47], a[12:15], v[168:171], v[44:47]
  s_waitcnt vmcnt(4)
  ds_read_b64_tr_b16 a[52:53], v17 offset:0
  v_mfma_f32_16x16x32_bf16 v[48:51], a[0:3], v[172:175], v[48:51]
  buffer_load_dwordx4 v[168:171], v8, s[20:23], 0 offen sc1
  v_add_u32 v8, s55, v144
  v_mfma_f32_16x16x32_bf16 v[52:55], a[4:7], v[172:175], v[52:55]
  ds_read_b64_tr_b16 a[54:55], v17 offset:2048
  v_mfma_f32_16x16x32_bf16 v[56:59], a[8:11], v[172:175], v[56:59]
  ds_read_b64_tr_b16 a[56:57], v18 offset:0
  v_mfma_f32_16x16x32_bf16 v[60:63], a[12:15], v[172:175], v[60:63]
  ds_read_b64_tr_b16 a[58:59], v18 offset:2048
  buffer_load_dwordx4 v[172:175], v10, s[20:23], 0 offen sc1
  buffer_load_dwordx2 v[4:5], v13, s[12:15], 0 offen
  buffer_load_dwordx2 v[6:7], v14, s[12:15], 0 offen
  v_add_u32 v10, s55, v145
  s_add_u32 s55, s55, 135168
  s_cmp_eq_u32 s55, s54
  s_cselect_b32 s55, s53, s55
  ds_read_b64_tr_b16 a[60:61], v19 offset:0
  ds_read_b64_tr_b16 a[62:63], v19 offset:2048
  ds_read_b64_tr_b16 a[64:65], v16 offset:38912
  ds_read_b64_tr_b16 a[66:67], v16 offset:40960
  ds_read_b64_tr_b16 a[68:69], v17 offset:38912
  ds_read_b64_tr_b16 a[70:71], v17 offset:40960
  ds_read_b64_tr_b16 a[72:73], v18 offset:38912
  ds_read_b64_tr_b16 a[74:75], v18 offset:40960
  ds_read_b64_tr_b16 a[76:77], v19 offset:38912
  ds_read_b64_tr_b16 a[78:79], v19 offset:40960
  ds_read_b64_tr_b16 a[0:1], v20 offset:0
  ds_read_b64_tr_b16 a[2:3], v20 offset:2048
  ds_read_b64_tr_b16 a[4:5], v21 offset:0
  ds_read_b64_tr_b16 a[6:7], v21 offset:2048
  ds_read_b64_tr_b16 a[8:9], v22 offset:0
  ds_read_b64_tr_b16 a[10:11], v22 offset:2048
  ds_read_b64_tr_b16 a[12:13], v23 offset:0
  ds_read_b64_tr_b16 a[14:15], v23 offset:2048
  s_waitcnt vmcnt(7)
  v_mfma_f32_16x16x32_bf16 v[32:35], a[16:19], v[152:155], v[32:35]
  v_mfma_f32_16x16x32_bf16 v[36:39], a[20:23], v[152:155], v[36:39]
  v_mfma_f32_16x16x32_bf16 v[40:43], a[24:27], v[152:155], v[40:43]
  v_mfma_f32_16x16x32_bf16 v[44:47], a[28:31], v[152:155], v[44:47]
  s_waitcnt vmcnt(6)
  v_mfma_f32_16x16x32_bf16 v[48:51], a[16:19], v[156:159], v[48:51]
  buffer_load_dwordx4 v[152:155], v8, s[20:23], 0 offen sc1
  v_add_u32 v8, s55, v144
  v_mfma_f32_16x16x32_bf16 v[52:55], a[20:23], v[156:159], v[52:55]
  ds_read_b64_tr_b16 a[16:17], v20 offset:16384
  v_mfma_f32_16x16x32_bf16 v[56:59], a[24:27], v[156:159], v[56:59]
  ds_read_b64_tr_b16 a[18:19], v20 offset:18432
  v_mfma_f32_16x16x32_bf16 v[60:63], a[28:31], v[156:159], v[60:63]
  s_waitcnt vmcnt(6)
  ds_read_b64_tr_b16 a[20:21], v21 offset:16384
  buffer_load_dwordx4 v[156:159], v10, s[20:23], 0 offen sc1
  v_add_u32 v10, s55, v145
  v_mfma_f32_16x16x32_bf16 v[32:35], a[32:35], v[160:163], v[32:35]
  s_add_u32 s55, s55, 135168
  s_cmp_eq_u32 s55, s54
  s_cselect_b32 s55, s53, s55
  v_mfma_f32_16x16x32_bf16 v[36:39], a[36:39], v[160:163], v[36:39]
  ds_read_b64_tr_b16 a[22:23], v21 offset:18432
  v_mfma_f32_16x16x32_bf16 v[40:43], a[40:43], v[160:163], v[40:43]
  ds_read_b64_tr_b16 a[24:25], v22 offset:16384
  v_mfma_f32_16x16x32_bf16 v[44:47], a[44:47], v[160:163], v[44:47]
  s_waitcnt vmcnt(6)
  ds_read_b64_tr_b16 a[26:27], v22 offset:18432
  v_mfma_f32_16x16x32_bf16 v[48:51], a[32:35], v[164:167], v[48:51]
  buffer_load_dwordx4 v[160:163], v8, s[20:23], 0 offen sc1
  v_add_u32 v8, s55, v144
  v_mfma_f32_16x16x32_bf16 v[52:55], a[36:39], v[164:167], v[52:55]
  ds_read_b64_tr_b16 a[28:29], v23 offset:16384
  v_mfma_f32_16x16x32_bf16 v[56:59], a[40:43], v[164:167], v[56:59]
  ds_read_b64_tr_b16 a[30:31], v23 offset:18432
  v_mfma_f32_16x16x32_bf16 v[60:63], a[44:47], v[164:167], v[60:63]
  ds_read_b64_tr_b16 a[32:33], v20 offset:32768
  buffer_load_dwordx4 v[164:167], v10, s[20:23], 0 offen sc1
  v_add_u32 v10, s55, v145
  s_add_u32 s55, s55, 135168
  s_cmp_eq_u32 s55, s54
  s_cselect_b32 s55, s53, s55
  ds_read_b64_tr_b16 a[34:35], v20 offset:34816
  ds_read_b64_tr_b16 a[36:37], v21 offset:32768
  ds_read_b64_tr_b16 a[38:39], v21 offset:34816
  ds_read_b64_tr_b16 a[40:41], v22 offset:32768
  ds_read_b64_tr_b16 a[42:43], v22 offset:34816
  s_waitcnt vmcnt(7)
  v_mfma_f32_16x16x32_bf16 v[32:35], v[64:67], v[168:171], v[32:35]
  ds_read_b64_tr_b16 a[44:45], v23 offset:32768
  v_mfma_f32_16x16x32_bf16 v[36:39], v[68:71], v[168:171], v[36:39]
  ds_read_b64_tr_b16 a[46:47], v23 offset:34816
  v_mfma_f32_16x16x32_bf16 v[40:43], v[72:75], v[168:171], v[40:43]
  v_mfma_f32_16x16x32_bf16 v[44:47], v[76:79], v[168:171], v[44:47]
  s_waitcnt vmcnt(6)
  v_mfma_f32_16x16x32_bf16 v[48:51], v[64:67], v[172:175], v[48:51]
  buffer_load_dwordx4 v[168:171], v8, s[20:23], 0 offen sc1
  v_add_u32 v8, s55, v144
  v_mfma_f32_16x16x32_bf16 v[52:55], v[68:71], v[172:175], v[52:55]
  ds_read_b64_tr_b16 v[64:65], v16 offset:22528
  v_mfma_f32_16x16x32_bf16 v[56:59], v[72:75], v[172:175], v[56:59]
  ds_read_b64_tr_b16 v[66:67], v16 offset:24576
  v_lshl_add_u32 v16, v1, 4, s76
  v_mfma_f32_16x16x32_bf16 v[60:63], v[76:79], v[172:175], v[60:63]
  ds_read_b64_tr_b16 v[68:69], v17 offset:22528
  buffer_load_dwordx4 v[172:175], v10, s[20:23], 0 offen sc1
  v_add_u32 v10, s55, v145
  s_add_u32 s55, s55, 135168
  s_cmp_eq_u32 s55, s54
  s_cselect_b32 s55, s53, s55
  ds_read_b64_tr_b16 v[70:71], v17 offset:24576
  ds_read_b64_tr_b16 v[72:73], v18 offset:22528
  ds_read_b64_tr_b16 v[74:75], v18 offset:24576
  ds_read_b64_tr_b16 v[76:77], v19 offset:22528
  ds_read_b64_tr_b16 v[78:79], v19 offset:24576
  v_add_u32 v17, s48, v12
  v_add_u32 v18, s49, v12
  v_add_u32 v19, s50, v12
  s_waitcnt vmcnt(5)
  v_mfma_f32_16x16x32_bf16 v[32:35], v[80:83], v[152:155], v[32:35]
  v_mfma_f32_16x16x32_bf16 v[36:39], v[84:87], v[152:155], v[36:39]
  v_mfma_f32_16x16x32_bf16 v[40:43], v[88:91], v[152:155], v[40:43]
  v_mfma_f32_16x16x32_bf16 v[44:47], v[92:95], v[152:155], v[44:47]
  s_waitcnt vmcnt(4)
  v_mfma_f32_16x16x32_bf16 v[48:51], v[80:83], v[156:159], v[48:51]
  buffer_load_dwordx4 v[152:155], v8, s[20:23], 0 offen sc1
  v_add_u32 v8, s55, v144
  v_mfma_f32_16x16x32_bf16 v[52:55], v[84:87], v[156:159], v[52:55]
  ds_read_b64_tr_b16 v[80:81], v20 offset:49152
  v_mfma_f32_16x16x32_bf16 v[56:59], v[88:91], v[156:159], v[56:59]
  ds_read_b64_tr_b16 v[82:83], v20 offset:51200
  v_mfma_f32_16x16x32_bf16 v[60:63], v[92:95], v[156:159], v[60:63]
  s_waitcnt vmcnt(4)
  ds_read_b64_tr_b16 v[84:85], v21 offset:49152
  buffer_load_dwordx4 v[156:159], v10, s[20:23], 0 offen sc1
  v_add_u32 v10, s55, v145
  v_mfma_f32_16x16x32_bf16 v[32:35], v[96:99], v[160:163], v[32:35]
  s_add_u32 s55, s55, 135168
  s_cmp_eq_u32 s55, s54
  s_cselect_b32 s55, s53, s55
  v_mfma_f32_16x16x32_bf16 v[36:39], v[100:103], v[160:163], v[36:39]
  ds_read_b64_tr_b16 v[86:87], v21 offset:51200
  v_mfma_f32_16x16x32_bf16 v[40:43], v[104:107], v[160:163], v[40:43]
  ds_read_b64_tr_b16 v[88:89], v22 offset:49152
  v_mfma_f32_16x16x32_bf16 v[44:47], v[108:111], v[160:163], v[44:47]
  s_waitcnt vmcnt(4)
  ds_read_b64_tr_b16 v[90:91], v22 offset:51200
  v_mfma_f32_16x16x32_bf16 v[48:51], v[96:99], v[164:167], v[48:51]
  buffer_load_dwordx4 v[160:163], v8, s[20:23], 0 offen sc1
  v_add_u32 v8, s55, v144
  v_mfma_f32_16x16x32_bf16 v[52:55], v[100:103], v[164:167], v[52:55]
  ds_read_b64_tr_b16 v[92:93], v23 offset:49152
  v_mfma_f32_16x16x32_bf16 v[56:59], v[104:107], v[164:167], v[56:59]
  ds_read_b64_tr_b16 v[94:95], v23 offset:51200
  v_mfma_f32_16x16x32_bf16 v[60:63], v[108:111], v[164:167], v[60:63]
  ds_read_b64_tr_b16 v[96:97], v24 offset:0
  buffer_load_dwordx4 v[164:167], v10, s[20:23], 0 offen sc1
  v_add_u32 v10, s55, v145
  s_add_u32 s55, s55, 135168
  s_cmp_eq_u32 s55, s54
  s_cselect_b32 s55, s53, s55
  ds_read_b64_tr_b16 v[98:99], v24 offset:2048
  ds_read_b64_tr_b16 v[100:101], v25 offset:0
  ds_read_b64_tr_b16 v[102:103], v25 offset:2048
  ds_read_b64_tr_b16 v[104:105], v26 offset:0
  ds_read_b64_tr_b16 v[106:107], v26 offset:2048
  s_waitcnt vmcnt(5)
  v_mfma_f32_16x16x32_bf16 v[32:35], v[112:115], v[168:171], v[32:35]
  ds_read_b64_tr_b16 v[108:109], v27 offset:0
  v_mfma_f32_16x16x32_bf16 v[36:39], v[116:119], v[168:171], v[36:39]
  ds_read_b64_tr_b16 v[110:111], v27 offset:2048
  v_mfma_f32_16x16x32_bf16 v[40:43], v[120:123], v[168:171], v[40:43]
  v_mfma_f32_16x16x32_bf16 v[44:47], v[124:127], v[168:171], v[44:47]
  s_waitcnt vmcnt(4)
  v_mfma_f32_16x16x32_bf16 v[48:51], v[112:115], v[172:175], v[48:51]
  buffer_load_dwordx4 v[168:171], v8, s[20:23], 0 offen sc1
  v_add_u32 v8, s55, v144
  v_mfma_f32_16x16x32_bf16 v[52:55], v[116:119], v[172:175], v[52:55]
  ds_read_b64_tr_b16 v[112:113], v24 offset:16384
  v_mfma_f32_16x16x32_bf16 v[56:59], v[120:123], v[172:175], v[56:59]
  ds_read_b64_tr_b16 v[114:115], v24 offset:18432
  v_mfma_f32_16x16x32_bf16 v[60:63], v[124:127], v[172:175], v[60:63]
  ds_read_b64_tr_b16 v[116:117], v25 offset:16384
  buffer_load_dwordx4 v[172:175], v10, s[20:23], 0 offen sc1
  v_add_u32 v10, s55, v145
  s_add_u32 s55, s55, 135168
  s_cmp_eq_u32 s55, s54
  s_cselect_b32 s55, s53, s55
  ds_read_b64_tr_b16 v[118:119], v25 offset:18432
  ds_read_b64_tr_b16 v[120:121], v26 offset:16384
  ds_read_b64_tr_b16 v[122:123], v26 offset:18432
  ds_read_b64_tr_b16 v[124:125], v27 offset:16384
  ds_read_b64_tr_b16 v[126:127], v27 offset:18432
  s_waitcnt vmcnt(5)
  v_mfma_f32_16x16x32_bf16 v[32:35], v[128:131], v[152:155], v[32:35]
  v_mfma_f32_16x16x32_bf16 v[36:39], v[132:135], v[152:155], v[36:39]
  v_mfma_f32_16x16x32_bf16 v[40:43], v[136:139], v[152:155], v[40:43]
  v_mfma_f32_16x16x32_bf16 v[44:47], v[140:143], v[152:155], v[44:47]
  s_waitcnt vmcnt(4)
  v_mfma_f32_16x16x32_bf16 v[48:51], v[128:131], v[156:159], v[48:51]
  buffer_load_dwordx4 v[152:155], v8, s[20:23], 0 offen sc1
  v_add_u32 v8, s55, v144
  v_mfma_f32_16x16x32_bf16 v[52:55], v[132:135], v[156:159], v[52:55]
  v_mfma_f32_16x16x32_bf16 v[56:59], v[136:139], v[156:159], v[56:59]
  v_mfma_f32_16x16x32_bf16 v[60:63], v[140:143], v[156:159], v[60:63]
  s_waitcnt vmcnt(4) lgkmcnt(15)
  buffer_load_dwordx4 v[156:159], v10, s[20:23], 0 offen sc1
  v_add_u32 v10, s55, v145
  v_mfma_f32_16x16x32_bf16 v[32:35], a[48:51], v[160:163], v[32:35]
  s_waitcnt lgkmcnt(15)
  s_add_u32 s55, s55, 135168
  s_cmp_eq_u32 s55, s54
  s_cselect_b32 s55, s53, s55
  v_mfma_f32_16x16x32_bf16 v[36:39], a[52:55], v[160:163], v[36:39]
  s_waitcnt lgkmcnt(15)
  v_mfma_f32_16x16x32_bf16 v[40:43], a[56:59], v[160:163], v[40:43]
  s_waitcnt lgkmcnt(15)
  v_mfma_f32_16x16x32_bf16 v[44:47], a[60:63], v[160:163], v[44:47]
  s_waitcnt vmcnt(4)
  v_mfma_f32_16x16x32_bf16 v[48:51], a[48:51], v[164:167], v[48:51]
  buffer_load_dwordx4 v[160:163], v8, s[20:23], 0 offen sc1
  v_add_u32 v8, s55, v144
  v_mfma_f32_16x16x32_bf16 v[52:55], a[52:55], v[164:167], v[52:55]
  v_mfma_f32_16x16x32_bf16 v[56:59], a[56:59], v[164:167], v[56:59]
  v_mfma_f32_16x16x32_bf16 v[60:63], a[60:63], v[164:167], v[60:63]
  s_waitcnt vmcnt(4) lgkmcnt(15)
  buffer_load_dwordx4 v[164:167], v10, s[20:23], 0 offen sc1
  v_add_u32 v10, s55, v145
  s_add_u32 s55, s55, 135168
  s_cmp_eq_u32 s55, s54
  s_cselect_b32 s55, s53, s55
  v_mfma_f32_16x16x32_bf16 v[32:35], a[64:67], v[168:171], v[32:35]
  s_waitcnt lgkmcnt(15)
  ds_write_b32 v0, v146 offset:64
  v_mfma_f32_16x16x32_bf16 v[36:39], a[68:71], v[168:171], v[36:39]
  s_waitcnt lgkmcnt(15)
  v_mfma_f32_16x16x32_bf16 v[40:43], a[72:75], v[168:171], v[40:43]
  s_waitcnt lgkmcnt(15)
  v_mfma_f32_16x16x32_bf16 v[44:47], a[76:79], v[168:171], v[44:47]
  s_waitcnt vmcnt(4)
  v_mfma_f32_16x16x32_bf16 v[48:51], a[64:67], v[172:175], v[48:51]
  buffer_load_dwordx4 v[168:171], v8, s[20:23], 0 offen sc1
  v_add_u32 v8, s55, v144
  v_mfma_f32_16x16x32_bf16 v[52:55], a[68:71], v[172:175], v[52:55]
  v_mfma_f32_16x16x32_bf16 v[56:59], a[72:75], v[172:175], v[56:59]
  v_mfma_f32_16x16x32_bf16 v[60:63], a[76:79], v[172:175], v[60:63]
  s_waitcnt vmcnt(4) lgkmcnt(15)
  buffer_load_dwordx4 v[172:175], v10, s[20:23], 0 offen sc1
  v_add_u32 v10, s55, v145
  s_add_u32 s55, s55, 135168
  s_cmp_eq_u32 s55, s54
  s_cselect_b32 s55, s53, s55
  v_mfma_f32_16x16x32_bf16 v[32:35], a[0:3], v[152:155], v[32:35]
  s_waitcnt lgkmcnt(15)
  v_mfma_f32_16x16x32_bf16 v[36:39], a[4:7], v[152:155], v[36:39]
  s_waitcnt lgkmcnt(15)
  v_mfma_f32_16x16x32_bf16 v[40:43], a[8:11], v[152:155], v[40:43]
  s_waitcnt lgkmcnt(15)
  v_mfma_f32_16x16x32_bf16 v[44:47], a[12:15], v[152:155], v[44:47]
  s_waitcnt vmcnt(4)
  v_mfma_f32_16x16x32_bf16 v[48:51], a[0:3], v[156:159], v[48:51]
  buffer_load_dwordx4 v[152:155], v8, s[20:23], 0 offen sc1
  v_add_u32 v8, s55, v144
  v_mfma_f32_16x16x32_bf16 v[52:55], a[4:7], v[156:159], v[52:55]
  v_mfma_f32_16x16x32_bf16 v[56:59], a[8:11], v[156:159], v[56:59]
  v_mfma_f32_16x16x32_bf16 v[60:63], a[12:15], v[156:159], v[60:63]
  s_waitcnt vmcnt(4) lgkmcnt(15)
  buffer_load_dwordx4 v[156:159], v10, s[20:23], 0 offen sc1
  v_add_u32 v10, s55, v145
  v_mfma_f32_16x16x32_bf16 v[32:35], a[16:19], v[160:163], v[32:35]
  s_waitcnt lgkmcnt(15)
  s_add_u32 s55, s55, 135168
  s_cmp_eq_u32 s55, s54
  s_cselect_b32 s55, s53, s55
  v_mfma_f32_16x16x32_bf16 v[36:39], a[20:23], v[160:163], v[36:39]
  s_waitcnt lgkmcnt(15)
  v_mfma_f32_16x16x32_bf16 v[40:43], a[24:27], v[160:163], v[40:43]
  s_waitcnt lgkmcnt(15)
  v_mfma_f32_16x16x32_bf16 v[44:47], a[28:31], v[160:163], v[44:47]
  s_waitcnt vmcnt(4)
  v_mfma_f32_16x16x32_bf16 v[48:51], a[16:19], v[164:167], v[48:51]
  buffer_load_dwordx4 v[160:163], v8, s[20:23], 0 offen sc1
  v_add_u32 v8, s55, v144
  v_mfma_f32_16x16x32_bf16 v[52:55], a[20:23], v[164:167], v[52:55]
  v_mfma_f32_16x16x32_bf16 v[56:59], a[24:27], v[164:167], v[56:59]
  v_mfma_f32_16x16x32_bf16 v[60:63], a[28:31], v[164:167], v[60:63]
  s_waitcnt vmcnt(4) lgkmcnt(15)
  buffer_load_dwordx4 v[164:167], v10, s[20:23], 0 offen sc1
  v_add_u32 v10, s55, v145
  s_add_u32 s55, s55, 135168
  s_cmp_eq_u32 s55, s54
  s_cselect_b32 s55, s53, s55
  v_mfma_f32_16x16x32_bf16 v[32:35], a[32:35], v[168:171], v[32:35]
  s_waitcnt lgkmcnt(15)
  v_mfma_f32_16x16x32_bf16 v[36:39], a[36:39], v[168:171], v[36:39]
  s_waitcnt lgkmcnt(15)
  v_mfma_f32_16x16x32_bf16 v[40:43], a[40:43], v[168:171], v[40:43]
  s_waitcnt lgkmcnt(15)
  v_mfma_f32_16x16x32_bf16 v[44:47], a[44:47], v[168:171], v[44:47]
  s_waitcnt vmcnt(4)
  v_mfma_f32_16x16x32_bf16 v[48:51], a[32:35], v[172:175], v[48:51]
  buffer_load_dwordx4 v[168:171], v8, s[20:23], 0 offen sc1
  v_add_u32 v8, s55, v144
  v_mfma_f32_16x16x32_bf16 v[52:55], a[36:39], v[172:175], v[52:55]
  v_mfma_f32_16x16x32_bf16 v[56:59], a[40:43], v[172:175], v[56:59]
  v_mfma_f32_16x16x32_bf16 v[60:63], a[44:47], v[172:175], v[60:63]
  s_waitcnt vmcnt(4) lgkmcnt(15)
  buffer_load_dwordx4 v[172:175], v10, s[20:23], 0 offen sc1
  v_add_u32 v10, s55, v145
  s_add_u32 s55, s55, 135168
  s_cmp_eq_u32 s55, s54
  s_cselect_b32 s55, s53, s55
  v_mfma_f32_16x16x32_bf16 v[32:35], v[64:67], v[152:155], v[32:35]
  s_waitcnt lgkmcnt(15)
  v_mfma_f32_16x16x32_bf16 v[36:39], v[68:71], v[152:155], v[36:39]
  s_waitcnt lgkmcnt(15)
  v_mfma_f32_16x16x32_bf16 v[40:43], v[72:75], v[152:155], v[40:43]
  s_waitcnt lgkmcnt(15)
  v_mfma_f32_16x16x32_bf16 v[44:47], v[76:79], v[152:155], v[44:47]
  s_waitcnt vmcnt(4)
  v_mfma_f32_16x16x32_bf16 v[48:51], v[64:67], v[156:159], v[48:51]
  buffer_load_dwordx4 v[152:155], v8, s[20:23], 0 offen sc1
  v_mfma_f32_16x16x32_bf16 v[52:55], v[68:71], v[156:159], v[52:55]
  v_lshlrev_b32 v64, 16, v4
  v_and_b32 v65, 0xffff0000, v4
  v_lshlrev_b32 v66, 16, v5
  v_mfma_f32_16x16x32_bf16 v[56:59], v[72:75], v[156:159], v[56:59]
  v_and_b32 v67, 0xffff0000, v5
  v_lshlrev_b32 v68, 16, v6
  v_and_b32 v69, 0xffff0000, v6
  v_mfma_f32_16x16x32_bf16 v[60:63], v[76:79], v[156:159], v[60:63]
  s_waitcnt vmcnt(4) lgkmcnt(15)
  v_lshlrev_b32 v70, 16, v7
  v_and_b32 v71, 0xffff0000, v7
  buffer_load_dwordx4 v[156:159], v10, s[20:23], 0 offen sc1
  v_mfma_f32_16x16x32_bf16 v[32:35], v[80:83], v[160:163], v[32:35]
  s_waitcnt lgkmcnt(15)
  v_mfma_f32_16x16x32_bf16 v[36:39], v[84:87], v[160:163], v[36:39]
  s_waitcnt lgkmcnt(15)
  v_mfma_f32_16x16x32_bf16 v[40:43], v[88:91], v[160:163], v[40:43]
  s_waitcnt lgkmcnt(15)
  v_mfma_f32_16x16x32_bf16 v[44:47], v[92:95], v[160:163], v[44:47]
  s_waitcnt vmcnt(4)
  v_mfma_f32_16x16x32_bf16 v[48:51], v[80:83], v[164:167], v[48:51]
  v_mfma_f32_16x16x32_bf16 v[52:55], v[84:87], v[164:167], v[52:55]
  v_mfma_f32_16x16x32_bf16 v[56:59], v[88:91], v[164:167], v[56:59]
  v_mfma_f32_16x16x32_bf16 v[60:63], v[92:95], v[164:167], v[60:63]
  s_waitcnt vmcnt(3) lgkmcnt(15)
  v_mfma_f32_16x16x32_bf16 v[32:35], v[96:99], v[168:171], v[32:35]
  s_waitcnt lgkmcnt(13)
  ds_read_b32 v31, v30 offset:64
  v_mfma_f32_16x16x32_bf16 v[36:39], v[100:103], v[168:171], v[36:39]
  s_waitcnt lgkmcnt(12)
  v_mfma_f32_16x16x32_bf16 v[40:43], v[104:107], v[168:171], v[40:43]
  s_waitcnt lgkmcnt(10)
  v_mfma_f32_16x16x32_bf16 v[44:47], v[108:111], v[168:171], v[44:47]
  s_waitcnt vmcnt(2)
  v_mfma_f32_16x16x32_bf16 v[48:51], v[96:99], v[172:175], v[48:51]
  v_mfma_f32_16x16x32_bf16 v[52:55], v[100:103], v[172:175], v[52:55]
  v_mfma_f32_16x16x32_bf16 v[56:59], v[104:107], v[172:175], v[56:59]
  v_mfma_f32_16x16x32_bf16 v[60:63], v[108:111], v[172:175], v[60:63]
  s_waitcnt vmcnt(1) lgkmcnt(8)
  v_mfma_f32_16x16x32_bf16 v[32:35], v[112:115], v[152:155], v[32:35]
  s_waitcnt lgkmcnt(6)
  v_mfma_f32_16x16x32_bf16 v[36:39], v[116:119], v[152:155], v[36:39]
  s_waitcnt lgkmcnt(4)
  v_mfma_f32_16x16x32_bf16 v[40:43], v[120:123], v[152:155], v[40:43]
  s_waitcnt lgkmcnt(0)
  L_pfc0:
  v_readfirstlane_b32 s64, v31
  s_nop 1
  s_cmp_ge_u32 s64, 4
  s_cbranch_scc1 L_pfdc0
  ds_read_b32 v31, v30 offset:64
  s_waitcnt lgkmcnt(0)
  s_branch L_pfc0
L_pfdc0:
  v_mfma_f32_16x16x32_bf16 v[44:47], v[124:127], v[152:155], v[44:47]
  s_waitcnt vmcnt(0)
  s_nop 1
  ds_write_b128 v16, v[36:39] offset:3584
  v_mfma_f32_16x16x32_bf16 v[48:51], v[112:115], v[156:159], v[48:51]
  v_mfma_f32_16x16x32_bf16 v[52:55], v[116:119], v[156:159], v[52:55]
  v_mfma_f32_16x16x32_bf16 v[56:59], v[120:123], v[156:159], v[56:59]
  v_mfma_f32_16x16x32_bf16 v[60:63], v[124:127], v[156:159], v[60:63]
  s_nop 5
  ds_write_b128 v16, v[52:55] offset:4608
  ds_write_b128 v16, v[40:43] offset:42496
  ds_write_b128 v16, v[56:59] offset:43520
  ds_write_b128 v16, v[44:47] offset:58880
  ds_write_b128 v16, v[60:63] offset:59904
  s_waitcnt lgkmcnt(0)
  s_barrier
  ds_read_b128 v[80:83], v17 offset:0
  ds_read_b128 v[84:87], v17 offset:1024
  ds_read_b128 v[88:91], v18 offset:0
  ds_read_b128 v[92:95], v18 offset:1024
  ds_read_b128 v[96:99], v19 offset:0
  ds_read_b128 v[100:103], v19 offset:1024
  s_waitcnt lgkmcnt(5)
  v_pk_add_f32 v[80:81], v[80:81], v[32:33]
  v_pk_add_f32 v[82:83], v[82:83], v[34:35]
  s_waitcnt lgkmcnt(4)
  v_pk_add_f32 v[84:85], v[84:85], v[48:49]
  v_pk_add_f32 v[86:87], v[86:87], v[50:51]
  s_waitcnt lgkmcnt(3)
  v_pk_add_f32 v[80:81], v[80:81], v[88:89]
  v_pk_add_f32 v[82:83], v[82:83], v[90:91]
  s_waitcnt lgkmcnt(2)
  v_pk_add_f32 v[84:85], v[84:85], v[92:93]
  v_pk_add_f32 v[86:87], v[86:87], v[94:95]
  v_mul_f32 v72, 0xbfb8aa3b, v80
  v_mul_f32 v73, 0xbfb8aa3b, v81
  v_mul_f32 v74, 0xbfb8aa3b, v82
  v_mul_f32 v75, 0xbfb8aa3b, v83
  v_mul_f32 v76, 0xbfb8aa3b, v84
  v_mul_f32 v77, 0xbfb8aa3b, v85
  v_mul_f32 v78, 0xbfb8aa3b, v86
  v_mul_f32 v79, 0xbfb8aa3b, v87
  v_exp_f32 v72, v72
  v_exp_f32 v73, v73
  v_exp_f32 v74, v74
  v_exp_f32 v75, v75
  v_exp_f32 v76, v76
  v_exp_f32 v77, v77
  v_exp_f32 v78, v78
  v_exp_f32 v79, v79
  v_add_f32 v72, 1.0, v72
  v_add_f32 v73, 1.0, v73
  v_add_f32 v74, 1.0, v74
  v_add_f32 v75, 1.0, v75
  v_add_f32 v76, 1.0, v76
  v_add_f32 v77, 1.0, v77
  v_add_f32 v78, 1.0, v78
  v_add_f32 v79, 1.0, v79
  v_rcp_f32 v72, v72
  v_rcp_f32 v73, v73
  v_rcp_f32 v74, v74
  v_rcp_f32 v75, v75
  v_rcp_f32 v76, v76
  v_rcp_f32 v77, v77
  v_rcp_f32 v78, v78
  v_rcp_f32 v79, v79
  s_waitcnt lgkmcnt(1)
  v_pk_mul_f32 v[80:81], v[80:81], v[96:97]
  v_pk_mul_f32 v[82:83], v[82:83], v[98:99]
  s_waitcnt lgkmcnt(0)
  v_pk_mul_f32 v[84:85], v[84:85], v[100:101]
  v_pk_mul_f32 v[86:87], v[86:87], v[102:103]
  v_pk_fma_f32 v[64:65], v[80:81], v[72:73], v[64:65]
  v_pk_fma_f32 v[66:67], v[82:83], v[74:75], v[66:67]
  v_pk_fma_f32 v[68:69], v[84:85], v[76:77], v[68:69]
  v_pk_fma_f32 v[70:71], v[86:87], v[78:79], v[70:71]
  v_cvt_pk_bf16_f32 v4, v64, v65
  v_cvt_pk_bf16_f32 v5, v66, v67
  v_cvt_pk_bf16_f32 v6, v68, v69
  v_cvt_pk_bf16_f32 v7, v70, v71
  buffer_store_dwordx2 v[4:5], v13, s[16:19], 0 offen nt
  buffer_store_dwordx2 v[6:7], v14, s[16:19], 0 offen nt
  s_endpgm
L_s2s:
  v_lshrrev_b32 v4, 2, v1
  v_lshlrev_b32 v4, 7, v4
  v_and_b32 v5, 3, v1
  v_lshl_add_u32 v4, v5, 3, v4
  v_bfe_u32 v5, v1, 3, 2
  v_xor_b32 v5, s32, v5
  v_lshl_add_u32 v4, v5, 5, v4
  s_lshl_b32 s47, s32, 12
  s_add_u32 s47, s47, 3584
  v_add_u32 v16, s47, v4
  v_xor_b32 v17, 32, v16
  v_xor_b32 v18, 64, v16
  v_xor_b32 v19, 96, v16
  v_add_u32 v20, 55296, v16
  v_add_u32 v21, 55296, v17
  v_add_u32 v22, 55296, v18
  v_add_u32 v23, 55296, v19
  v_add_u32 v24, 120832, v16
  v_add_u32 v25, 120832, v17
  v_add_u32 v26, 120832, v18
  v_add_u32 v27, 120832, v19
  s_setprio 3
  v_lshl_add_u32 v7, v1, 3, s101
  v_cmp_gt_u32 vcc, 16, v1
  s_nop 1
  v_cndmask_b32 v7, -16, v7, vcc
  s_lshl_b32 s47, s30, 2
  s_add_u32 s47, s47, 3072
  v_mov_b32 v30, s47
  v_mov_b32 v31, 0
  v_xor_b32 v0, 4, v30
  s_waitcnt vmcnt(0)
  s_barrier
  v_cmp_ne_u32 vcc, 0, v28
  s_nop 4
  s_cbranch_vccz L_pna
L_psa:
  s_cmp_lg_u32 s30, 6
  s_cbranch_scc1 L_pea
  buffer_store_dwordx2 v[28:29], v7, s[24:27], 0 offen sc1
L_pea:
  v_add_u32 v12, s72, v11
  s_add_u32 m0, s76, 3584
  s_nop 0
  buffer_load_dwordx4 v12, s[68:71], 0 offen lds
  v_add_u32 v9, 7168, v12
  s_add_u32 m0, s76, 4608
  s_nop 0
  buffer_load_dwordx4 v9, s[68:71], 0 offen lds
  s_add_u32 s72, s72, s75
  s_cmp_eq_u32 s72, s73
  s_cselect_b32 s72, s74, s72
  ds_read_b64_tr_b16 a[0:1], v16 offset:38912
  ds_read_b64_tr_b16 a[2:3], v16 offset:40960
  ds_read_b64_tr_b16 a[4:5], v17 offset:38912
  ds_read_b64_tr_b16 a[6:7], v17 offset:40960
  ds_read_b64_tr_b16 a[8:9], v18 offset:38912
  ds_read_b64_tr_b16 a[10:11], v18 offset:40960
  ds_read_b64_tr_b16 a[12:13], v19 offset:38912
  ds_read_b64_tr_b16 a[14:15], v19 offset:40960
  ds_read_b64_tr_b16 a[16:17], v20 offset:0
  ds_read_b64_tr_b16 a[18:19], v20 offset:2048
  ds_read_b64_tr_b16 a[20:21], v21 offset:0
  ds_read_b64_tr_b16 a[22:23], v21 offset:2048
  ds_read_b64_tr_b16 a[24:25], v22 offset:0
  ds_read_b64_tr_b16 a[26:27], v22 offset:2048
  ds_read_b64_tr_b16 a[28:29], v23 offset:0
  ds_read_b64_tr_b16 a[30:31], v23 offset:2048
  ds_read_b64_tr_b16 a[32:33], v20 offset:16384
  ds_read_b64_tr_b16 a[34:35], v20 offset:18432
  ds_read_b64_tr_b16 a[36:37], v21 offset:16384
  ds_read_b64_tr_b16 a[38:39], v21 offset:18432
  ds_read_b64_tr_b16 a[40:41], v22 offset:16384
  ds_read_b64_tr_b16 a[42:43], v22 offset:18432
  ds_read_b64_tr_b16 a[44:45], v23 offset:16384
  ds_read_b64_tr_b16 a[46:47], v23 offset:18432
  ds_read_b64_tr_b16 v[64:65], v20 offset:32768
  ds_read_b64_tr_b16 v[66:67], v20 offset:34816
  ds_read_b64_tr_b16 v[68:69], v21 offset:32768
  ds_read_b64_tr_b16 v[70:71], v21 offset:34816
  ds_read_b64_tr_b16 v[72:73], v22 offset:32768
  ds_read_b64_tr_b16 v[74:75], v22 offset:34816
  ds_read_b64_tr_b16 v[76:77], v23 offset:32768
  ds_read_b64_tr_b16 v[78:79], v23 offset:34816
  ds_write_b32 v30, v31 offset:64
  s_waitcnt lgkmcnt(0)
  s_barrier
  s_waitcnt lgkmcnt(0)
  v_add_u32 v12, s72, v11
  s_add_u32 m0, s76, 42496
  s_nop 0
  buffer_load_dwordx4 v12, s[68:71], 0 offen lds
  v_add_u32 v9, 7168, v12
  s_add_u32 m0, s76, 43520
  s_nop 0
  buffer_load_dwordx4 v9, s[68:71], 0 offen lds
  s_add_u32 s72, s72, s75
  s_cmp_eq_u32 s72, s73
  s_cselect_b32 s72, s74, s72
  ds_read_b64_tr_b16 v[80:81], v16 offset:22528
  ds_read_b64_tr_b16 v[82:83], v16 offset:24576
  ds_read_b64_tr_b16 v[84:85], v17 offset:22528
  ds_read_b64_tr_b16 v[86:87], v17 offset:24576
  ds_read_b64_tr_b16 v[88:89], v18 offset:22528
  ds_read_b64_tr_b16 v[90:91], v18 offset:24576
  ds_read_b64_tr_b16 v[92:93], v19 offset:22528
  ds_read_b64_tr_b16 v[94:95], v19 offset:24576
  v_add_u32 v12, s72, v11
  s_add_u32 m0, s76, 58880
  s_nop 0
  buffer_load_dwordx4 v12, s[68:71], 0 offen lds
  v_add_u32 v9, 7168, v12
  s_add_u32 m0, s76, 59904
  s_nop 0
  buffer_load_dwordx4 v9, s[68:71], 0 offen lds
  s_add_u32 s72, s72, s75
  s_cmp_eq_u32 s72, s73
  s_cselect_b32 s72, s74, s72
  ds_read_b64_tr_b16 v[96:97], v20 offset:49152
  ds_read_b64_tr_b16 v[98:99], v20 offset:51200
  ds_read_b64_tr_b16 v[100:101], v21 offset:49152
  ds_read_b64_tr_b16 v[102:103], v21 offset:51200
  ds_read_b64_tr_b16 v[104:105], v22 offset:49152
  ds_read_b64_tr_b16 v[106:107], v22 offset:51200
  ds_read_b64_tr_b16 v[108:109], v23 offset:49152
  ds_read_b64_tr_b16 v[110:111], v23 offset:51200
  v_add_u32 v12, s72, v11
  s_add_u32 m0, s76, 75264
  s_nop 0
  buffer_load_dwordx4 v12, s[68:71], 0 offen lds
  v_add_u32 v9, 7168, v12
  s_add_u32 m0, s76, 76288
  s_nop 0
  buffer_load_dwordx4 v9, s[68:71], 0 offen lds
  s_add_u32 s72, s72, s75
  s_cmp_eq_u32 s72, s73
  s_cselect_b32 s72, s74, s72
  ds_read_b64_tr_b16 v[112:113], v24 offset:0
  ds_read_b64_tr_b16 v[114:115], v24 offset:2048
  ds_read_b64_tr_b16 v[116:117], v25 offset:0
  ds_read_b64_tr_b16 v[118:119], v25 offset:2048
  ds_read_b64_tr_b16 v[120:121], v26 offset:0
  ds_read_b64_tr_b16 v[122:123], v26 offset:2048
  ds_read_b64_tr_b16 v[124:125], v27 offset:0
  ds_read_b64_tr_b16 v[126:127], v27 offset:2048
  v_add_u32 v12, s72, v11
  s_add_u32 m0, s76, 91648
  s_nop 0
  buffer_load_dwordx4 v12, s[68:71], 0 offen lds
  v_add_u32 v9, 7168, v12
  s_add_u32 m0, s76, 92672
  s_nop 0
  buffer_load_dwordx4 v9, s[68:71], 0 offen lds
  s_add_u32 s72, s72, s75
  s_cmp_eq_u32 s72, s73
  s_cselect_b32 s72, s74, s72
  ds_read_b64_tr_b16 v[128:129], v24 offset:16384
  ds_read_b64_tr_b16 v[130:131], v24 offset:18432
  ds_read_b64_tr_b16 v[132:133], v25 offset:16384
  ds_read_b64_tr_b16 v[134:135], v25 offset:18432
  ds_read_b64_tr_b16 v[136:137], v26 offset:16384
  ds_read_b64_tr_b16 v[138:139], v26 offset:18432
  ds_read_b64_tr_b16 v[140:141], v27 offset:16384
  ds_read_b64_tr_b16 v[142:143], v27 offset:18432
  s_lshl_b32 s47, s66, 6
  s_mul_i32 s48, s47, 47663
  s_lshr_b32 s48, s48, 23
  s_mul_i32 s59, s48, 5
  s_cmp_eq_u32 s48, 11
  s_cselect_b32 s59, 63, s59
  s_sub_u32 s59, s47, s59
  s_mul_i32 s50, s59, 44621
  s_lshr_b32 s50, s50, 22
  s_add_u32 s47, s47, 63
  s_mul_i32 s49, s47, 47663
  s_lshr_b32 s49, s49, 23
  s_mul_i32 s59, s49, 5
  s_cmp_eq_u32 s49, 11
  s_cselect_b32 s59, 63, s59
  s_sub_u32 s59, s47, s59
  s_min_u32 s59, s59, 2047
  s_mul_i32 s51, s59, 44621
  s_lshr_b32 s51, s51, 22
  s_mul_i32 s48, s48, 14
  s_mul_i32 s49, s49, 14
  s_sub_u32 s49, s49, 14
  s_lshl_b32 s50, s50, 2
  s_add_u32 s50, s50, 140
  s_lshl_b32 s51, s51, 2
  s_add_u32 s51, s51, 136
  v_min_u32 v47, 35, v1
  v_mov_b32 v15, s48
  v_mov_b32 v48, s49
  v_cmp_le_u32 vcc, 14, v47
  s_nop 1
  v_cndmask_b32 v15, v15, v48, vcc
  v_mov_b32 v48, s50
  v_cmp_le_u32 vcc, 28, v47
  s_nop 1
  v_cndmask_b32 v15, v15, v48, vcc
  v_mov_b32 v48, s51
  v_cmp_le_u32 vcc, 32, v47
  s_nop 1
  v_cndmask_b32 v15, v15, v48, vcc
  v_add_u32 v15, v15, v47
  v_lshlrev_b32 v15, 7, v15
  v_add_u32 v15, 9732096, v15
  s_mov_b32 s48, 0x0fffffff
  s_mov_b32 s49, 0
  s_mov_b32 s50, 0xf0000000
  s_mov_b32 s51, 15
  s_waitcnt lgkmcnt(0)
  s_barrier
  s_lshl_b32 s45, s66, 1
  s_add_u32 s45, s45, s31
  s_lshl_b32 s45, s45, 5
  s_lshl_b32 s47, s32, 5
  s_lshl_b32 s46, s67, 7
  s_add_u32 s46, s46, s47
  v_mul_u32_u24 v40, 33792, v3
  s_mov_b32 s47, 47663
  s_mov_b32 s52, 44621
  v_add_u32 v44, s45, v2
  v_add_u32 v44, 0, v44
  v_mul_lo_u32 v45, v44, s47
  v_lshrrev_b32 v45, 23, v45
  v_mul_u32_u24 v46, 176, v45
  v_sub_u32 v46, v44, v46
  v_mul_u32_u24 v41, 171, v45
  v_min_u32 v42, 1873, v41
  v_add_u32 v42, v42, v46
  v_sub_u32 v41, v42, v41
  v_cmp_gt_u32 vcc, 171, v41
  v_mul_u32_u24 v41, 896, v42
  v_lshl_add_u32 v41, v3, 3, v41
  v_add_u32 v41, s46, v41
  v_cndmask_b32 v13, -16, v41, vcc
  v_min_u32 v42, 2047, v42
  v_mul_lo_u32 v45, v42, s52
  v_lshrrev_b32 v45, 22, v45
  v_mul_u32_u24 v46, 94, v45
  v_min_u32 v46, 1953, v46
  v_sub_u32 v42, v42, v46
  buffer_load_dwordx2 v[4:5], v15, s[24:27], 0 offen sc1
  v_add_u32 v12, s72, v11
  s_add_u32 m0, s76, 26112
  s_nop 0
  buffer_load_dwordx4 v12, s[68:71], 0 offen lds
  v_add_u32 v9, 7168, v12
  s_add_u32 m0, s76, 27136
  s_nop 0
  buffer_load_dwordx4 v9, s[68:71], 0 offen lds
  s_add_u32 s72, s72, s75
  s_cmp_eq_u32 s72, s73
  s_cselect_b32 s72, s74, s72
  v_mul_u32_u24 v45, 96, v45
  v_add_u32 v44, v42, v45
  v_lshl_add_u32 v144, v44, 4, v40
  v_add_u32 v44, s45, v2
  v_add_u32 v44, 16, v44
  v_mul_lo_u32 v45, v44, s47
  v_lshrrev_b32 v45, 23, v45
  v_mul_u32_u24 v46, 176, v45
  v_sub_u32 v46, v44, v46
  v_mul_u32_u24 v41, 171, v45
  v_min_u32 v42, 1873, v41
  v_add_u32 v42, v42, v46
  v_sub_u32 v41, v42, v41
  v_cmp_gt_u32 vcc, 171, v41
  v_mul_u32_u24 v41, 896, v42
  v_lshl_add_u32 v41, v3, 3, v41
  v_add_u32 v41, s46, v41
  v_cndmask_b32 v14, -16, v41, vcc
  v_min_u32 v42, 2047, v42
  v_mul_lo_u32 v45, v42, s52
  v_lshrrev_b32 v45, 22, v45
  v_mul_u32_u24 v46, 94, v45
  v_min_u32 v46, 1953, v46
  v_sub_u32 v42, v42, v46
  v_mul_u32_u24 v45, 96, v45
  v_add_u32 v44, v42, v45
  v_lshl_add_u32 v145, v44, 4, v40
  s_mul_i32 s53, s32, 0
  s_add_u32 s53, s53, 0
  s_add_u32 s54, s53, 2162688
  s_mul_i32 s55, s42, 135168
  s_add_u32 s55, s55, s53
  s_mov_b32 s18, 1835008
  s_mov_b32 s19, 0x20000
  s_mov_b32 s20, s24
  s_mov_b32 s21, s25
  s_mov_b32 s22, 9732096
  s_mov_b32 s23, 0x20000
  s_waitcnt vmcnt(2)
  s_mov_b32 s65, 0

L_pl0:
  v_cmp_ne_u64 vcc, v[4:5], v[28:29]
  s_add_u32 s65, s65, 1
  s_cmp_ge_u32 s65, 0x40000
  s_cbranch_scc1 L_pd0
  s_nop 1
  s_and_b64 vcc, vcc, s[48:49]
  s_cbranch_scc0 L_pd0
  s_sleep 3
  buffer_load_dwordx2 v[4:5], v15, s[24:27], 0 offen sc1
  s_waitcnt vmcnt(0)
  s_branch L_pl0
L_pd0:
  s_barrier
  s_mov_b32 s65, 0

L_pl1:
  v_cmp_ne_u64 vcc, v[4:5], v[28:29]
  s_add_u32 s65, s65, 1
  s_cmp_ge_u32 s65, 0x40000
  s_cbranch_scc1 L_pd1
  s_nop 1
  s_and_b64 vcc, vcc, s[50:51]
  s_cbranch_scc0 L_pd1
  s_sleep 3
  buffer_load_dwordx2 v[4:5], v15, s[24:27], 0 offen sc1
  s_waitcnt vmcnt(0)
  s_branch L_pl1
L_pd1:
  s_setprio 0
  v_add_u32 v8, s55, v144
  buffer_load_dwordx4 v[152:155], v8, s[20:23], 0 offen sc1
  v_add_u32 v10, s55, v145
  buffer_load_dwordx4 v[156:159], v10, s[20:23], 0 offen sc1
  s_add_u32 s55, s55, 135168
  s_cmp_eq_u32 s55, s54
  s_cselect_b32 s55, s53, s55
  v_add_u32 v8, s55, v144
  buffer_load_dwordx4 v[160:163], v8, s[20:23], 0 offen sc1
  v_add_u32 v10, s55, v145
  buffer_load_dwordx4 v[164:167], v10, s[20:23], 0 offen sc1
  s_add_u32 s55, s55, 135168
  s_cmp_eq_u32 s55, s54
  s_cselect_b32 s55, s53, s55
  v_add_u32 v8, s55, v144
  buffer_load_dwordx4 v[168:171], v8, s[20:23], 0 offen sc1
  v_add_u32 v10, s55, v145
  buffer_load_dwordx4 v[172:175], v10, s[20:23], 0 offen sc1
  s_add_u32 s55, s55, 135168
  s_cmp_eq_u32 s55, s54
  s_cselect_b32 s55, s53, s55
  v_mov_b32 v146, 3
  v_add_u32 v8, s55, v144
  v_add_u32 v10, s55, v145
  s_add_u32 s55, s55, 135168
  s_cmp_eq_u32 s55, s54
  s_cselect_b32 s55, s53, s55
  s_lshl_b32 s47, s31, 11
  v_lshl_add_u32 v12, v1, 4, s47
  s_waitcnt vmcnt(5)
  v_mfma_f32_16x16x32_bf16 v[32:35], a[48:51], v[152:155], 0
  ds_write_b32 v0, v146 offset:64
  s_nop 1
  v_mov_b32 v146, 4
  v_mfma_f32_16x16x32_bf16 v[36:39], a[52:55], v[152:155], 0
  v_mfma_f32_16x16x32_bf16 v[40:43], a[56:59], v[152:155], 0
  v_mfma_f32_16x16x32_bf16 v[44:47], a[60:63], v[152:155], 0
  s_waitcnt vmcnt(4)
  v_mfma_f32_16x16x32_bf16 v[48:51], a[48:51], v[156:159], 0
  buffer_load_dwordx4 v[152:155], v8, s[20:23], 0 offen sc1
  v_add_u32 v8, s55, v144
  v_mfma_f32_16x16x32_bf16 v[52:55], a[52:55], v[156:159], 0
  v_mfma_f32_16x16x32_bf16 v[56:59], a[56:59], v[156:159], 0
  v_mfma_f32_16x16x32_bf16 v[60:63], a[60:63], v[156:159], 0
  s_waitcnt vmcnt(4)
  v_mfma_f32_16x16x32_bf16 v[32:35], a[64:67], v[160:163], v[32:35]
  buffer_load_dwordx4 v[156:159], v10, s[20:23], 0 offen sc1
  v_add_u32 v10, s55, v145
  ds_read_b32 v31, v30 offset:64
  s_add_u32 s55, s55, 135168
  s_cmp_eq_u32 s55, s54
  s_cselect_b32 s55, s53, s55
  v_mfma_f32_16x16x32_bf16 v[36:39], a[68:71], v[160:163], v[36:39]
  v_mfma_f32_16x16x32_bf16 v[40:43], a[72:75], v[160:163], v[40:43]
  v_mfma_f32_16x16x32_bf16 v[44:47], a[76:79], v[160:163], v[44:47]
  s_waitcnt vmcnt(4)
  v_mfma_f32_16x16x32_bf16 v[48:51], a[64:67], v[164:167], v[48:51]
  buffer_load_dwordx4 v[160:163], v8, s[20:23], 0 offen sc1
  v_add_u32 v8, s55, v144
  v_mfma_f32_16x16x32_bf16 v[52:55], a[68:71], v[164:167], v[52:55]
  v_mfma_f32_16x16x32_bf16 v[56:59], a[72:75], v[164:167], v[56:59]
  v_mfma_f32_16x16x32_bf16 v[60:63], a[76:79], v[164:167], v[60:63]
  s_waitcnt vmcnt(4)
  v_mfma_f32_16x16x32_bf16 v[32:35], a[0:3], v[168:171], v[32:35]
  s_waitcnt lgkmcnt(0)
  buffer_load_dwordx4 v[164:167], v10, s[20:23], 0 offen sc1
  v_add_u32 v10, s55, v145
  L_pfl1:
  v_readfirstlane_b32 s64, v31
  s_nop 1
  s_cmp_ge_u32 s64, 3
  s_cbranch_scc1 L_pfdl1
  ds_read_b32 v31, v30 offset:64
  s_waitcnt lgkmcnt(0)
  s_branch L_pfl1
L_pfdl1:
  s_add_u32 s55, s55, 135168
  s_cmp_eq_u32 s55, s54
  s_cselect_b32 s55, s53, s55
  v_mfma_f32_16x16x32_bf16 v[36:39], a[4:7], v[168:171], v[36:39]
  ds_read_b64_tr_b16 a[48:49], v16 offset:0
  v_mfma_f32_16x16x32_bf16 v[40:43], a[8:11], v[168:171], v[40:43]
  ds_read_b64_tr_b16 a[50:51], v16 offset:2048
  v_mfma_f32_16x16x32_bf16 v[44:47], a[12:15], v[168:171], v[44:47]
  s_waitcnt vmcnt(4)
  ds_read_b64_tr_b16 a[52:53], v17 offset:0
  v_mfma_f32_16x16x32_bf16 v[48:51], a[0:3], v[172:175], v[48:51]
  buffer_load_dwordx4 v[168:171], v8, s[20:23], 0 offen sc1
  v_add_u32 v8, s55, v144
  v_mfma_f32_16x16x32_bf16 v[52:55], a[4:7], v[172:175], v[52:55]
  ds_read_b64_tr_b16 a[54:55], v17 offset:2048
  v_mfma_f32_16x16x32_bf16 v[56:59], a[8:11], v[172:175], v[56:59]
  ds_read_b64_tr_b16 a[56:57], v18 offset:0
  v_mfma_f32_16x16x32_bf16 v[60:63], a[12:15], v[172:175], v[60:63]
  ds_read_b64_tr_b16 a[58:59], v18 offset:2048
  buffer_load_dwordx4 v[172:175], v10, s[20:23], 0 offen sc1
  buffer_load_dwordx2 v[4:5], v13, s[12:15], 0 offen
  buffer_load_dwordx2 v[6:7], v14, s[12:15], 0 offen
  v_add_u32 v10, s55, v145
  s_add_u32 s55, s55, 135168
  s_cmp_eq_u32 s55, s54
  s_cselect_b32 s55, s53, s55
  ds_read_b64_tr_b16 a[60:61], v19 offset:0
  ds_read_b64_tr_b16 a[62:63], v19 offset:2048
  ds_read_b64_tr_b16 a[64:65], v16 offset:38912
  ds_read_b64_tr_b16 a[66:67], v16 offset:40960
  ds_read_b64_tr_b16 a[68:69], v17 offset:38912
  ds_read_b64_tr_b16 a[70:71], v17 offset:40960
  ds_read_b64_tr_b16 a[72:73], v18 offset:38912
  ds_read_b64_tr_b16 a[74:75], v18 offset:40960
  ds_read_b64_tr_b16 a[76:77], v19 offset:38912
  ds_read_b64_tr_b16 a[78:79], v19 offset:40960
  ds_read_b64_tr_b16 a[0:1], v20 offset:0
  ds_read_b64_tr_b16 a[2:3], v20 offset:2048
  ds_read_b64_tr_b16 a[4:5], v21 offset:0
  ds_read_b64_tr_b16 a[6:7], v21 offset:2048
  ds_read_b64_tr_b16 a[8:9], v22 offset:0
  ds_read_b64_tr_b16 a[10:11], v22 offset:2048
  ds_read_b64_tr_b16 a[12:13], v23 offset:0
  ds_read_b64_tr_b16 a[14:15], v23 offset:2048
  s_waitcnt vmcnt(7)
  v_mfma_f32_16x16x32_bf16 v[32:35], a[16:19], v[152:155], v[32:35]
  v_mfma_f32_16x16x32_bf16 v[36:39], a[20:23], v[152:155], v[36:39]
  v_mfma_f32_16x16x32_bf16 v[40:43], a[24:27], v[152:155], v[40:43]
  v_mfma_f32_16x16x32_bf16 v[44:47], a[28:31], v[152:155], v[44:47]
  s_waitcnt vmcnt(6)
  v_mfma_f32_16x16x32_bf16 v[48:51], a[16:19], v[156:159], v[48:51]
  buffer_load_dwordx4 v[152:155], v8, s[20:23], 0 offen sc1
  v_add_u32 v8, s55, v144
  v_mfma_f32_16x16x32_bf16 v[52:55], a[20:23], v[156:159], v[52:55]
  ds_read_b64_tr_b16 a[16:17], v20 offset:16384
  v_mfma_f32_16x16x32_bf16 v[56:59], a[24:27], v[156:159], v[56:59]
  ds_read_b64_tr_b16 a[18:19], v20 offset:18432
  v_mfma_f32_16x16x32_bf16 v[60:63], a[28:31], v[156:159], v[60:63]
  s_waitcnt vmcnt(6)
  ds_read_b64_tr_b16 a[20:21], v21 offset:16384
  buffer_load_dwordx4 v[156:159], v10, s[20:23], 0 offen sc1
  v_add_u32 v10, s55, v145
  v_mfma_f32_16x16x32_bf16 v[32:35], a[32:35], v[160:163], v[32:35]
  s_add_u32 s55, s55, 135168
  s_cmp_eq_u32 s55, s54
  s_cselect_b32 s55, s53, s55
  v_mfma_f32_16x16x32_bf16 v[36:39], a[36:39], v[160:163], v[36:39]
  ds_read_b64_tr_b16 a[22:23], v21 offset:18432
  v_mfma_f32_16x16x32_bf16 v[40:43], a[40:43], v[160:163], v[40:43]
  ds_read_b64_tr_b16 a[24:25], v22 offset:16384
  v_mfma_f32_16x16x32_bf16 v[44:47], a[44:47], v[160:163], v[44:47]
  s_waitcnt vmcnt(6)
  ds_read_b64_tr_b16 a[26:27], v22 offset:18432
  v_mfma_f32_16x16x32_bf16 v[48:51], a[32:35], v[164:167], v[48:51]
  buffer_load_dwordx4 v[160:163], v8, s[20:23], 0 offen sc1
  v_add_u32 v8, s55, v144
  v_mfma_f32_16x16x32_bf16 v[52:55], a[36:39], v[164:167], v[52:55]
  ds_read_b64_tr_b16 a[28:29], v23 offset:16384
  v_mfma_f32_16x16x32_bf16 v[56:59], a[40:43], v[164:167], v[56:59]
  ds_read_b64_tr_b16 a[30:31], v23 offset:18432
  v_mfma_f32_16x16x32_bf16 v[60:63], a[44:47], v[164:167], v[60:63]
  ds_read_b64_tr_b16 a[32:33], v20 offset:32768
  buffer_load_dwordx4 v[164:167], v10, s[20:23], 0 offen sc1
  v_add_u32 v10, s55, v145
  s_add_u32 s55, s55, 135168
  s_cmp_eq_u32 s55, s54
  s_cselect_b32 s55, s53, s55
  ds_read_b64_tr_b16 a[34:35], v20 offset:34816
  ds_read_b64_tr_b16 a[36:37], v21 offset:32768
  ds_read_b64_tr_b16 a[38:39], v21 offset:34816
  ds_read_b64_tr_b16 a[40:41], v22 offset:32768
  ds_read_b64_tr_b16 a[42:43], v22 offset:34816
  s_waitcnt vmcnt(7)
  v_mfma_f32_16x16x32_bf16 v[32:35], v[64:67], v[168:171], v[32:35]
  ds_read_b64_tr_b16 a[44:45], v23 offset:32768
  v_mfma_f32_16x16x32_bf16 v[36:39], v[68:71], v[168:171], v[36:39]
  ds_read_b64_tr_b16 a[46:47], v23 offset:34816
  v_mfma_f32_16x16x32_bf16 v[40:43], v[72:75], v[168:171], v[40:43]
  v_mfma_f32_16x16x32_bf16 v[44:47], v[76:79], v[168:171], v[44:47]
  s_waitcnt vmcnt(6)
  v_mfma_f32_16x16x32_bf16 v[48:51], v[64:67], v[172:175], v[48:51]
  buffer_load_dwordx4 v[168:171], v8, s[20:23], 0 offen sc1
  v_add_u32 v8, s55, v144
  v_mfma_f32_16x16x32_bf16 v[52:55], v[68:71], v[172:175], v[52:55]
  ds_read_b64_tr_b16 v[64:65], v16 offset:22528
  v_mfma_f32_16x16x32_bf16 v[56:59], v[72:75], v[172:175], v[56:59]
  ds_read_b64_tr_b16 v[66:67], v16 offset:24576
  v_lshl_add_u32 v16, v1, 4, s76
  v_mfma_f32_16x16x32_bf16 v[60:63], v[76:79], v[172:175], v[60:63]
  ds_read_b64_tr_b16 v[68:69], v17 offset:22528
  buffer_load_dwordx4 v[172:175], v10, s[20:23], 0 offen sc1
  v_add_u32 v10, s55, v145
  s_add_u32 s55, s55, 135168
  s_cmp_eq_u32 s55, s54
  s_cselect_b32 s55, s53, s55
  ds_read_b64_tr_b16 v[70:71], v17 offset:24576
  ds_read_b64_tr_b16 v[72:73], v18 offset:22528
  ds_read_b64_tr_b16 v[74:75], v18 offset:24576
  ds_read_b64_tr_b16 v[76:77], v19 offset:22528
  ds_read_b64_tr_b16 v[78:79], v19 offset:24576
  v_add_u32 v17, 58880, v12
  v_add_u32 v18, 46592, v12
  v_add_u32 v19, 11776, v12
  s_waitcnt vmcnt(5)
  v_mfma_f32_16x16x32_bf16 v[32:35], v[80:83], v[152:155], v[32:35]
  v_mfma_f32_16x16x32_bf16 v[36:39], v[84:87], v[152:155], v[36:39]
  v_mfma_f32_16x16x32_bf16 v[40:43], v[88:91], v[152:155], v[40:43]
  v_mfma_f32_16x16x32_bf16 v[44:47], v[92:95], v[152:155], v[44:47]
  s_waitcnt vmcnt(4)
  v_mfma_f32_16x16x32_bf16 v[48:51], v[80:83], v[156:159], v[48:51]
  buffer_load_dwordx4 v[152:155], v8, s[20:23], 0 offen sc1
  v_add_u32 v8, s55, v144
  v_mfma_f32_16x16x32_bf16 v[52:55], v[84:87], v[156:159], v[52:55]
  v_mfma_f32_16x16x32_bf16 v[56:59], v[88:91], v[156:159], v[56:59]
  v_mfma_f32_16x16x32_bf16 v[60:63], v[92:95], v[156:159], v[60:63]
  s_waitcnt vmcnt(4)
  buffer_load_dwordx4 v[156:159], v10, s[20:23], 0 offen sc1
  v_add_u32 v10, s55, v145
  v_mfma_f32_16x16x32_bf16 v[32:35], v[96:99], v[160:163], v[32:35]
  s_add_u32 s55, s55, 135168
  s_cmp_eq_u32 s55, s54
  s_cselect_b32 s55, s53, s55
  v_mfma_f32_16x16x32_bf16 v[36:39], v[100:103], v[160:163], v[36:39]
  v_mfma_f32_16x16x32_bf16 v[40:43], v[104:107], v[160:163], v[40:43]
  v_mfma_f32_16x16x32_bf16 v[44:47], v[108:111], v[160:163], v[44:47]
  s_waitcnt vmcnt(4)
  v_mfma_f32_16x16x32_bf16 v[48:51], v[96:99], v[164:167], v[48:51]
  buffer_load_dwordx4 v[160:163], v8, s[20:23], 0 offen sc1
  v_add_u32 v8, s55, v144
  v_mfma_f32_16x16x32_bf16 v[52:55], v[100:103], v[164:167], v[52:55]
  v_mfma_f32_16x16x32_bf16 v[56:59], v[104:107], v[164:167], v[56:59]
  v_mfma_f32_16x16x32_bf16 v[60:63], v[108:111], v[164:167], v[60:63]
  s_waitcnt vmcnt(4)
  buffer_load_dwordx4 v[164:167], v10, s[20:23], 0 offen sc1
  v_add_u32 v10, s55, v145
  s_add_u32 s55, s55, 135168
  s_cmp_eq_u32 s55, s54
  s_cselect_b32 s55, s53, s55
  v_mfma_f32_16x16x32_bf16 v[32:35], v[112:115], v[168:171], v[32:35]
  v_mfma_f32_16x16x32_bf16 v[36:39], v[116:119], v[168:171], v[36:39]
  v_mfma_f32_16x16x32_bf16 v[40:43], v[120:123], v[168:171], v[40:43]
  v_mfma_f32_16x16x32_bf16 v[44:47], v[124:127], v[168:171], v[44:47]
  s_waitcnt vmcnt(4)
  v_mfma_f32_16x16x32_bf16 v[48:51], v[112:115], v[172:175], v[48:51]
  buffer_load_dwordx4 v[168:171], v8, s[20:23], 0 offen sc1
  v_add_u32 v8, s55, v144
  v_mfma_f32_16x16x32_bf16 v[52:55], v[116:119], v[172:175], v[52:55]
  v_mfma_f32_16x16x32_bf16 v[56:59], v[120:123], v[172:175], v[56:59]
  v_mfma_f32_16x16x32_bf16 v[60:63], v[124:127], v[172:175], v[60:63]
  s_waitcnt vmcnt(4)
  buffer_load_dwordx4 v[172:175], v10, s[20:23], 0 offen sc1
  v_add_u32 v10, s55, v145
  s_add_u32 s55, s55, 135168
  s_cmp_eq_u32 s55, s54
  s_cselect_b32 s55, s53, s55
  v_mfma_f32_16x16x32_bf16 v[32:35], v[128:131], v[152:155], v[32:35]
  v_mfma_f32_16x16x32_bf16 v[36:39], v[132:135], v[152:155], v[36:39]
  v_mfma_f32_16x16x32_bf16 v[40:43], v[136:139], v[152:155], v[40:43]
  v_mfma_f32_16x16x32_bf16 v[44:47], v[140:143], v[152:155], v[44:47]
  s_waitcnt vmcnt(4)
  v_mfma_f32_16x16x32_bf16 v[48:51], v[128:131], v[156:159], v[48:51]
  buffer_load_dwordx4 v[152:155], v8, s[20:23], 0 offen sc1
  v_add_u32 v8, s55, v144
  v_mfma_f32_16x16x32_bf16 v[52:55], v[132:135], v[156:159], v[52:55]
  v_mfma_f32_16x16x32_bf16 v[56:59], v[136:139], v[156:159], v[56:59]
  v_mfma_f32_16x16x32_bf16 v[60:63], v[140:143], v[156:159], v[60:63]
  s_waitcnt vmcnt(4) lgkmcnt(15)
  buffer_load_dwordx4 v[156:159], v10, s[20:23], 0 offen sc1
  v_add_u32 v10, s55, v145
  v_mfma_f32_16x16x32_bf16 v[32:35], a[48:51], v[160:163], v[32:35]
  s_waitcnt lgkmcnt(15)
  s_add_u32 s55, s55, 135168
  s_cmp_eq_u32 s55, s54
  s_cselect_b32 s55, s53, s55
  v_mfma_f32_16x16x32_bf16 v[36:39], a[52:55], v[160:163], v[36:39]
  s_waitcnt lgkmcnt(15)
  v_mfma_f32_16x16x32_bf16 v[40:43], a[56:59], v[160:163], v[40:43]
  s_waitcnt lgkmcnt(15)
  v_mfma_f32_16x16x32_bf16 v[44:47], a[60:63], v[160:163], v[44:47]
  s_waitcnt vmcnt(4)
  v_mfma_f32_16x16x32_bf16 v[48:51], a[48:51], v[164:167], v[48:51]
  buffer_load_dwordx4 v[160:163], v8, s[20:23], 0 offen sc1
  v_add_u32 v8, s55, v144
  v_mfma_f32_16x16x32_bf16 v[52:55], a[52:55], v[164:167], v[52:55]
  v_mfma_f32_16x16x32_bf16 v[56:59], a[56:59], v[164:167], v[56:59]
  v_mfma_f32_16x16x32_bf16 v[60:63], a[60:63], v[164:167], v[60:63]
  s_waitcnt vmcnt(4) lgkmcnt(15)
  buffer_load_dwordx4 v[164:167], v10, s[20:23], 0 offen sc1
  v_add_u32 v10, s55, v145
  s_add_u32 s55, s55, 135168
  s_cmp_eq_u32 s55, s54
  s_cselect_b32 s55, s53, s55
  v_mfma_f32_16x16x32_bf16 v[32:35], a[64:67], v[168:171], v[32:35]
  s_waitcnt lgkmcnt(15)
  ds_write_b32 v0, v146 offset:64
  v_mfma_f32_16x16x32_bf16 v[36:39], a[68:71], v[168:171], v[36:39]
  s_waitcnt lgkmcnt(15)
  v_mfma_f32_16x16x32_bf16 v[40:43], a[72:75], v[168:171], v[40:43]
  s_waitcnt lgkmcnt(15)
  v_mfma_f32_16x16x32_bf16 v[44:47], a[76:79], v[168:171], v[44:47]
  s_waitcnt vmcnt(4)
  v_mfma_f32_16x16x32_bf16 v[48:51], a[64:67], v[172:175], v[48:51]
  buffer_load_dwordx4 v[168:171], v8, s[20:23], 0 offen sc1
  v_add_u32 v8, s55, v144
  v_mfma_f32_16x16x32_bf16 v[52:55], a[68:71], v[172:175], v[52:55]
  v_mfma_f32_16x16x32_bf16 v[56:59], a[72:75], v[172:175], v[56:59]
  v_mfma_f32_16x16x32_bf16 v[60:63], a[76:79], v[172:175], v[60:63]
  s_waitcnt vmcnt(4) lgkmcnt(15)
  buffer_load_dwordx4 v[172:175], v10, s[20:23], 0 offen sc1
  v_add_u32 v10, s55, v145
  s_add_u32 s55, s55, 135168
  s_cmp_eq_u32 s55, s54
  s_cselect_b32 s55, s53, s55
  v_mfma_f32_16x16x32_bf16 v[32:35], a[0:3], v[152:155], v[32:35]
  s_waitcnt lgkmcnt(15)
  v_mfma_f32_16x16x32_bf16 v[36:39], a[4:7], v[152:155], v[36:39]
  s_waitcnt lgkmcnt(15)
  v_mfma_f32_16x16x32_bf16 v[40:43], a[8:11], v[152:155], v[40:43]
  s_waitcnt lgkmcnt(15)
  v_mfma_f32_16x16x32_bf16 v[44:47], a[12:15], v[152:155], v[44:47]
  s_waitcnt vmcnt(4)
  v_mfma_f32_16x16x32_bf16 v[48:51], a[0:3], v[156:159], v[48:51]
  buffer_load_dwordx4 v[152:155], v8, s[20:23], 0 offen sc1
  v_mfma_f32_16x16x32_bf16 v[52:55], a[4:7], v[156:159], v[52:55]
  v_mfma_f32_16x16x32_bf16 v[56:59], a[8:11], v[156:159], v[56:59]
  v_mfma_f32_16x16x32_bf16 v[60:63], a[12:15], v[156:159], v[60:63]
  s_waitcnt vmcnt(4) lgkmcnt(15)
  buffer_load_dwordx4 v[156:159], v10, s[20:23], 0 offen sc1
  v_mfma_f32_16x16x32_bf16 v[32:35], a[16:19], v[160:163], v[32:35]
  s_waitcnt lgkmcnt(15)
  v_mfma_f32_16x16x32_bf16 v[36:39], a[20:23], v[160:163], v[36:39]
  s_waitcnt lgkmcnt(15)
  v_mfma_f32_16x16x32_bf16 v[40:43], a[24:27], v[160:163], v[40:43]
  s_waitcnt lgkmcnt(15)
  v_mfma_f32_16x16x32_bf16 v[44:47], a[28:31], v[160:163], v[44:47]
  s_waitcnt vmcnt(4)
  v_mfma_f32_16x16x32_bf16 v[48:51], a[16:19], v[164:167], v[48:51]
  v_mfma_f32_16x16x32_bf16 v[52:55], a[20:23], v[164:167], v[52:55]
  v_mfma_f32_16x16x32_bf16 v[56:59], a[24:27], v[164:167], v[56:59]
  v_mfma_f32_16x16x32_bf16 v[60:63], a[28:31], v[164:167], v[60:63]
  s_waitcnt vmcnt(3) lgkmcnt(15)
  v_mfma_f32_16x16x32_bf16 v[32:35], a[32:35], v[168:171], v[32:35]
  s_waitcnt lgkmcnt(13)
  ds_read_b32 v31, v30 offset:64
  v_mfma_f32_16x16x32_bf16 v[36:39], a[36:39], v[168:171], v[36:39]
  s_waitcnt lgkmcnt(12)
  v_mfma_f32_16x16x32_bf16 v[40:43], a[40:43], v[168:171], v[40:43]
  s_waitcnt lgkmcnt(10)
  v_mfma_f32_16x16x32_bf16 v[44:47], a[44:47], v[168:171], v[44:47]
  s_waitcnt vmcnt(2)
  v_mfma_f32_16x16x32_bf16 v[48:51], a[32:35], v[172:175], v[48:51]
  v_mfma_f32_16x16x32_bf16 v[52:55], a[36:39], v[172:175], v[52:55]
  v_mfma_f32_16x16x32_bf16 v[56:59], a[40:43], v[172:175], v[56:59]
  v_mfma_f32_16x16x32_bf16 v[60:63], a[44:47], v[172:175], v[60:63]
  s_waitcnt vmcnt(1) lgkmcnt(8)
  v_mfma_f32_16x16x32_bf16 v[32:35], v[64:67], v[152:155], v[32:35]
  s_waitcnt lgkmcnt(6)
  v_mfma_f32_16x16x32_bf16 v[36:39], v[68:71], v[152:155], v[36:39]
  s_waitcnt lgkmcnt(4)
  v_mfma_f32_16x16x32_bf16 v[40:43], v[72:75], v[152:155], v[40:43]
  s_waitcnt lgkmcnt(0)
  L_pfc1:
  v_readfirstlane_b32 s64, v31
  s_nop 1
  s_cmp_ge_u32 s64, 4
  s_cbranch_scc1 L_pfdc1
  ds_read_b32 v31, v30 offset:64
  s_waitcnt lgkmcnt(0)
  s_branch L_pfc1
L_pfdc1:
  v_mfma_f32_16x16x32_bf16 v[44:47], v[76:79], v[152:155], v[44:47]
  s_waitcnt vmcnt(0)
  s_nop 1
  ds_write_b128 v16, v[36:39] offset:3584
  v_mfma_f32_16x16x32_bf16 v[48:51], v[64:67], v[156:159], v[48:51]
  v_mfma_f32_16x16x32_bf16 v[52:55], v[68:71], v[156:159], v[52:55]
  v_lshlrev_b32 v64, 16, v4
  v_and_b32 v65, 0xffff0000, v4
  v_lshlrev_b32 v66, 16, v5
  v_mfma_f32_16x16x32_bf16 v[56:59], v[72:75], v[156:159], v[56:59]
  v_and_b32 v67, 0xffff0000, v5
  v_lshlrev_b32 v68, 16, v6
  v_and_b32 v69, 0xffff0000, v6
  v_mfma_f32_16x16x32_bf16 v[60:63], v[76:79], v[156:159], v[60:63]
  ds_write_b128 v16, v[52:55] offset:4608
  v_lshlrev_b32 v70, 16, v7
  v_and_b32 v71, 0xffff0000, v7
  ds_write_b128 v16, v[40:43] offset:42496
  ds_write_b128 v16, v[56:59] offset:43520
  ds_write_b128 v16, v[44:47] offset:58880
  s_nop 1
  ds_write_b128 v16, v[60:63] offset:59904
  s_waitcnt lgkmcnt(0)
  s_barrier
  ds_read_b128 v[80:83], v17 offset:0
  ds_read_b128 v[88:91], v18 offset:0
  ds_read_b128 v[84:87], v17 offset:1024
  ds_read_b128 v[92:95], v18 offset:1024
  ds_read_b128 v[96:99], v19 offset:0
  ds_read_b128 v[100:103], v19 offset:1024
  s_waitcnt lgkmcnt(4)
  v_pk_add_f32 v[80:81], v[80:81], v[88:89]
  v_pk_add_f32 v[82:83], v[82:83], v[90:91]
  s_waitcnt lgkmcnt(2)
  v_pk_add_f32 v[84:85], v[84:85], v[92:93]
  v_pk_add_f32 v[86:87], v[86:87], v[94:95]
  s_waitcnt lgkmcnt(1)
  v_pk_add_f32 v[80:81], v[80:81], v[96:97]
  v_pk_add_f32 v[82:83], v[82:83], v[98:99]
  s_waitcnt lgkmcnt(0)
  v_pk_add_f32 v[84:85], v[84:85], v[100:101]
  v_pk_add_f32 v[86:87], v[86:87], v[102:103]
  v_mul_f32 v72, 0xbfb8aa3b, v80
  v_mul_f32 v73, 0xbfb8aa3b, v81
  v_mul_f32 v74, 0xbfb8aa3b, v82
  v_mul_f32 v75, 0xbfb8aa3b, v83
  v_mul_f32 v76, 0xbfb8aa3b, v84
  v_mul_f32 v77, 0xbfb8aa3b, v85
  v_mul_f32 v78, 0xbfb8aa3b, v86
  v_mul_f32 v79, 0xbfb8aa3b, v87
  v_exp_f32 v72, v72
  v_exp_f32 v73, v73
  v_exp_f32 v74, v74
  v_exp_f32 v75, v75
  v_exp_f32 v76, v76
  v_exp_f32 v77, v77
  v_exp_f32 v78, v78
  v_exp_f32 v79, v79
  v_add_f32 v72, 1.0, v72
  v_add_f32 v73, 1.0, v73
  v_add_f32 v74, 1.0, v74
  v_add_f32 v75, 1.0, v75
  v_add_f32 v76, 1.0, v76
  v_add_f32 v77, 1.0, v77
  v_add_f32 v78, 1.0, v78
  v_add_f32 v79, 1.0, v79
  v_rcp_f32 v72, v72
  v_rcp_f32 v73, v73
  v_rcp_f32 v74, v74
  v_rcp_f32 v75, v75
  v_rcp_f32 v76, v76
  v_rcp_f32 v77, v77
  v_rcp_f32 v78, v78
  v_rcp_f32 v79, v79
  v_pk_mul_f32 v[80:81], v[80:81], v[32:33]
  v_pk_mul_f32 v[82:83], v[82:83], v[34:35]
  v_pk_mul_f32 v[84:85], v[84:85], v[48:49]
  v_pk_mul_f32 v[86:87], v[86:87], v[50:51]
  v_pk_fma_f32 v[64:65], v[80:81], v[72:73], v[64:65]
  v_pk_fma_f32 v[66:67], v[82:83], v[74:75], v[66:67]
  v_pk_fma_f32 v[68:69], v[84:85], v[76:77], v[68:69]
  v_pk_fma_f32 v[70:71], v[86:87], v[78:79], v[70:71]
  v_cvt_pk_bf16_f32 v4, v64, v65
  v_cvt_pk_bf16_f32 v5, v66, v67
  v_cvt_pk_bf16_f32 v6, v68, v69
  v_cvt_pk_bf16_f32 v7, v70, v71
  buffer_store_dwordx2 v[4:5], v13, s[16:19], 0 offen nt
  buffer_store_dwordx2 v[6:7], v14, s[16:19], 0 offen nt
  s_endpgm
L_pub:
  v_lshl_add_u32 v7, v1, 3, s101
  v_cmp_gt_u32 vcc, 16, v1
  s_nop 1
  v_cndmask_b32 v7, -16, v7, vcc
  s_waitcnt vmcnt(0)
  s_barrier
  s_cmp_lg_u32 s30, 6
  s_cbranch_scc1 L_end
  v_cmp_ne_u32 vcc, 0, v28
  s_nop 4
  s_cbranch_vccz L_pnb
L_psb:
  buffer_store_dwordx2 v[28:29], v7, s[24:27], 0 offen sc1
  s_endpgm
L_pns00:
  s_mov_b32 s65, 0
L_pos00:
  v_mov_b32 v54, 0
  s_sleep 4
  global_load_dwordx2 v[58:59], v54, s[60:61] sc1
  s_add_u32 s65, s65, 1
  s_waitcnt vmcnt(0)
  v_cmp_ne_u32 vcc, 0, v58
  s_cmp_ge_u32 s65, 0x40000
  s_cbranch_scc1 L_pss00
  s_nop 3
  s_cbranch_vccz L_pos00
  s_branch L_pss00
L_pns01:
  s_mov_b32 s65, 0
L_pos01:
  v_mov_b32 v54, 0
  s_sleep 4
  global_load_dwordx2 v[58:59], v54, s[60:61] sc1
  s_add_u32 s65, s65, 1
  s_waitcnt vmcnt(0)
  v_cmp_ne_u32 vcc, 0, v58
  s_cmp_ge_u32 s65, 0x40000
  s_cbranch_scc1 L_pss01
  s_nop 3
  s_cbranch_vccz L_pos01
  s_branch L_pss01
L_qt0:
  s_mov_b32 s65, 0
L_qot0:
  s_sleep 4
  buffer_load_dwordx4 v[48:51], v52, s[24:27], 0 offen sc1
  s_add_u32 s65, s65, 1
  s_waitcnt vmcnt(0)
  v_cmp_ne_u32 vcc, v49, v58
  v_cmp_ne_u32 s[48:49], v51, v59
  s_cmp_ge_u32 s65, 0x40000
  s_cbranch_scc1 L_rt0
  s_nop 1
  s_or_b64 vcc, vcc, s[48:49]
  s_cbranch_scc1 L_qot0
  s_branch L_rt0
L_pns11:
  s_mov_b32 s65, 0
L_pos11:
  v_mov_b32 v54, 0
  s_sleep 4
  global_load_dwordx2 v[58:59], v54, s[60:61] sc1
  s_add_u32 s65, s65, 1
  s_waitcnt vmcnt(0)
  v_cmp_ne_u32 vcc, 0, v58
  s_cmp_ge_u32 s65, 0x40000
  s_cbranch_scc1 L_pss11
  s_nop 3
  s_cbranch_vccz L_pos11
  s_branch L_pss11
L_qt1:
  s_mov_b32 s65, 0
L_qot1:
  s_sleep 4
  buffer_load_dwordx4 v[48:51], v52, s[24:27], 0 offen sc1
  s_add_u32 s65, s65, 1
  s_waitcnt vmcnt(0)
  v_cmp_ne_u32 vcc, v49, v58
  v_cmp_ne_u32 s[48:49], v51, v59
  s_cmp_ge_u32 s65, 0x40000
  s_cbranch_scc1 L_rt1
  s_nop 1
  s_or_b64 vcc, vcc, s[48:49]
  s_cbranch_scc1 L_qot1
  s_branch L_rt1
L_pna:
  s_mov_b32 s65, 0
L_poa:
  v_mov_b32 v6, 0
  s_sleep 4
  global_load_dwordx2 v[28:29], v6, s[60:61] sc1
  s_add_u32 s65, s65, 1
  s_waitcnt vmcnt(0)
  v_cmp_ne_u32 vcc, 0, v28
  s_cmp_ge_u32 s65, 0x40000
  s_cbranch_scc1 L_psa
  s_nop 3
  s_cbranch_vccz L_poa
  s_branch L_psa
L_pnb:
  s_mov_b32 s65, 0
L_pob:
  v_mov_b32 v6, 0
  s_sleep 4
  global_load_dwordx2 v[28:29], v6, s[60:61] sc1
  s_add_u32 s65, s65, 1
  s_waitcnt vmcnt(0)
  v_cmp_ne_u32 vcc, 0, v28
  s_cmp_ge_u32 s65, 0x40000
  s_cbranch_scc1 L_psb
  s_nop 3
  s_cbranch_vccz L_pob
  s_branch L_psb
L_end:
  s_endpgm
.section .rodata,"a"
.p2align 6
.amdhsa_kernel recurrent_scan__sliding_local_dilated__glu_gated_bilinear__prompt_kernel
  .amdhsa_next_free_vgpr 256
  .amdhsa_next_free_sgpr 102
  .amdhsa_accum_offset 176
  .amdhsa_group_segment_fixed_size 0
  .amdhsa_kernarg_size 80
  .amdhsa_user_sgpr_count 2
  .amdhsa_user_sgpr_kernarg_segment_ptr 1
  .amdhsa_system_sgpr_workgroup_id_x 1
.end_amdhsa_kernel
```
